```python
import torch

def _softmax(x, axis=-1):
    return torch.softmax(x, dim=axis)

def _gelu(x):
    return torch.nn.functional.gelu(x, approximate='tanh')

def _silu(x):
    return torch.nn.functional.silu(x)

def _sigmoid(x):
    return torch.sigmoid(x)

def _layernorm(x, axis=-1, eps=1e-05):
    m = x.mean(dim=axis, keepdim=True)
    v = x.var(dim=axis, keepdim=True, unbiased=False)
    return (x - m) / torch.sqrt(v + eps)

def _scatter_add(tgt, idx, src, axis=0):
    return tgt.clone().index_add_(axis, idx, src)

def _segment_sum(src, seg, n):
    out = torch.zeros((n,) + src.shape[1:], dtype=src.dtype)
    return out.index_add_(0, seg, src)

def _pad(x, pw):
    flat = tuple((v for pair in reversed(pw) for v in pair))
    return torch.nn.functional.pad(x, flat)
kernel_name = 'concat_heads__memory_aug_recurrent_mem_tr__mha_block__prompt'

def setup_inputs():

    _w = lambda a: (lambda t: t.to(torch.bfloat16) if t.is_floating_point() else t)(torch.as_tensor(a))

    def _A_setup():
        B, S, Dm = (1, 2048, 512)
        H, Dh = (32, 128)
        M, seg = (8, 32)
        seg = min(seg, S)
        S = S // seg * seg
        return {'x': _w((lambda *s: torch.randn(*s, dtype=torch.bfloat16) * 0.05)(B, S, Dm)), 'mem0': _w((lambda *s: torch.randn(*s, dtype=torch.bfloat16) * 0.8)(B, M, Dm)), 'Wq': _w((lambda *s: torch.randn(*s, dtype=torch.bfloat16) * 1.6)(Dm, H, Dh) * Dm ** (-0.5)), 'Wk': _w((lambda *s: torch.randn(*s, dtype=torch.bfloat16) * 1.6)(Dm, H, Dh) * Dm ** (-0.5)), 'Wv': _w((lambda *s: torch.randn(*s, dtype=torch.bfloat16) * 0.8)(Dm, H, Dh) * Dm ** (-0.5)), 'Wo': _w((lambda *s: torch.randn(*s, dtype=torch.bfloat16) * 0.8)(H, Dh, Dm) * (H * Dh) ** (-0.5)), 'seg_len': seg}
    _A_in = _A_setup()

    def _B_setup():
        B, S, D, H = (1, 2048, 512, 32)
        return {'x': _w((lambda *s: torch.randn(*s, dtype=torch.bfloat16) * 0.2)(B, S, D)), 'wqkv': _w((lambda *s: torch.randn(*s, dtype=torch.bfloat16) * 0.2)(D, 3 * D)), 'wo': _w((lambda *s: torch.randn(*s, dtype=torch.bfloat16) * 0.05)(D, D))}
    _B_in = _B_setup()
    return {'A_x': _A_in['x'], 'A_mem0': _A_in['mem0'], 'A_Wq': _A_in['Wq'], 'A_Wk': _A_in['Wk'], 'A_Wv': _A_in['Wv'], 'A_Wo': _A_in['Wo'], 'A_seg_len': _A_in['seg_len'], 'B_x': _B_in['x'], 'B_wqkv': _B_in['wqkv'], 'B_wo': _B_in['wo']}

def reference(A_x, A_mem0, A_Wq, A_Wk, A_Wv, A_Wo, A_seg_len, B_x, B_wqkv, B_wo):

    def _A_ref(x, mem0, Wq, Wk, Wv, Wo, seg_len):
        B, S, Dm = x.shape
        H, Dh = (Wq.shape[1], Wq.shape[2])
        M = mem0.shape[1]
        scale = Dh ** (-0.5)
        n_seg = S // seg_len
        L = M + seg_len
        idx = torch.arange(L)
        mask = (idx[:, None] < M) | (idx[:, None] >= idx[None, :])
        mem = mem0
        outs = []
        for s in range(n_seg):
            xs = x[:, s * seg_len:(s + 1) * seg_len, :].clone()
            h = torch.concatenate([mem, xs], axis=1)
            q = torch.einsum('btd,dhe->bhte', h, Wq)
            k = torch.einsum('btd,dhe->bhte', h, Wk)
            v = torch.einsum('btd,dhe->bhte', h, Wv)
            scores = torch.einsum('bhqe,bhke->bhqk', q, k) * scale
            scores = torch.where(mask[None, None], scores, -1000000000.0)
            p = _softmax(scores, axis=-1)
            o = torch.einsum('bhqk,bhke->bhqe', p, v)
            o = torch.einsum('bhte,hed->btd', o, Wo)
            mem = o[:, :M, :].clone()
            outs.append(o[:, M:, :])
        return torch.concatenate(outs, axis=1)

    def _B_ref(x, wqkv, wo):
        B, S, D = x.shape
        H = 32
        Dh = D // H
        qkv = (lambda x, *d: x.permute(*d))((x @ wqkv).reshape(B, S, 3, H, Dh), 2, 0, 3, 1, 4)
        q, k, v = (qkv[0], qkv[1], qkv[2])
        scores = torch.einsum('bhqd,bhkd->bhqk', q, k) * Dh ** (-0.5)
        p = _softmax(scores, axis=-1)
        o = torch.einsum('bhqk,bhkd->bhqd', p, v)
        return (lambda x, *d: x.permute(*d))(o, 0, 2, 1, 3).reshape(B, S, D) @ wo
    a = _A_ref(A_x, A_mem0, A_Wq, A_Wk, A_Wv, A_Wo, A_seg_len)
    b = _B_ref(B_x, B_wqkv, B_wo)
    return torch.concatenate([a, b], axis=-1)
```

```asm
; @launch grid=(256,1,1) block=(256,1,1) lds=163840
.amdgcn_target "amdgcn-amd-amdhsa--gfx950"
.text
.globl concat_heads__memory_aug_recurrent_mem_tr__mha_block__prompt_kernel
.p2align 8
.type concat_heads__memory_aug_recurrent_mem_tr__mha_block__prompt_kernel,@function
concat_heads__memory_aug_recurrent_mem_tr__mha_block__prompt_kernel:
    s_cmp_ge_u32 s2, 256
    s_cbranch_scc1 L_exit
    s_load_dwordx4 s[4:7], s[0:1], 88
    s_load_dwordx8 s[64:71], s[0:1], 16
    s_load_dwordx2 s[72:73], s[0:1], 8
    s_getreg_b32 s60, hwreg(HW_REG_XCC_ID, 0, 3)
    s_lshl_b32 s60, s60, 2
    s_lshr_b32 s60, 0x36251407, s60
    s_and_b32 s60, s60, 7
    v_lshrrev_b32 v1, 6, v0
    s_nop 0
    v_readfirstlane_b32 s18, v1
    s_lshl_b32 s3, s60, 2
    s_cmp_eq_u32 s60, 0
    s_cselect_b32 s3, 128, s3
    v_mov_b32 v3, s3
    v_mov_b32 v4, 1
    v_mov_b32 v6, 0
    s_mov_b32 s101, 0
    s_waitcnt lgkmcnt(0)
    s_mov_b32 s16, s4
    s_mov_b32 s17, s5
    s_mov_b32 s8, s6
    s_and_b32 s9, s7, 0xffff
    s_mov_b32 s10, 268435456
    s_mov_b32 s11, 0x00020000
    s_cmp_eq_u32 s18, 0
    s_cbranch_scc0 L_noatom
    s_mov_b64 exec, 1
    global_atomic_add v5, v3, v4, s[16:17] sc0
    s_mov_b64 exec, -1
L_noatom:
    s_getpc_b64 s[74:75]
L_pc0:
    s_sub_u32 s74, s74, L_pc0-concat_heads__memory_aug_recurrent_mem_tr__mha_block__prompt_kernel
    s_subb_u32 s75, s75, 0
    s_and_b32 s77, s75, 0xffff
    s_mov_b32 s76, s74
    s_mov_b32 s78, L_code_end-concat_heads__memory_aug_recurrent_mem_tr__mha_block__prompt_kernel
    s_mov_b32 s79, 0x00020000
    v_lshlrev_b32 v7, 7, v0
    buffer_load_dword v22, v7, s[76:79], 0 offen
    v_add_u32 v7, 0x8000, v7
    buffer_load_dword v22, v7, s[76:79], 0 offen
    s_cmp_eq_u32 s60, 0
    s_cbranch_scc0 L_nopre
    s_cmp_eq_u32 s18, 0
    s_cbranch_scc1 L_nopre
    s_mov_b32 s76, s70
    s_and_b32 s77, s71, 0xffff
    s_mov_b32 s78, 4194304
    s_mov_b32 s79, 0x00020000
    v_lshlrev_b32 v7, 7, v0
    s_lshr_b32 s74, s2, 3
    s_lshl_b32 s74, s74, 17
    buffer_load_dword v22, v7, s[76:79], s74 offen
    s_add_u32 s74, s74, 0x8000
    buffer_load_dword v22, v7, s[76:79], s74 offen
    s_add_u32 s74, s74, 0x8000
L_nopre:
    s_cmp_eq_u32 s60, 0
    s_cbranch_scc1 L_nowo
    s_sub_u32 s75, s18, 1
    s_cmp_ge_u32 s75, 2
    s_cbranch_scc1 L_nowo
    s_mov_b32 s76, s70
    s_and_b32 s77, s71, 0xffff
    s_mov_b32 s78, 4194304
    s_mov_b32 s79, 0x00020000
    v_and_b32 v7, 63, v0
    v_lshlrev_b32 v7, 7, v7
    s_lshl_b32 s74, s2, 14
    s_lshl_b32 s75, s75, 13
    s_add_u32 s74, s74, s75
    buffer_load_dword v22, v7, s[76:79], s74 offen
    s_mov_b32 s76, s68
    s_and_b32 s77, s69, 0xffff
    s_mov_b32 s78, 4194304
    s_mov_b32 s79, 0x00020000
    buffer_load_dword v22, v7, s[76:79], s74 offen
L_nowo:
    s_cmp_eq_u32 s18, 0
    s_cbranch_scc0 L_tk
    s_waitcnt vmcnt(2)
L_tkw:
    s_mov_b64 exec, 1
    ds_write_b32 v6, v5
    s_waitcnt lgkmcnt(0)
    s_mov_b64 exec, -1
L_tk:
    s_barrier
    ds_read_b32 v5, v6
    s_waitcnt lgkmcnt(0)
    v_readfirstlane_b32 s61, v5
    s_barrier
    s_cmp_ge_u32 s61, 32
    s_cbranch_scc1 L_exit
    s_cmp_lg_u32 s60, 0
    s_cbranch_scc1 L_worker
    s_mov_b32 s19, s61
    v_and_b32 v28, 63, v0
    v_and_b32 v24, 15, v28
    v_lshrrev_b32 v25, 4, v28
    s_mov_b32 s12, s64
    s_and_b32 s13, s65, 0xffff
    s_mov_b32 s14, 4194304
    s_mov_b32 s15, 0x00020000
    s_mov_b32 s44, s66
    s_and_b32 s45, s67, 0xffff
    s_mov_b32 s46, 4194304
    s_mov_b32 s47, 0x00020000
    s_mov_b32 s48, s68
    s_and_b32 s49, s69, 0xffff
    s_mov_b32 s50, 4194304
    s_mov_b32 s51, 0x00020000
    s_mov_b32 s52, s70
    s_and_b32 s53, s71, 0xffff
    s_mov_b32 s54, 4194304
    s_mov_b32 s55, 0x00020000
    v_lshlrev_b32 v143, 13, v25
    v_lshl_add_u32 v143, v24, 4, v143
    s_lshl_b32 s37, s19, 8
    v_add_u32 v143, s37, v143
    v_lshrrev_b32 v29, 3, v28
    v_lshlrev_b32 v29, 16, v29
    v_bfe_u32 v30, v28, 1, 2
    v_lshl_add_u32 v29, v30, 13, v29
    v_and_b32 v30, 1, v28
    v_lshl_add_u32 v29, v30, 7, v29
    v_add_u32 v138, s37, v29
    v_lshrrev_b32 v27, 1, v25
    v_and_b32 v26, 1, v25
    v_lshlrev_b32 v29, 4, v27
    v_lshl_add_u32 v29, v26, 3, v29
    v_lshlrev_b32 v29, 10, v29
    v_lshl_add_u32 v29, v24, 4, v29
    s_lshl_b32 s37, s19, 17
    s_lshl_b32 s38, s18, 8
    s_add_u32 s37, s37, s38
    v_add_u32 v13, s37, v29
    s_add_u32 s74, s18, 3
    s_and_b32 s75, s74, 1
    s_and_b32 s74, s74, 2
    s_lshl_b32 s74, s74, 15
    s_lshl_b32 s75, s75, 11
    s_add_u32 s74, s74, s75
    s_add_u32 s76, s74, 0
    buffer_load_dwordx4 v[144:147], v13, s[52:55], s76 offen
    s_add_u32 s76, s74, 1024
    buffer_load_dwordx4 v[148:151], v13, s[52:55], s76 offen
    s_add_u32 s76, s74, 4096
    buffer_load_dwordx4 v[152:155], v13, s[52:55], s76 offen
    s_add_u32 s76, s74, 5120
    buffer_load_dwordx4 v[156:159], v13, s[52:55], s76 offen
    s_add_u32 s76, s74, 32768
    buffer_load_dwordx4 v[160:163], v13, s[52:55], s76 offen
    s_add_u32 s76, s74, 33792
    buffer_load_dwordx4 v[164:167], v13, s[52:55], s76 offen
    s_add_u32 s76, s74, 36864
    buffer_load_dwordx4 v[168:171], v13, s[52:55], s76 offen
    s_add_u32 s76, s74, 37888
    buffer_load_dwordx4 v[172:175], v13, s[52:55], s76 offen
    s_add_u32 s74, s18, 0
    s_and_b32 s75, s74, 1
    s_and_b32 s74, s74, 2
    s_lshl_b32 s74, s74, 15
    s_lshl_b32 s75, s75, 11
    s_add_u32 s74, s74, s75
    s_add_u32 s76, s74, 0
    buffer_load_dwordx4 v[40:43], v13, s[52:55], s76 offen
    s_add_u32 s76, s74, 1024
    buffer_load_dwordx4 v[44:47], v13, s[52:55], s76 offen
    s_add_u32 s76, s74, 4096
    buffer_load_dwordx4 v[48:51], v13, s[52:55], s76 offen
    s_add_u32 s76, s74, 5120
    buffer_load_dwordx4 v[52:55], v13, s[52:55], s76 offen
    s_add_u32 s76, s74, 32768
    buffer_load_dwordx4 v[56:59], v13, s[52:55], s76 offen
    s_add_u32 s76, s74, 33792
    buffer_load_dwordx4 v[60:63], v13, s[52:55], s76 offen
    s_add_u32 s76, s74, 36864
    buffer_load_dwordx4 v[64:67], v13, s[52:55], s76 offen
    s_add_u32 s76, s74, 37888
    buffer_load_dwordx4 v[68:71], v13, s[52:55], s76 offen
    s_add_u32 s74, s18, 1
    s_and_b32 s75, s74, 1
    s_and_b32 s74, s74, 2
    s_lshl_b32 s74, s74, 15
    s_lshl_b32 s75, s75, 11
    s_add_u32 s74, s74, s75
    s_add_u32 s76, s74, 0
    buffer_load_dwordx4 v[72:75], v13, s[52:55], s76 offen
    s_add_u32 s76, s74, 1024
    buffer_load_dwordx4 v[76:79], v13, s[52:55], s76 offen
    s_add_u32 s76, s74, 4096
    buffer_load_dwordx4 v[80:83], v13, s[52:55], s76 offen
    s_add_u32 s76, s74, 5120
    buffer_load_dwordx4 v[84:87], v13, s[52:55], s76 offen
    s_add_u32 s76, s74, 32768
    buffer_load_dwordx4 v[88:91], v13, s[52:55], s76 offen
    s_add_u32 s76, s74, 33792
    buffer_load_dwordx4 v[92:95], v13, s[52:55], s76 offen
    s_add_u32 s76, s74, 36864
    buffer_load_dwordx4 v[96:99], v13, s[52:55], s76 offen
    s_add_u32 s76, s74, 37888
    buffer_load_dwordx4 v[100:103], v13, s[52:55], s76 offen
    s_add_u32 s74, s18, 2
    s_and_b32 s75, s74, 1
    s_and_b32 s74, s74, 2
    s_lshl_b32 s74, s74, 15
    s_lshl_b32 s75, s75, 11
    s_add_u32 s74, s74, s75
    s_add_u32 s76, s74, 0
    buffer_load_dwordx4 v[104:107], v13, s[52:55], s76 offen
    s_add_u32 s76, s74, 1024
    buffer_load_dwordx4 v[108:111], v13, s[52:55], s76 offen
    s_add_u32 s76, s74, 4096
    buffer_load_dwordx4 v[112:115], v13, s[52:55], s76 offen
    s_add_u32 s76, s74, 5120
    buffer_load_dwordx4 v[116:119], v13, s[52:55], s76 offen
    s_add_u32 s76, s74, 32768
    buffer_load_dwordx4 v[120:123], v13, s[52:55], s76 offen
    s_add_u32 s76, s74, 33792
    buffer_load_dwordx4 v[124:127], v13, s[52:55], s76 offen
    s_add_u32 s76, s74, 36864
    buffer_load_dwordx4 v[128:131], v13, s[52:55], s76 offen
    s_add_u32 s76, s74, 37888
    buffer_load_dwordx4 v[132:135], v13, s[52:55], s76 offen
    s_lshl_b32 s74, s18, 20
    s_lshl_b32 s75, s18, 13
    s_add_u32 s76, s74, 0
    s_add_u32 m0, s75, 0
    s_nop 0
    buffer_load_dwordx4 v143, s[48:51], s76 offen  lds
    s_add_u32 s76, s74, 65536
    s_add_u32 m0, s75, 1024
    s_nop 0
    buffer_load_dwordx4 v143, s[48:51], s76 offen  lds
    s_add_u32 s76, s74, 131072
    s_add_u32 m0, s75, 2048
    s_nop 0
    buffer_load_dwordx4 v143, s[48:51], s76 offen  lds
    s_add_u32 s76, s74, 196608
    s_add_u32 m0, s75, 3072
    s_nop 0
    buffer_load_dwordx4 v143, s[48:51], s76 offen  lds
    s_add_u32 s76, s74, 262144
    s_add_u32 m0, s75, 4096
    s_nop 0
    buffer_load_dwordx4 v143, s[48:51], s76 offen  lds
    s_add_u32 s76, s74, 327680
    s_add_u32 m0, s75, 5120
    s_nop 0
    buffer_load_dwordx4 v143, s[48:51], s76 offen  lds
    s_add_u32 s76, s74, 393216
    s_add_u32 m0, s75, 6144
    s_nop 0
    buffer_load_dwordx4 v143, s[48:51], s76 offen  lds
    s_add_u32 s76, s74, 458752
    s_add_u32 m0, s75, 7168
    s_nop 0
    buffer_load_dwordx4 v143, s[48:51], s76 offen  lds
    s_lshl_b32 s74, s18, 20
    s_lshl_b32 s75, s18, 13
    s_add_u32 s76, s74, 524288
    s_add_u32 m0, s75, 32768
    s_nop 0
    buffer_load_dwordx4 v143, s[48:51], s76 offen  lds
    s_add_u32 s76, s74, 589824
    s_add_u32 m0, s75, 33792
    s_nop 0
    buffer_load_dwordx4 v143, s[48:51], s76 offen  lds
    s_add_u32 s76, s74, 655360
    s_add_u32 m0, s75, 34816
    s_nop 0
    buffer_load_dwordx4 v143, s[48:51], s76 offen  lds
    s_add_u32 s76, s74, 720896
    s_add_u32 m0, s75, 35840
    s_nop 0
    buffer_load_dwordx4 v143, s[48:51], s76 offen  lds
    s_add_u32 s76, s74, 786432
    s_add_u32 m0, s75, 36864
    s_nop 0
    buffer_load_dwordx4 v143, s[48:51], s76 offen  lds
    s_add_u32 s76, s74, 851968
    s_add_u32 m0, s75, 37888
    s_nop 0
    buffer_load_dwordx4 v143, s[48:51], s76 offen  lds
    s_add_u32 s76, s74, 917504
    s_add_u32 m0, s75, 38912
    s_nop 0
    buffer_load_dwordx4 v143, s[48:51], s76 offen  lds
    s_add_u32 s76, s74, 983040
    s_add_u32 m0, s75, 39936
    s_nop 0
    buffer_load_dwordx4 v143, s[48:51], s76 offen  lds
    v_and_b32 v26, 1, v25
    v_lshrrev_b32 v27, 1, v25
    v_and_b32 v31, 7, v24
    v_lshrrev_b32 v32, 3, v24
    v_lshlrev_b32 v0, 4, v28
    v_lshlrev_b32 v30, 2, v24
    s_lshl_b32 s37, s18, 6
    v_add_u32 v30, s37, v30
    v_mul_u32_u24 v29, 1312, v25
    v_add_u32 v2, v29, v30
    v_lshrrev_b32 v33, 2, v24
    v_mul_u32_u24 v29, 1312, v33
    v_and_b32 v33, 3, v24
    v_mul_u32_u24 v33, 320, v33
    v_add_u32 v29, v29, v33
    v_lshl_add_u32 v14, v25, 4, v29
    v_lshrrev_b32 v29, 2, v31
    v_and_b32 v33, 2, v31
    v_add_u32 v29, v29, v33
    v_mul_u32_u24 v29, 1312, v29
    v_and_b32 v33, 1, v31
    v_mul_u32_u24 v33, 384, v33
    v_add_u32 v29, v29, v33
    v_lshl_add_u32 v3, v25, 4, v29
    v_add_u32 v3, 10304, v3
    v_lshl_add_u32 v4, v32, 7, v3
    v_lshlrev_b32 v29, 4, v31
    v_add_u32 v29, 5184, v29
    v_lshl_add_u32 v5, v25, 7, v29
    v_lshl_add_u32 v29, v32, 9, v29
    v_lshl_add_u32 v29, v26, 7, v29
    v_lshl_add_u32 v29, v27, 2, v29
    s_lshr_b32 s37, s18, 1
    s_lshl_b32 s37, s37, 8
    s_and_b32 s38, s18, 1
    s_lshl_b32 s38, s38, 3
    s_add_u32 s37, s37, s38
    v_add_u32 v6, s37, v29
    v_lshrrev_b32 v36, 2, v24
    v_lshl_add_u32 v29, v36, 1, v27
    s_lshl_b32 s37, s18, 3
    v_add_u32 v29, s37, v29
    v_lshlrev_b32 v29, 13, v29
    v_and_b32 v37, 3, v24
    v_lshl_add_u32 v29, v26, 11, v29
    v_lshl_add_u32 v29, v37, 4, v29
    s_lshl_b32 s37, s19, 6
    v_add_u32 v7, s37, v29
    v_lshlrev_b32 v29, 4, v25
    v_lshl_add_u32 v29, v37, 2, v29
    s_lshr_b32 s37, s19, 3
    s_lshl_b32 s37, s37, 11
    s_and_b32 s38, s19, 7
    s_lshl_b32 s38, s38, 7
    s_add_u32 s37, s37, s38
    s_lshr_b32 s38, s18, 1
    s_lshl_b32 s38, s38, 10
    s_add_u32 s37, s37, s38
    s_and_b32 s38, s18, 1
    s_lshl_b32 s38, s38, 6
    s_add_u32 s37, s37, s38
    v_add_u32 v8, s37, v29
    v_lshlrev_b32 v29, 4, v31
    v_lshl_add_u32 v29, v25, 8, v29
    v_lshl_add_u32 v29, v32, 11, v29
    s_and_b32 s37, s18, 1
    s_lshl_b32 s37, s37, 12
    s_lshr_b32 s38, s18, 1
    s_lshl_b32 s38, s38, 7
    s_add_u32 s37, s37, s38
    v_add_u32 v9, s37, v29
    v_mov_b32 v11, 0x4444
    v_mov_b32 v29, 0xeeee
    v_cmp_lt_u32 vcc, 7, v24
    s_nop 1
    v_cndmask_b32 v11, v11, v29, vcc
    s_mov_b32 s34, 0x3e0293ee
    s_mov_b32 s35, 0x3e0293ee
    s_mov_b32 s42, 671088640
    s_mov_b32 m0, 14912
    v_lshlrev_b32 v29, 11, v25
    v_add_u32 v12, v29, v30
    v_sub_u32 v10, v12, v30
    v_lshl_add_u32 v10, v24, 3, v10
    s_lshr_b32 s37, s18, 1
    s_lshl_b32 s37, s37, 7
    s_and_b32 s38, s18, 1
    s_lshl_b32 s38, s38, 2
    s_add_u32 s37, s37, s38
    v_add_u32 v10, s37, v10
    v_lshlrev_b32 v29, 10, v31
    v_lshl_add_u32 v29, v25, 6, v29
    v_lshl_add_u32 v15, v32, 2, v29
    s_lshl_b32 s74, s18, 20
    s_lshl_b32 s75, s18, 13
    s_add_u32 s76, s74, 32768
    s_add_u32 m0, s75, 65536
    s_nop 0
    buffer_load_dwordx4 v143, s[48:51], s76 offen  lds
    s_add_u32 s76, s74, 98304
    s_add_u32 m0, s75, 66560
    s_nop 0
    buffer_load_dwordx4 v143, s[48:51], s76 offen  lds
    s_add_u32 s76, s74, 163840
    s_add_u32 m0, s75, 67584
    s_nop 0
    buffer_load_dwordx4 v143, s[48:51], s76 offen  lds
    s_add_u32 s76, s74, 229376
    s_add_u32 m0, s75, 68608
    s_nop 0
    buffer_load_dwordx4 v143, s[48:51], s76 offen  lds
    s_add_u32 s76, s74, 294912
    s_add_u32 m0, s75, 69632
    s_nop 0
    buffer_load_dwordx4 v143, s[48:51], s76 offen  lds
    s_add_u32 s76, s74, 360448
    s_add_u32 m0, s75, 70656
    s_nop 0
    buffer_load_dwordx4 v143, s[48:51], s76 offen  lds
    s_add_u32 s76, s74, 425984
    s_add_u32 m0, s75, 71680
    s_nop 0
    buffer_load_dwordx4 v143, s[48:51], s76 offen  lds
    s_add_u32 s76, s74, 491520
    s_add_u32 m0, s75, 72704
    s_nop 0
    buffer_load_dwordx4 v143, s[48:51], s76 offen  lds
    s_waitcnt vmcnt(48)
    v_mov_b32 v176, -1
    v_mov_b32 v177, -1
    v_mov_b32 v178, -1
    v_mov_b32 v179, -1
    s_lshl_b32 s37, s19, 13
    s_lshl_b32 s38, s18, 11
    s_add_u32 s37, s37, s38
    s_add_u32 s38, s37, 0x40000
    buffer_store_dwordx4 v[176:179], v0, s[8:11], s37 offen offset:0
    buffer_store_dwordx4 v[176:179], v0, s[8:11], s37 offen offset:1024
    buffer_store_dwordx4 v[176:179], v0, s[8:11], s38 offen offset:0
    buffer_store_dwordx4 v[176:179], v0, s[8:11], s38 offen offset:1024
    s_mov_b32 s39, 524288
    buffer_store_dword v176, v8, s[8:11], s39 offen
    s_mov_b32 s39, 532480
    buffer_store_dword v176, v8, s[8:11], s39 offen
    s_mov_b32 s39, 540672
    buffer_store_dword v176, v8, s[8:11], s39 offen
    s_lshl_b32 s37, s19, 14
    s_lshl_b32 s38, s18, 12
    s_add_u32 s37, s37, s38
    s_add_u32 s37, s37, 1048576
    buffer_store_dwordx4 v[176:179], v0, s[8:11], s37 offen offset:0 sc1
    buffer_store_dwordx4 v[176:179], v0, s[8:11], s37 offen offset:1024 sc1
    buffer_store_dwordx4 v[176:179], v0, s[8:11], s37 offen offset:2048 sc1
    buffer_store_dwordx4 v[176:179], v0, s[8:11], s37 offen offset:3072 sc1
    v_mov_b32 v33, 0
    v_lshrrev_b32 v34, 2, v0
    s_lshl_b32 s33, s19, 8
    s_add_u32 s33, s33, 557056
    buffer_store_dword v33, v34, s[8:11], s33 offen
    s_lshl_b32 s26, s19, 2
    s_add_u32 s26, s26, 557056
    s_mov_b32 s38, 0x05040100
    s_mov_b32 s39, 0x07060302
    s_mul_i32 s74, s18, 20480
    s_add_u32 s74, s74, 16384
    v_add_u32 v141, s74, v0
    s_add_u32 s74, s18, 2
    s_and_b32 s74, s74, 3
    s_lshl_b32 s74, s74, 14
    s_add_u32 s74, s74, 98304
    v_add_u32 v142, s74, v0
    s_waitcnt lgkmcnt(0)
    v_perm_b32 v240, v148, v144, s38
    v_perm_b32 v241, v149, v145, s38
    v_perm_b32 v242, v156, v152, s38
    v_perm_b32 v243, v157, v153, s38
    v_perm_b32 v244, v164, v160, s38
    v_perm_b32 v245, v165, v161, s38
    v_perm_b32 v246, v172, v168, s38
    v_perm_b32 v247, v173, v169, s38
    v_perm_b32 v248, v148, v144, s39
    v_perm_b32 v249, v149, v145, s39
    v_perm_b32 v250, v156, v152, s39
    v_perm_b32 v251, v157, v153, s39
    v_perm_b32 v252, v164, v160, s39
    v_perm_b32 v253, v165, v161, s39
    v_perm_b32 v254, v172, v168, s39
    v_perm_b32 v255, v173, v169, s39
    v_perm_b32 v24, v150, v146, s38
    v_perm_b32 v25, v151, v147, s38
    v_perm_b32 v26, v158, v154, s38
    v_perm_b32 v27, v159, v155, s38
    v_perm_b32 v28, v166, v162, s38
    v_perm_b32 v29, v167, v163, s38
    v_perm_b32 v30, v174, v170, s38
    v_perm_b32 v31, v175, v171, s38
    ds_write_b128 v142, v[24:27] offset:12288
    ds_write_b128 v142, v[28:31] offset:13312
    v_perm_b32 v32, v150, v146, s39
    v_perm_b32 v33, v151, v147, s39
    v_perm_b32 v34, v158, v154, s39
    v_perm_b32 v35, v159, v155, s39
    v_perm_b32 v36, v166, v162, s39
    v_perm_b32 v37, v167, v163, s39
    v_perm_b32 v38, v174, v170, s39
    v_perm_b32 v39, v175, v171, s39
    ds_write_b128 v142, v[32:35] offset:14336
    ds_write_b128 v142, v[36:39] offset:15360
    s_waitcnt vmcnt(52)
    s_waitcnt lgkmcnt(0)
    v_perm_b32 v168, v44, v40, s38
    v_perm_b32 v169, v45, v41, s38
    v_perm_b32 v170, v52, v48, s38
    v_perm_b32 v171, v53, v49, s38
    v_perm_b32 v172, v60, v56, s38
    v_perm_b32 v173, v61, v57, s38
    v_perm_b32 v174, v68, v64, s38
    v_perm_b32 v175, v69, v65, s38
    v_perm_b32 v176, v44, v40, s39
    v_perm_b32 v177, v45, v41, s39
    v_perm_b32 v178, v52, v48, s39
    v_perm_b32 v179, v53, v49, s39
    v_perm_b32 v180, v60, v56, s39
    v_perm_b32 v181, v61, v57, s39
    v_perm_b32 v182, v68, v64, s39
    v_perm_b32 v183, v69, v65, s39
    v_perm_b32 v184, v46, v42, s38
    v_perm_b32 v185, v47, v43, s38
    v_perm_b32 v186, v54, v50, s38
    v_perm_b32 v187, v55, v51, s38
    v_perm_b32 v188, v62, v58, s38
    v_perm_b32 v189, v63, v59, s38
    v_perm_b32 v190, v70, v66, s38
    v_perm_b32 v191, v71, v67, s38
    v_perm_b32 v192, v46, v42, s39
    v_perm_b32 v193, v47, v43, s39
    v_perm_b32 v194, v54, v50, s39
    v_perm_b32 v195, v55, v51, s39
    v_perm_b32 v196, v62, v58, s39
    v_perm_b32 v197, v63, v59, s39
    v_perm_b32 v198, v70, v66, s39
    v_perm_b32 v199, v71, v67, s39
    s_waitcnt vmcnt(44)
    s_waitcnt lgkmcnt(0)
    v_perm_b32 v200, v76, v72, s38
    v_perm_b32 v201, v77, v73, s38
    v_perm_b32 v202, v84, v80, s38
    v_perm_b32 v203, v85, v81, s38
    v_perm_b32 v204, v92, v88, s38
    v_perm_b32 v205, v93, v89, s38
    v_perm_b32 v206, v100, v96, s38
    v_perm_b32 v207, v101, v97, s38
    v_perm_b32 v208, v76, v72, s39
    v_perm_b32 v209, v77, v73, s39
    v_perm_b32 v210, v84, v80, s39
    v_perm_b32 v211, v85, v81, s39
    v_perm_b32 v212, v92, v88, s39
    v_perm_b32 v213, v93, v89, s39
    v_perm_b32 v214, v100, v96, s39
    v_perm_b32 v215, v101, v97, s39
    v_perm_b32 v216, v78, v74, s38
    v_perm_b32 v217, v79, v75, s38
    v_perm_b32 v218, v86, v82, s38
    v_perm_b32 v219, v87, v83, s38
    v_perm_b32 v220, v94, v90, s38
    v_perm_b32 v221, v95, v91, s38
    v_perm_b32 v222, v102, v98, s38
    v_perm_b32 v223, v103, v99, s38
    v_perm_b32 v32, v78, v74, s39
    v_perm_b32 v33, v79, v75, s39
    v_perm_b32 v34, v86, v82, s39
    v_perm_b32 v35, v87, v83, s39
    v_perm_b32 v36, v94, v90, s39
    v_perm_b32 v37, v95, v91, s39
    v_perm_b32 v38, v102, v98, s39
    v_perm_b32 v39, v103, v99, s39
    ds_write_b128 v142, v[32:35] offset:6144
    ds_write_b128 v142, v[36:39] offset:7168
    s_waitcnt vmcnt(36)
    s_waitcnt lgkmcnt(0)
    v_perm_b32 v224, v108, v104, s38
    v_perm_b32 v225, v109, v105, s38
    v_perm_b32 v226, v116, v112, s38
    v_perm_b32 v227, v117, v113, s38
    v_perm_b32 v228, v124, v120, s38
    v_perm_b32 v229, v125, v121, s38
    v_perm_b32 v230, v132, v128, s38
    v_perm_b32 v231, v133, v129, s38
    v_perm_b32 v232, v108, v104, s39
    v_perm_b32 v233, v109, v105, s39
    v_perm_b32 v234, v116, v112, s39
    v_perm_b32 v235, v117, v113, s39
    v_perm_b32 v236, v124, v120, s39
    v_perm_b32 v237, v125, v121, s39
    v_perm_b32 v238, v132, v128, s39
    v_perm_b32 v239, v133, v129, s39
    v_perm_b32 v24, v110, v106, s38
    v_perm_b32 v25, v111, v107, s38
    v_perm_b32 v26, v118, v114, s38
    v_perm_b32 v27, v119, v115, s38
    v_perm_b32 v28, v126, v122, s38
    v_perm_b32 v29, v127, v123, s38
    v_perm_b32 v30, v134, v130, s38
    v_perm_b32 v31, v135, v131, s38
    ds_write_b128 v142, v[24:27] offset:8192
    ds_write_b128 v142, v[28:31] offset:9216
    v_perm_b32 v32, v110, v106, s39
    v_perm_b32 v33, v111, v107, s39
    v_perm_b32 v34, v118, v114, s39
    v_perm_b32 v35, v119, v115, s39
    v_perm_b32 v36, v126, v122, s39
    v_perm_b32 v37, v127, v123, s39
    v_perm_b32 v38, v134, v130, s39
    v_perm_b32 v39, v135, v131, s39
    ds_write_b128 v142, v[32:35] offset:10240
    ds_write_b128 v142, v[36:39] offset:11264
    s_waitcnt lgkmcnt(0)
    s_waitcnt vmcnt(28)
    s_barrier
    s_add_u32 s74, s18, 0
    s_and_b32 s74, s74, 3
    s_lshl_b32 s74, s74, 13
    s_add_u32 s74, s74, 0
    v_add_u32 v140, s74, v10
    ds_read2st64_b32 v[24:25], v140 offset0:0 offset1:1
    ds_read2st64_b32 v[26:27], v140 offset0:2 offset1:3
    ds_read2st64_b32 v[28:29], v140 offset0:4 offset1:5
    ds_read2st64_b32 v[30:31], v140 offset0:6 offset1:7
    s_add_u32 s74, s18, 1
    s_and_b32 s74, s74, 3
    s_lshl_b32 s74, s74, 13
    s_add_u32 s74, s74, 0
    v_add_u32 v140, s74, v10
    ds_read2st64_b32 v[32:33], v140 offset0:0 offset1:1
    ds_read2st64_b32 v[34:35], v140 offset0:2 offset1:3
    ds_read2st64_b32 v[36:37], v140 offset0:4 offset1:5
    ds_read2st64_b32 v[38:39], v140 offset0:6 offset1:7
    s_add_u32 s74, s18, 2
    s_and_b32 s74, s74, 3
    s_lshl_b32 s74, s74, 13
    s_add_u32 s74, s74, 0
    v_add_u32 v140, s74, v10
    ds_read2st64_b32 v[40:41], v140 offset0:0 offset1:1
    ds_read2st64_b32 v[42:43], v140 offset0:2 offset1:3
    ds_read2st64_b32 v[44:45], v140 offset0:4 offset1:5
    ds_read2st64_b32 v[46:47], v140 offset0:6 offset1:7
    s_add_u32 s74, s18, 3
    s_and_b32 s74, s74, 3
    s_lshl_b32 s74, s74, 13
    s_add_u32 s74, s74, 0
    v_add_u32 v140, s74, v10
    ds_read2st64_b32 v[48:49], v140 offset0:0 offset1:1
    ds_read2st64_b32 v[50:51], v140 offset0:2 offset1:3
    ds_read2st64_b32 v[52:53], v140 offset0:4 offset1:5
    ds_read2st64_b32 v[54:55], v140 offset0:6 offset1:7
    s_waitcnt lgkmcnt(0)
    s_barrier
    s_lshl_b32 s74, s18, 20
    s_lshl_b32 s75, s18, 13
    s_add_u32 s76, s74, 557056
    s_add_u32 m0, s75, 0
    s_nop 0
    buffer_load_dwordx4 v143, s[48:51], s76 offen  lds
    s_add_u32 s76, s74, 622592
    s_add_u32 m0, s75, 1024
    s_nop 0
    buffer_load_dwordx4 v143, s[48:51], s76 offen  lds
    s_add_u32 s76, s74, 688128
    s_add_u32 m0, s75, 2048
    s_nop 0
    buffer_load_dwordx4 v143, s[48:51], s76 offen  lds
    s_add_u32 s76, s74, 753664
    s_add_u32 m0, s75, 3072
    s_nop 0
    buffer_load_dwordx4 v143, s[48:51], s76 offen  lds
    s_add_u32 s76, s74, 819200
    s_add_u32 m0, s75, 4096
    s_nop 0
    buffer_load_dwordx4 v143, s[48:51], s76 offen  lds
    s_add_u32 s76, s74, 884736
    s_add_u32 m0, s75, 5120
    s_nop 0
    buffer_load_dwordx4 v143, s[48:51], s76 offen  lds
    s_add_u32 s76, s74, 950272
    s_add_u32 m0, s75, 6144
    s_nop 0
    buffer_load_dwordx4 v143, s[48:51], s76 offen  lds
    s_add_u32 s76, s74, 1015808
    s_add_u32 m0, s75, 7168
    s_nop 0
    buffer_load_dwordx4 v143, s[48:51], s76 offen  lds
    v_perm_b32 v16, v25, v24, s38
    v_perm_b32 v17, v27, v26, s38
    v_perm_b32 v18, v29, v28, s38
    v_perm_b32 v19, v31, v30, s38
    v_accvgpr_write_b32 a152, v16
    v_accvgpr_write_b32 a153, v17
    v_accvgpr_write_b32 a154, v18
    v_accvgpr_write_b32 a155, v19
    v_perm_b32 v20, v25, v24, s39
    v_perm_b32 v21, v27, v26, s39
    v_perm_b32 v22, v29, v28, s39
    v_perm_b32 v23, v31, v30, s39
    v_accvgpr_write_b32 a160, v20
    v_accvgpr_write_b32 a161, v21
    v_accvgpr_write_b32 a162, v22
    v_accvgpr_write_b32 a163, v23
    v_perm_b32 v16, v33, v32, s38
    v_perm_b32 v17, v35, v34, s38
    v_perm_b32 v18, v37, v36, s38
    v_perm_b32 v19, v39, v38, s38
    v_accvgpr_write_b32 a184, v16
    v_accvgpr_write_b32 a185, v17
    v_accvgpr_write_b32 a186, v18
    v_accvgpr_write_b32 a187, v19
    v_perm_b32 v20, v33, v32, s39
    v_perm_b32 v21, v35, v34, s39
    v_perm_b32 v22, v37, v36, s39
    v_perm_b32 v23, v39, v38, s39
    v_accvgpr_write_b32 a192, v20
    v_accvgpr_write_b32 a193, v21
    v_accvgpr_write_b32 a194, v22
    v_accvgpr_write_b32 a195, v23
    v_perm_b32 v16, v41, v40, s38
    v_perm_b32 v17, v43, v42, s38
    v_perm_b32 v18, v45, v44, s38
    v_perm_b32 v19, v47, v46, s38
    v_accvgpr_write_b32 a216, v16
    v_accvgpr_write_b32 a217, v17
    v_accvgpr_write_b32 a218, v18
    v_accvgpr_write_b32 a219, v19
    v_perm_b32 v20, v41, v40, s39
    v_perm_b32 v21, v43, v42, s39
    v_perm_b32 v22, v45, v44, s39
    v_perm_b32 v23, v47, v46, s39
    v_accvgpr_write_b32 a224, v20
    v_accvgpr_write_b32 a225, v21
    v_accvgpr_write_b32 a226, v22
    v_accvgpr_write_b32 a227, v23
    v_perm_b32 v16, v49, v48, s38
    v_perm_b32 v17, v51, v50, s38
    v_perm_b32 v18, v53, v52, s38
    v_perm_b32 v19, v55, v54, s38
    v_accvgpr_write_b32 a248, v16
    v_accvgpr_write_b32 a249, v17
    v_accvgpr_write_b32 a250, v18
    v_accvgpr_write_b32 a251, v19
    v_perm_b32 v144, v49, v48, s39
    v_perm_b32 v145, v51, v50, s39
    v_perm_b32 v146, v53, v52, s39
    v_perm_b32 v147, v55, v54, s39
    s_waitcnt vmcnt(28)
    s_barrier
    s_add_u32 s74, s18, 0
    s_and_b32 s74, s74, 3
    s_lshl_b32 s74, s74, 13
    s_add_u32 s74, s74, 32768
    v_add_u32 v140, s74, v10
    ds_read2st64_b32 v[24:25], v140 offset0:0 offset1:1
    ds_read2st64_b32 v[26:27], v140 offset0:2 offset1:3
    ds_read2st64_b32 v[28:29], v140 offset0:4 offset1:5
    ds_read2st64_b32 v[30:31], v140 offset0:6 offset1:7
    s_add_u32 s74, s18, 1
    s_and_b32 s74, s74, 3
    s_lshl_b32 s74, s74, 13
    s_add_u32 s74, s74, 32768
    v_add_u32 v140, s74, v10
    ds_read2st64_b32 v[32:33], v140 offset0:0 offset1:1
    ds_read2st64_b32 v[34:35], v140 offset0:2 offset1:3
    ds_read2st64_b32 v[36:37], v140 offset0:4 offset1:5
    ds_read2st64_b32 v[38:39], v140 offset0:6 offset1:7
    s_add_u32 s74, s18, 2
    s_and_b32 s74, s74, 3
    s_lshl_b32 s74, s74, 13
    s_add_u32 s74, s74, 32768
    v_add_u32 v140, s74, v10
    ds_read2st64_b32 v[40:41], v140 offset0:0 offset1:1
    ds_read2st64_b32 v[42:43], v140 offset0:2 offset1:3
    ds_read2st64_b32 v[44:45], v140 offset0:4 offset1:5
    ds_read2st64_b32 v[46:47], v140 offset0:6 offset1:7
    s_add_u32 s74, s18, 3
    s_and_b32 s74, s74, 3
    s_lshl_b32 s74, s74, 13
    s_add_u32 s74, s74, 32768
    v_add_u32 v140, s74, v10
    ds_read2st64_b32 v[48:49], v140 offset0:0 offset1:1
    ds_read2st64_b32 v[50:51], v140 offset0:2 offset1:3
    ds_read2st64_b32 v[52:53], v140 offset0:4 offset1:5
    ds_read2st64_b32 v[54:55], v140 offset0:6 offset1:7
    s_waitcnt lgkmcnt(0)
    s_barrier
    s_lshl_b32 s74, s18, 20
    s_lshl_b32 s75, s18, 13
    s_add_u32 s76, s74, 0
    s_add_u32 m0, s75, 32768
    s_nop 0
    buffer_load_dwordx4 v143, s[44:47], s76 offen  lds
    s_add_u32 s76, s74, 65536
    s_add_u32 m0, s75, 33792
    s_nop 0
    buffer_load_dwordx4 v143, s[44:47], s76 offen  lds
    s_add_u32 s76, s74, 131072
    s_add_u32 m0, s75, 34816
    s_nop 0
    buffer_load_dwordx4 v143, s[44:47], s76 offen  lds
    s_add_u32 s76, s74, 196608
    s_add_u32 m0, s75, 35840
    s_nop 0
    buffer_load_dwordx4 v143, s[44:47], s76 offen  lds
    s_add_u32 s76, s74, 262144
    s_add_u32 m0, s75, 36864
    s_nop 0
    buffer_load_dwordx4 v143, s[44:47], s76 offen  lds
    s_add_u32 s76, s74, 327680
    s_add_u32 m0, s75, 37888
    s_nop 0
    buffer_load_dwordx4 v143, s[44:47], s76 offen  lds
    s_add_u32 s76, s74, 393216
    s_add_u32 m0, s75, 38912
    s_nop 0
    buffer_load_dwordx4 v143, s[44:47], s76 offen  lds
    s_add_u32 s76, s74, 458752
    s_add_u32 m0, s75, 39936
    s_nop 0
    buffer_load_dwordx4 v143, s[44:47], s76 offen  lds
    v_perm_b32 v16, v25, v24, s38
    v_perm_b32 v17, v27, v26, s38
    v_perm_b32 v18, v29, v28, s38
    v_perm_b32 v19, v31, v30, s38
    v_accvgpr_write_b32 a156, v16
    v_accvgpr_write_b32 a157, v17
    v_accvgpr_write_b32 a158, v18
    v_accvgpr_write_b32 a159, v19
    v_perm_b32 v20, v25, v24, s39
    v_perm_b32 v21, v27, v26, s39
    v_perm_b32 v22, v29, v28, s39
    v_perm_b32 v23, v31, v30, s39
    v_accvgpr_write_b32 a164, v20
    v_accvgpr_write_b32 a165, v21
    v_accvgpr_write_b32 a166, v22
    v_accvgpr_write_b32 a167, v23
    v_perm_b32 v16, v33, v32, s38
    v_perm_b32 v17, v35, v34, s38
    v_perm_b32 v18, v37, v36, s38
    v_perm_b32 v19, v39, v38, s38
    v_accvgpr_write_b32 a188, v16
    v_accvgpr_write_b32 a189, v17
    v_accvgpr_write_b32 a190, v18
    v_accvgpr_write_b32 a191, v19
    v_perm_b32 v20, v33, v32, s39
    v_perm_b32 v21, v35, v34, s39
    v_perm_b32 v22, v37, v36, s39
    v_perm_b32 v23, v39, v38, s39
    v_accvgpr_write_b32 a196, v20
    v_accvgpr_write_b32 a197, v21
    v_accvgpr_write_b32 a198, v22
    v_accvgpr_write_b32 a199, v23
    v_perm_b32 v16, v41, v40, s38
    v_perm_b32 v17, v43, v42, s38
    v_perm_b32 v18, v45, v44, s38
    v_perm_b32 v19, v47, v46, s38
    v_accvgpr_write_b32 a220, v16
    v_accvgpr_write_b32 a221, v17
    v_accvgpr_write_b32 a222, v18
    v_accvgpr_write_b32 a223, v19
    v_perm_b32 v20, v41, v40, s39
    v_perm_b32 v21, v43, v42, s39
    v_perm_b32 v22, v45, v44, s39
    v_perm_b32 v23, v47, v46, s39
    v_accvgpr_write_b32 a228, v20
    v_accvgpr_write_b32 a229, v21
    v_accvgpr_write_b32 a230, v22
    v_accvgpr_write_b32 a231, v23
    v_perm_b32 v16, v49, v48, s38
    v_perm_b32 v17, v51, v50, s38
    v_perm_b32 v18, v53, v52, s38
    v_perm_b32 v19, v55, v54, s38
    v_accvgpr_write_b32 a252, v16
    v_accvgpr_write_b32 a253, v17
    v_accvgpr_write_b32 a254, v18
    v_accvgpr_write_b32 a255, v19
    v_perm_b32 v148, v49, v48, s39
    v_perm_b32 v149, v51, v50, s39
    v_perm_b32 v150, v53, v52, s39
    v_perm_b32 v151, v55, v54, s39
    s_waitcnt vmcnt(28)
    s_barrier
    s_add_u32 s74, s18, 0
    s_and_b32 s74, s74, 3
    s_lshl_b32 s74, s74, 13
    s_add_u32 s74, s74, 65536
    v_add_u32 v140, s74, v10
    ds_read2st64_b32 v[24:25], v140 offset0:0 offset1:1
    ds_read2st64_b32 v[26:27], v140 offset0:2 offset1:3
    ds_read2st64_b32 v[28:29], v140 offset0:4 offset1:5
    ds_read2st64_b32 v[30:31], v140 offset0:6 offset1:7
    s_add_u32 s74, s18, 1
    s_and_b32 s74, s74, 3
    s_lshl_b32 s74, s74, 13
    s_add_u32 s74, s74, 65536
    v_add_u32 v140, s74, v10
    ds_read2st64_b32 v[32:33], v140 offset0:0 offset1:1
    ds_read2st64_b32 v[34:35], v140 offset0:2 offset1:3
    ds_read2st64_b32 v[36:37], v140 offset0:4 offset1:5
    ds_read2st64_b32 v[38:39], v140 offset0:6 offset1:7
    s_add_u32 s74, s18, 2
    s_and_b32 s74, s74, 3
    s_lshl_b32 s74, s74, 13
    s_add_u32 s74, s74, 65536
    v_add_u32 v140, s74, v10
    ds_read2st64_b32 v[40:41], v140 offset0:0 offset1:1
    ds_read2st64_b32 v[42:43], v140 offset0:2 offset1:3
    ds_read2st64_b32 v[44:45], v140 offset0:4 offset1:5
    ds_read2st64_b32 v[46:47], v140 offset0:6 offset1:7
    s_add_u32 s74, s18, 3
    s_and_b32 s74, s74, 3
    s_lshl_b32 s74, s74, 13
    s_add_u32 s74, s74, 65536
    v_add_u32 v140, s74, v10
    ds_read2st64_b32 v[48:49], v140 offset0:0 offset1:1
    ds_read2st64_b32 v[50:51], v140 offset0:2 offset1:3
    ds_read2st64_b32 v[52:53], v140 offset0:4 offset1:5
    ds_read2st64_b32 v[54:55], v140 offset0:6 offset1:7
    s_waitcnt lgkmcnt(0)
    s_barrier
    s_lshl_b32 s74, s18, 20
    s_lshl_b32 s75, s18, 13
    s_add_u32 s76, s74, 524288
    s_add_u32 m0, s75, 65536
    s_nop 0
    buffer_load_dwordx4 v143, s[44:47], s76 offen  lds
    s_add_u32 s76, s74, 589824
    s_add_u32 m0, s75, 66560
    s_nop 0
    buffer_load_dwordx4 v143, s[44:47], s76 offen  lds
    s_add_u32 s76, s74, 655360
    s_add_u32 m0, s75, 67584
    s_nop 0
    buffer_load_dwordx4 v143, s[44:47], s76 offen  lds
    s_add_u32 s76, s74, 720896
    s_add_u32 m0, s75, 68608
    s_nop 0
    buffer_load_dwordx4 v143, s[44:47], s76 offen  lds
    s_add_u32 s76, s74, 786432
    s_add_u32 m0, s75, 69632
    s_nop 0
    buffer_load_dwordx4 v143, s[44:47], s76 offen  lds
    s_add_u32 s76, s74, 851968
    s_add_u32 m0, s75, 70656
    s_nop 0
    buffer_load_dwordx4 v143, s[44:47], s76 offen  lds
    s_add_u32 s76, s74, 917504
    s_add_u32 m0, s75, 71680
    s_nop 0
    buffer_load_dwordx4 v143, s[44:47], s76 offen  lds
    s_add_u32 s76, s74, 983040
    s_add_u32 m0, s75, 72704
    s_nop 0
    buffer_load_dwordx4 v143, s[44:47], s76 offen  lds
    v_perm_b32 v16, v25, v24, s38
    v_perm_b32 v17, v27, v26, s38
    v_perm_b32 v18, v29, v28, s38
    v_perm_b32 v19, v31, v30, s38
    v_accvgpr_write_b32 a168, v16
    v_accvgpr_write_b32 a169, v17
    v_accvgpr_write_b32 a170, v18
    v_accvgpr_write_b32 a171, v19
    v_perm_b32 v20, v25, v24, s39
    v_perm_b32 v21, v27, v26, s39
    v_perm_b32 v22, v29, v28, s39
    v_perm_b32 v23, v31, v30, s39
    v_accvgpr_write_b32 a176, v20
    v_accvgpr_write_b32 a177, v21
    v_accvgpr_write_b32 a178, v22
    v_accvgpr_write_b32 a179, v23
    v_perm_b32 v16, v33, v32, s38
    v_perm_b32 v17, v35, v34, s38
    v_perm_b32 v18, v37, v36, s38
    v_perm_b32 v19, v39, v38, s38
    v_accvgpr_write_b32 a200, v16
    v_accvgpr_write_b32 a201, v17
    v_accvgpr_write_b32 a202, v18
    v_accvgpr_write_b32 a203, v19
    v_perm_b32 v20, v33, v32, s39
    v_perm_b32 v21, v35, v34, s39
    v_perm_b32 v22, v37, v36, s39
    v_perm_b32 v23, v39, v38, s39
    v_accvgpr_write_b32 a208, v20
    v_accvgpr_write_b32 a209, v21
    v_accvgpr_write_b32 a210, v22
    v_accvgpr_write_b32 a211, v23
    v_perm_b32 v16, v41, v40, s38
    v_perm_b32 v17, v43, v42, s38
    v_perm_b32 v18, v45, v44, s38
    v_perm_b32 v19, v47, v46, s38
    v_accvgpr_write_b32 a232, v16
    v_accvgpr_write_b32 a233, v17
    v_accvgpr_write_b32 a234, v18
    v_accvgpr_write_b32 a235, v19
    v_perm_b32 v20, v41, v40, s39
    v_perm_b32 v21, v43, v42, s39
    v_perm_b32 v22, v45, v44, s39
    v_perm_b32 v23, v47, v46, s39
    v_accvgpr_write_b32 a240, v20
    v_accvgpr_write_b32 a241, v21
    v_accvgpr_write_b32 a242, v22
    v_accvgpr_write_b32 a243, v23
    v_perm_b32 v152, v49, v48, s38
    v_perm_b32 v153, v51, v50, s38
    v_perm_b32 v154, v53, v52, s38
    v_perm_b32 v155, v55, v54, s38
    v_perm_b32 v160, v49, v48, s39
    v_perm_b32 v161, v51, v50, s39
    v_perm_b32 v162, v53, v52, s39
    v_perm_b32 v163, v55, v54, s39
    s_waitcnt vmcnt(16)
    s_barrier
    s_cmp_eq_u32 s18, 0
    s_cbranch_scc0 L_rec_na
    v_mov_b32 v138, 0
    v_mov_b32 v136, 1
    s_mov_b64 exec, 1
    global_atomic_add v138, v136, s[16:17] offset:132
    s_mov_b64 exec, -1
L_rec_na:
    s_add_u32 s74, s18, 0
    s_and_b32 s74, s74, 3
    s_lshl_b32 s74, s74, 13
    s_add_u32 s74, s74, 0
    v_add_u32 v140, s74, v10
    ds_read2st64_b32 v[24:25], v140 offset0:0 offset1:1
    ds_read2st64_b32 v[26:27], v140 offset0:2 offset1:3
    ds_read2st64_b32 v[28:29], v140 offset0:4 offset1:5
    ds_read2st64_b32 v[30:31], v140 offset0:6 offset1:7
    s_add_u32 s74, s18, 1
    s_and_b32 s74, s74, 3
    s_lshl_b32 s74, s74, 13
    s_add_u32 s74, s74, 0
    v_add_u32 v140, s74, v10
    ds_read2st64_b32 v[32:33], v140 offset0:0 offset1:1
    ds_read2st64_b32 v[34:35], v140 offset0:2 offset1:3
    ds_read2st64_b32 v[36:37], v140 offset0:4 offset1:5
    ds_read2st64_b32 v[38:39], v140 offset0:6 offset1:7
    s_add_u32 s74, s18, 2
    s_and_b32 s74, s74, 3
    s_lshl_b32 s74, s74, 13
    s_add_u32 s74, s74, 0
    v_add_u32 v140, s74, v10
    ds_read2st64_b32 v[40:41], v140 offset0:0 offset1:1
    ds_read2st64_b32 v[42:43], v140 offset0:2 offset1:3
    ds_read2st64_b32 v[44:45], v140 offset0:4 offset1:5
    ds_read2st64_b32 v[46:47], v140 offset0:6 offset1:7
    s_add_u32 s74, s18, 3
    s_and_b32 s74, s74, 3
    s_lshl_b32 s74, s74, 13
    s_add_u32 s74, s74, 0
    v_add_u32 v140, s74, v10
    ds_read2st64_b32 v[48:49], v140 offset0:0 offset1:1
    ds_read2st64_b32 v[50:51], v140 offset0:2 offset1:3
    ds_read2st64_b32 v[52:53], v140 offset0:4 offset1:5
    ds_read2st64_b32 v[54:55], v140 offset0:6 offset1:7
    s_waitcnt lgkmcnt(0)
    s_barrier
    s_lshl_b32 s74, s18, 20
    s_lshl_b32 s75, s18, 13
    s_add_u32 s76, s74, 32768
    s_add_u32 m0, s75, 0
    s_nop 0
    buffer_load_dwordx4 v143, s[44:47], s76 offen  lds
    s_add_u32 s76, s74, 98304
    s_add_u32 m0, s75, 1024
    s_nop 0
    buffer_load_dwordx4 v143, s[44:47], s76 offen  lds
    s_add_u32 s76, s74, 163840
    s_add_u32 m0, s75, 2048
    s_nop 0
    buffer_load_dwordx4 v143, s[44:47], s76 offen  lds
    s_add_u32 s76, s74, 229376
    s_add_u32 m0, s75, 3072
    s_nop 0
    buffer_load_dwordx4 v143, s[44:47], s76 offen  lds
    s_add_u32 s76, s74, 294912
    s_add_u32 m0, s75, 4096
    s_nop 0
    buffer_load_dwordx4 v143, s[44:47], s76 offen  lds
    s_add_u32 s76, s74, 360448
    s_add_u32 m0, s75, 5120
    s_nop 0
    buffer_load_dwordx4 v143, s[44:47], s76 offen  lds
    s_add_u32 s76, s74, 425984
    s_add_u32 m0, s75, 6144
    s_nop 0
    buffer_load_dwordx4 v143, s[44:47], s76 offen  lds
    s_add_u32 s76, s74, 491520
    s_add_u32 m0, s75, 7168
    s_nop 0
    buffer_load_dwordx4 v143, s[44:47], s76 offen  lds
    v_perm_b32 v16, v25, v24, s38
    v_perm_b32 v17, v27, v26, s38
    v_perm_b32 v18, v29, v28, s38
    v_perm_b32 v19, v31, v30, s38
    v_accvgpr_write_b32 a172, v16
    v_accvgpr_write_b32 a173, v17
    v_accvgpr_write_b32 a174, v18
    v_accvgpr_write_b32 a175, v19
    v_perm_b32 v20, v25, v24, s39
    v_perm_b32 v21, v27, v26, s39
    v_perm_b32 v22, v29, v28, s39
    v_perm_b32 v23, v31, v30, s39
    v_accvgpr_write_b32 a180, v20
    v_accvgpr_write_b32 a181, v21
    v_accvgpr_write_b32 a182, v22
    v_accvgpr_write_b32 a183, v23
    v_perm_b32 v16, v33, v32, s38
    v_perm_b32 v17, v35, v34, s38
    v_perm_b32 v18, v37, v36, s38
    v_perm_b32 v19, v39, v38, s38
    v_accvgpr_write_b32 a204, v16
    v_accvgpr_write_b32 a205, v17
    v_accvgpr_write_b32 a206, v18
    v_accvgpr_write_b32 a207, v19
    v_perm_b32 v20, v33, v32, s39
    v_perm_b32 v21, v35, v34, s39
    v_perm_b32 v22, v37, v36, s39
    v_perm_b32 v23, v39, v38, s39
    v_accvgpr_write_b32 a212, v20
    v_accvgpr_write_b32 a213, v21
    v_accvgpr_write_b32 a214, v22
    v_accvgpr_write_b32 a215, v23
    v_perm_b32 v16, v41, v40, s38
    v_perm_b32 v17, v43, v42, s38
    v_perm_b32 v18, v45, v44, s38
    v_perm_b32 v19, v47, v46, s38
    v_accvgpr_write_b32 a236, v16
    v_accvgpr_write_b32 a237, v17
    v_accvgpr_write_b32 a238, v18
    v_accvgpr_write_b32 a239, v19
    v_perm_b32 v20, v41, v40, s39
    v_perm_b32 v21, v43, v42, s39
    v_perm_b32 v22, v45, v44, s39
    v_perm_b32 v23, v47, v46, s39
    v_accvgpr_write_b32 a244, v20
    v_accvgpr_write_b32 a245, v21
    v_accvgpr_write_b32 a246, v22
    v_accvgpr_write_b32 a247, v23
    v_perm_b32 v156, v49, v48, s38
    v_perm_b32 v157, v51, v50, s38
    v_perm_b32 v158, v53, v52, s38
    v_perm_b32 v159, v55, v54, s38
    v_perm_b32 v164, v49, v48, s39
    v_perm_b32 v165, v51, v50, s39
    v_perm_b32 v166, v53, v52, s39
    v_perm_b32 v167, v55, v54, s39
    s_waitcnt vmcnt(16)
    s_barrier
    s_add_u32 s74, s18, 0
    s_and_b32 s74, s74, 3
    s_lshl_b32 s74, s74, 13
    s_add_u32 s74, s74, 32768
    v_add_u32 v140, s74, v12
    ds_read2st64_b32 v[24:25], v140 offset0:0 offset1:1
    ds_read2st64_b32 v[26:27], v140 offset0:2 offset1:3
    ds_read2st64_b32 v[28:29], v140 offset0:4 offset1:5
    ds_read2st64_b32 v[30:31], v140 offset0:6 offset1:7
    s_add_u32 s74, s18, 1
    s_and_b32 s74, s74, 3
    s_lshl_b32 s74, s74, 13
    s_add_u32 s74, s74, 32768
    v_add_u32 v140, s74, v12
    ds_read2st64_b32 v[32:33], v140 offset0:0 offset1:1
    ds_read2st64_b32 v[34:35], v140 offset0:2 offset1:3
    ds_read2st64_b32 v[36:37], v140 offset0:4 offset1:5
    ds_read2st64_b32 v[38:39], v140 offset0:6 offset1:7
    s_add_u32 s74, s18, 2
    s_and_b32 s74, s74, 3
    s_lshl_b32 s74, s74, 13
    s_add_u32 s74, s74, 32768
    v_add_u32 v140, s74, v12
    ds_read2st64_b32 v[40:41], v140 offset0:0 offset1:1
    ds_read2st64_b32 v[42:43], v140 offset0:2 offset1:3
    ds_read2st64_b32 v[44:45], v140 offset0:4 offset1:5
    ds_read2st64_b32 v[46:47], v140 offset0:6 offset1:7
    s_add_u32 s74, s18, 3
    s_and_b32 s74, s74, 3
    s_lshl_b32 s74, s74, 13
    s_add_u32 s74, s74, 32768
    v_add_u32 v140, s74, v12
    ds_read2st64_b32 v[48:49], v140 offset0:0 offset1:1
    ds_read2st64_b32 v[50:51], v140 offset0:2 offset1:3
    ds_read2st64_b32 v[52:53], v140 offset0:4 offset1:5
    ds_read2st64_b32 v[54:55], v140 offset0:6 offset1:7
    s_waitcnt lgkmcnt(0)
    s_barrier
    s_lshl_b32 s74, s18, 20
    s_lshl_b32 s75, s18, 13
    s_add_u32 s76, s74, 557056
    s_add_u32 m0, s75, 32768
    s_nop 0
    buffer_load_dwordx4 v143, s[44:47], s76 offen  lds
    s_add_u32 s76, s74, 622592
    s_add_u32 m0, s75, 33792
    s_nop 0
    buffer_load_dwordx4 v143, s[44:47], s76 offen  lds
    s_add_u32 s76, s74, 688128
    s_add_u32 m0, s75, 34816
    s_nop 0
    buffer_load_dwordx4 v143, s[44:47], s76 offen  lds
    s_add_u32 s76, s74, 753664
    s_add_u32 m0, s75, 35840
    s_nop 0
    buffer_load_dwordx4 v143, s[44:47], s76 offen  lds
    s_add_u32 s76, s74, 819200
    s_add_u32 m0, s75, 36864
    s_nop 0
    buffer_load_dwordx4 v143, s[44:47], s76 offen  lds
    s_add_u32 s76, s74, 884736
    s_add_u32 m0, s75, 37888
    s_nop 0
    buffer_load_dwordx4 v143, s[44:47], s76 offen  lds
    s_add_u32 s76, s74, 950272
    s_add_u32 m0, s75, 38912
    s_nop 0
    buffer_load_dwordx4 v143, s[44:47], s76 offen  lds
    s_add_u32 s76, s74, 1015808
    s_add_u32 m0, s75, 39936
    s_nop 0
    buffer_load_dwordx4 v143, s[44:47], s76 offen  lds
    v_perm_b32 v80, v25, v24, s38
    v_perm_b32 v81, v27, v26, s38
    v_perm_b32 v82, v29, v28, s38
    v_perm_b32 v83, v31, v30, s38
    v_perm_b32 v88, v25, v24, s39
    v_perm_b32 v89, v27, v26, s39
    v_perm_b32 v90, v29, v28, s39
    v_perm_b32 v91, v31, v30, s39
    v_perm_b32 v112, v33, v32, s38
    v_perm_b32 v113, v35, v34, s38
    v_perm_b32 v114, v37, v36, s38
    v_perm_b32 v115, v39, v38, s38
    v_perm_b32 v120, v33, v32, s39
    v_perm_b32 v121, v35, v34, s39
    v_perm_b32 v122, v37, v36, s39
    v_perm_b32 v123, v39, v38, s39
    v_perm_b32 v16, v41, v40, s38
    v_perm_b32 v17, v43, v42, s38
    v_perm_b32 v18, v45, v44, s38
    v_perm_b32 v19, v47, v46, s38
    ds_write_b128 v142, v[16:19] offset:2048
    v_perm_b32 v20, v41, v40, s39
    v_perm_b32 v21, v43, v42, s39
    v_perm_b32 v22, v45, v44, s39
    v_perm_b32 v23, v47, v46, s39
    ds_write_b128 v142, v[20:23] offset:4096
    v_perm_b32 v16, v49, v48, s38
    v_perm_b32 v17, v51, v50, s38
    v_perm_b32 v18, v53, v52, s38
    v_perm_b32 v19, v55, v54, s38
    v_accvgpr_write_b32 a120, v16
    v_accvgpr_write_b32 a121, v17
    v_accvgpr_write_b32 a122, v18
    v_accvgpr_write_b32 a123, v19
    v_perm_b32 v20, v49, v48, s39
    v_perm_b32 v21, v51, v50, s39
    v_perm_b32 v22, v53, v52, s39
    v_perm_b32 v23, v55, v54, s39
    v_accvgpr_write_b32 a128, v20
    v_accvgpr_write_b32 a129, v21
    v_accvgpr_write_b32 a130, v22
    v_accvgpr_write_b32 a131, v23
    s_waitcnt vmcnt(16)
    s_barrier
    s_add_u32 s74, s18, 0
    s_and_b32 s74, s74, 3
    s_lshl_b32 s74, s74, 13
    s_add_u32 s74, s74, 65536
    v_add_u32 v140, s74, v12
    ds_read2st64_b32 v[24:25], v140 offset0:0 offset1:1
    ds_read2st64_b32 v[26:27], v140 offset0:2 offset1:3
    ds_read2st64_b32 v[28:29], v140 offset0:4 offset1:5
    ds_read2st64_b32 v[30:31], v140 offset0:6 offset1:7
    s_add_u32 s74, s18, 1
    s_and_b32 s74, s74, 3
    s_lshl_b32 s74, s74, 13
    s_add_u32 s74, s74, 65536
    v_add_u32 v140, s74, v12
    ds_read2st64_b32 v[32:33], v140 offset0:0 offset1:1
    ds_read2st64_b32 v[34:35], v140 offset0:2 offset1:3
    ds_read2st64_b32 v[36:37], v140 offset0:4 offset1:5
    ds_read2st64_b32 v[38:39], v140 offset0:6 offset1:7
    s_add_u32 s74, s18, 2
    s_and_b32 s74, s74, 3
    s_lshl_b32 s74, s74, 13
    s_add_u32 s74, s74, 65536
    v_add_u32 v140, s74, v12
    ds_read2st64_b32 v[40:41], v140 offset0:0 offset1:1
    ds_read2st64_b32 v[42:43], v140 offset0:2 offset1:3
    ds_read2st64_b32 v[44:45], v140 offset0:4 offset1:5
    ds_read2st64_b32 v[46:47], v140 offset0:6 offset1:7
    s_add_u32 s74, s18, 3
    s_and_b32 s74, s74, 3
    s_lshl_b32 s74, s74, 13
    s_add_u32 s74, s74, 65536
    v_add_u32 v140, s74, v12
    ds_read2st64_b32 v[48:49], v140 offset0:0 offset1:1
    ds_read2st64_b32 v[50:51], v140 offset0:2 offset1:3
    ds_read2st64_b32 v[52:53], v140 offset0:4 offset1:5
    ds_read2st64_b32 v[54:55], v140 offset0:6 offset1:7
    s_waitcnt lgkmcnt(0)
    s_barrier
    s_lshl_b32 s74, s18, 20
    s_lshl_b32 s75, s18, 13
    s_add_u32 s76, s74, 0
    s_add_u32 m0, s75, 65536
    s_nop 0
    buffer_load_dwordx4 v143, s[12:15], s76 offen  lds
    s_add_u32 s76, s74, 65536
    s_add_u32 m0, s75, 66560
    s_nop 0
    buffer_load_dwordx4 v143, s[12:15], s76 offen  lds
    s_add_u32 s76, s74, 131072
    s_add_u32 m0, s75, 67584
    s_nop 0
    buffer_load_dwordx4 v143, s[12:15], s76 offen  lds
    s_add_u32 s76, s74, 196608
    s_add_u32 m0, s75, 68608
    s_nop 0
    buffer_load_dwordx4 v143, s[12:15], s76 offen  lds
    s_add_u32 s76, s74, 262144
    s_add_u32 m0, s75, 69632
    s_nop 0
    buffer_load_dwordx4 v143, s[12:15], s76 offen  lds
    s_add_u32 s76, s74, 327680
    s_add_u32 m0, s75, 70656
    s_nop 0
    buffer_load_dwordx4 v143, s[12:15], s76 offen  lds
    s_add_u32 s76, s74, 393216
    s_add_u32 m0, s75, 71680
    s_nop 0
    buffer_load_dwordx4 v143, s[12:15], s76 offen  lds
    s_add_u32 s76, s74, 458752
    s_add_u32 m0, s75, 72704
    s_nop 0
    buffer_load_dwordx4 v143, s[12:15], s76 offen  lds
    v_perm_b32 v84, v25, v24, s38
    v_perm_b32 v85, v27, v26, s38
    v_perm_b32 v86, v29, v28, s38
    v_perm_b32 v87, v31, v30, s38
    v_perm_b32 v92, v25, v24, s39
    v_perm_b32 v93, v27, v26, s39
    v_perm_b32 v94, v29, v28, s39
    v_perm_b32 v95, v31, v30, s39
    v_perm_b32 v116, v33, v32, s38
    v_perm_b32 v117, v35, v34, s38
    v_perm_b32 v118, v37, v36, s38
    v_perm_b32 v119, v39, v38, s38
    v_perm_b32 v124, v33, v32, s39
    v_perm_b32 v125, v35, v34, s39
    v_perm_b32 v126, v37, v36, s39
    v_perm_b32 v127, v39, v38, s39
    v_perm_b32 v16, v41, v40, s38
    v_perm_b32 v17, v43, v42, s38
    v_perm_b32 v18, v45, v44, s38
    v_perm_b32 v19, v47, v46, s38
    ds_write_b128 v142, v[16:19] offset:3072
    v_perm_b32 v20, v41, v40, s39
    v_perm_b32 v21, v43, v42, s39
    v_perm_b32 v22, v45, v44, s39
    v_perm_b32 v23, v47, v46, s39
    ds_write_b128 v142, v[20:23] offset:5120
    v_perm_b32 v16, v49, v48, s38
    v_perm_b32 v17, v51, v50, s38
    v_perm_b32 v18, v53, v52, s38
    v_perm_b32 v19, v55, v54, s38
    v_accvgpr_write_b32 a124, v16
    v_accvgpr_write_b32 a125, v17
    v_accvgpr_write_b32 a126, v18
    v_accvgpr_write_b32 a127, v19
    v_perm_b32 v20, v49, v48, s39
    v_perm_b32 v21, v51, v50, s39
    v_perm_b32 v22, v53, v52, s39
    v_perm_b32 v23, v55, v54, s39
    v_accvgpr_write_b32 a132, v20
    v_accvgpr_write_b32 a133, v21
    v_accvgpr_write_b32 a134, v22
    v_accvgpr_write_b32 a135, v23
    s_waitcnt vmcnt(16)
    s_barrier
    s_add_u32 s74, s18, 0
    s_and_b32 s74, s74, 3
    s_lshl_b32 s74, s74, 13
    s_add_u32 s74, s74, 0
    v_add_u32 v140, s74, v12
    ds_read2st64_b32 v[24:25], v140 offset0:0 offset1:1
    ds_read2st64_b32 v[26:27], v140 offset0:2 offset1:3
    ds_read2st64_b32 v[28:29], v140 offset0:4 offset1:5
    ds_read2st64_b32 v[30:31], v140 offset0:6 offset1:7
    s_add_u32 s74, s18, 1
    s_and_b32 s74, s74, 3
    s_lshl_b32 s74, s74, 13
    s_add_u32 s74, s74, 0
    v_add_u32 v140, s74, v12
    ds_read2st64_b32 v[32:33], v140 offset0:0 offset1:1
    ds_read2st64_b32 v[34:35], v140 offset0:2 offset1:3
    ds_read2st64_b32 v[36:37], v140 offset0:4 offset1:5
    ds_read2st64_b32 v[38:39], v140 offset0:6 offset1:7
    s_add_u32 s74, s18, 2
    s_and_b32 s74, s74, 3
    s_lshl_b32 s74, s74, 13
    s_add_u32 s74, s74, 0
    v_add_u32 v140, s74, v12
    ds_read2st64_b32 v[40:41], v140 offset0:0 offset1:1
    ds_read2st64_b32 v[42:43], v140 offset0:2 offset1:3
    ds_read2st64_b32 v[44:45], v140 offset0:4 offset1:5
    ds_read2st64_b32 v[46:47], v140 offset0:6 offset1:7
    s_add_u32 s74, s18, 3
    s_and_b32 s74, s74, 3
    s_lshl_b32 s74, s74, 13
    s_add_u32 s74, s74, 0
    v_add_u32 v140, s74, v12
    ds_read2st64_b32 v[48:49], v140 offset0:0 offset1:1
    ds_read2st64_b32 v[50:51], v140 offset0:2 offset1:3
    ds_read2st64_b32 v[52:53], v140 offset0:4 offset1:5
    ds_read2st64_b32 v[54:55], v140 offset0:6 offset1:7
    s_waitcnt lgkmcnt(0)
    s_barrier
    s_lshl_b32 s74, s18, 20
    s_lshl_b32 s75, s18, 13
    s_add_u32 s76, s74, 524288
    s_add_u32 m0, s75, 0
    s_nop 0
    buffer_load_dwordx4 v143, s[12:15], s76 offen  lds
    s_add_u32 s76, s74, 589824
    s_add_u32 m0, s75, 1024
    s_nop 0
    buffer_load_dwordx4 v143, s[12:15], s76 offen  lds
    s_add_u32 s76, s74, 655360
    s_add_u32 m0, s75, 2048
    s_nop 0
    buffer_load_dwordx4 v143, s[12:15], s76 offen  lds
    s_add_u32 s76, s74, 720896
    s_add_u32 m0, s75, 3072
    s_nop 0
    buffer_load_dwordx4 v143, s[12:15], s76 offen  lds
    s_add_u32 s76, s74, 786432
    s_add_u32 m0, s75, 4096
    s_nop 0
    buffer_load_dwordx4 v143, s[12:15], s76 offen  lds
    s_add_u32 s76, s74, 851968
    s_add_u32 m0, s75, 5120
    s_nop 0
    buffer_load_dwordx4 v143, s[12:15], s76 offen  lds
    s_add_u32 s76, s74, 917504
    s_add_u32 m0, s75, 6144
    s_nop 0
    buffer_load_dwordx4 v143, s[12:15], s76 offen  lds
    s_add_u32 s76, s74, 983040
    s_add_u32 m0, s75, 7168
    s_nop 0
    buffer_load_dwordx4 v143, s[12:15], s76 offen  lds
    v_perm_b32 v96, v25, v24, s38
    v_perm_b32 v97, v27, v26, s38
    v_perm_b32 v98, v29, v28, s38
    v_perm_b32 v99, v31, v30, s38
    v_perm_b32 v20, v25, v24, s39
    v_perm_b32 v21, v27, v26, s39
    v_perm_b32 v22, v29, v28, s39
    v_perm_b32 v23, v31, v30, s39
    v_accvgpr_write_b32 a96, v20
    v_accvgpr_write_b32 a97, v21
    v_accvgpr_write_b32 a98, v22
    v_accvgpr_write_b32 a99, v23
    v_perm_b32 v128, v33, v32, s38
    v_perm_b32 v129, v35, v34, s38
    v_perm_b32 v130, v37, v36, s38
    v_perm_b32 v131, v39, v38, s38
    v_perm_b32 v20, v33, v32, s39
    v_perm_b32 v21, v35, v34, s39
    v_perm_b32 v22, v37, v36, s39
    v_perm_b32 v23, v39, v38, s39
    ds_write_b128 v142, v[20:23] offset:0
    v_perm_b32 v16, v41, v40, s38
    v_perm_b32 v17, v43, v42, s38
    v_perm_b32 v18, v45, v44, s38
    v_perm_b32 v19, v47, v46, s38
    v_accvgpr_write_b32 a104, v16
    v_accvgpr_write_b32 a105, v17
    v_accvgpr_write_b32 a106, v18
    v_accvgpr_write_b32 a107, v19
    v_perm_b32 v20, v41, v40, s39
    v_perm_b32 v21, v43, v42, s39
    v_perm_b32 v22, v45, v44, s39
    v_perm_b32 v23, v47, v46, s39
    v_accvgpr_write_b32 a112, v20
    v_accvgpr_write_b32 a113, v21
    v_accvgpr_write_b32 a114, v22
    v_accvgpr_write_b32 a115, v23
    v_perm_b32 v16, v49, v48, s38
    v_perm_b32 v17, v51, v50, s38
    v_perm_b32 v18, v53, v52, s38
    v_perm_b32 v19, v55, v54, s38
    v_accvgpr_write_b32 a136, v16
    v_accvgpr_write_b32 a137, v17
    v_accvgpr_write_b32 a138, v18
    v_accvgpr_write_b32 a139, v19
    v_perm_b32 v20, v49, v48, s39
    v_perm_b32 v21, v51, v50, s39
    v_perm_b32 v22, v53, v52, s39
    v_perm_b32 v23, v55, v54, s39
    v_accvgpr_write_b32 a144, v20
    v_accvgpr_write_b32 a145, v21
    v_accvgpr_write_b32 a146, v22
    v_accvgpr_write_b32 a147, v23
    s_waitcnt vmcnt(16)
    s_barrier
    s_add_u32 s74, s18, 0
    s_and_b32 s74, s74, 3
    s_lshl_b32 s74, s74, 13
    s_add_u32 s74, s74, 32768
    v_add_u32 v140, s74, v12
    ds_read2st64_b32 v[24:25], v140 offset0:0 offset1:1
    ds_read2st64_b32 v[26:27], v140 offset0:2 offset1:3
    ds_read2st64_b32 v[28:29], v140 offset0:4 offset1:5
    ds_read2st64_b32 v[30:31], v140 offset0:6 offset1:7
    s_add_u32 s74, s18, 1
    s_and_b32 s74, s74, 3
    s_lshl_b32 s74, s74, 13
    s_add_u32 s74, s74, 32768
    v_add_u32 v140, s74, v12
    ds_read2st64_b32 v[32:33], v140 offset0:0 offset1:1
    ds_read2st64_b32 v[34:35], v140 offset0:2 offset1:3
    ds_read2st64_b32 v[36:37], v140 offset0:4 offset1:5
    ds_read2st64_b32 v[38:39], v140 offset0:6 offset1:7
    s_add_u32 s74, s18, 2
    s_and_b32 s74, s74, 3
    s_lshl_b32 s74, s74, 13
    s_add_u32 s74, s74, 32768
    v_add_u32 v140, s74, v12
    ds_read2st64_b32 v[40:41], v140 offset0:0 offset1:1
    ds_read2st64_b32 v[42:43], v140 offset0:2 offset1:3
    ds_read2st64_b32 v[44:45], v140 offset0:4 offset1:5
    ds_read2st64_b32 v[46:47], v140 offset0:6 offset1:7
    s_add_u32 s74, s18, 3
    s_and_b32 s74, s74, 3
    s_lshl_b32 s74, s74, 13
    s_add_u32 s74, s74, 32768
    v_add_u32 v140, s74, v12
    ds_read2st64_b32 v[48:49], v140 offset0:0 offset1:1
    ds_read2st64_b32 v[50:51], v140 offset0:2 offset1:3
    ds_read2st64_b32 v[52:53], v140 offset0:4 offset1:5
    ds_read2st64_b32 v[54:55], v140 offset0:6 offset1:7
    s_waitcnt lgkmcnt(0)
    s_barrier
    s_lshl_b32 s74, s18, 20
    s_lshl_b32 s75, s18, 13
    s_add_u32 s76, s74, 32768
    s_add_u32 m0, s75, 32768
    s_nop 0
    buffer_load_dwordx4 v143, s[12:15], s76 offen  lds
    s_add_u32 s76, s74, 98304
    s_add_u32 m0, s75, 33792
    s_nop 0
    buffer_load_dwordx4 v143, s[12:15], s76 offen  lds
    s_add_u32 s76, s74, 163840
    s_add_u32 m0, s75, 34816
    s_nop 0
    buffer_load_dwordx4 v143, s[12:15], s76 offen  lds
    s_add_u32 s76, s74, 229376
    s_add_u32 m0, s75, 35840
    s_nop 0
    buffer_load_dwordx4 v143, s[12:15], s76 offen  lds
    s_add_u32 s76, s74, 294912
    s_add_u32 m0, s75, 36864
    s_nop 0
    buffer_load_dwordx4 v143, s[12:15], s76 offen  lds
    s_add_u32 s76, s74, 360448
    s_add_u32 m0, s75, 37888
    s_nop 0
    buffer_load_dwordx4 v143, s[12:15], s76 offen  lds
    s_add_u32 s76, s74, 425984
    s_add_u32 m0, s75, 38912
    s_nop 0
    buffer_load_dwordx4 v143, s[12:15], s76 offen  lds
    s_add_u32 s76, s74, 491520
    s_add_u32 m0, s75, 39936
    s_nop 0
    buffer_load_dwordx4 v143, s[12:15], s76 offen  lds
    v_perm_b32 v100, v25, v24, s38
    v_perm_b32 v101, v27, v26, s38
    v_perm_b32 v102, v29, v28, s38
    v_perm_b32 v103, v31, v30, s38
    v_perm_b32 v20, v25, v24, s39
    v_perm_b32 v21, v27, v26, s39
    v_perm_b32 v22, v29, v28, s39
    v_perm_b32 v23, v31, v30, s39
    v_accvgpr_write_b32 a100, v20
    v_accvgpr_write_b32 a101, v21
    v_accvgpr_write_b32 a102, v22
    v_accvgpr_write_b32 a103, v23
    v_perm_b32 v132, v33, v32, s38
    v_perm_b32 v133, v35, v34, s38
    v_perm_b32 v134, v37, v36, s38
    v_perm_b32 v135, v39, v38, s38
    v_perm_b32 v20, v33, v32, s39
    v_perm_b32 v21, v35, v34, s39
    v_perm_b32 v22, v37, v36, s39
    v_perm_b32 v23, v39, v38, s39
    ds_write_b128 v142, v[20:23] offset:1024
    v_perm_b32 v16, v41, v40, s38
    v_perm_b32 v17, v43, v42, s38
    v_perm_b32 v18, v45, v44, s38
    v_perm_b32 v19, v47, v46, s38
    v_accvgpr_write_b32 a108, v16
    v_accvgpr_write_b32 a109, v17
    v_accvgpr_write_b32 a110, v18
    v_accvgpr_write_b32 a111, v19
    v_perm_b32 v20, v41, v40, s39
    v_perm_b32 v21, v43, v42, s39
    v_perm_b32 v22, v45, v44, s39
    v_perm_b32 v23, v47, v46, s39
    v_accvgpr_write_b32 a116, v20
    v_accvgpr_write_b32 a117, v21
    v_accvgpr_write_b32 a118, v22
    v_accvgpr_write_b32 a119, v23
    v_perm_b32 v16, v49, v48, s38
    v_perm_b32 v17, v51, v50, s38
    v_perm_b32 v18, v53, v52, s38
    v_perm_b32 v19, v55, v54, s38
    v_accvgpr_write_b32 a140, v16
    v_accvgpr_write_b32 a141, v17
    v_accvgpr_write_b32 a142, v18
    v_accvgpr_write_b32 a143, v19
    v_perm_b32 v20, v49, v48, s39
    v_perm_b32 v21, v51, v50, s39
    v_perm_b32 v22, v53, v52, s39
    v_perm_b32 v23, v55, v54, s39
    v_accvgpr_write_b32 a148, v20
    v_accvgpr_write_b32 a149, v21
    v_accvgpr_write_b32 a150, v22
    v_accvgpr_write_b32 a151, v23
    s_waitcnt vmcnt(16)
    s_barrier
    s_add_u32 s74, s18, 0
    s_and_b32 s74, s74, 3
    s_lshl_b32 s74, s74, 13
    s_add_u32 s74, s74, 65536
    v_add_u32 v140, s74, v12
    ds_read2st64_b32 v[24:25], v140 offset0:0 offset1:1
    ds_read2st64_b32 v[26:27], v140 offset0:2 offset1:3
    ds_read2st64_b32 v[28:29], v140 offset0:4 offset1:5
    ds_read2st64_b32 v[30:31], v140 offset0:6 offset1:7
    s_add_u32 s74, s18, 1
    s_and_b32 s74, s74, 3
    s_lshl_b32 s74, s74, 13
    s_add_u32 s74, s74, 65536
    v_add_u32 v140, s74, v12
    ds_read2st64_b32 v[32:33], v140 offset0:0 offset1:1
    ds_read2st64_b32 v[34:35], v140 offset0:2 offset1:3
    ds_read2st64_b32 v[36:37], v140 offset0:4 offset1:5
    ds_read2st64_b32 v[38:39], v140 offset0:6 offset1:7
    s_add_u32 s74, s18, 2
    s_and_b32 s74, s74, 3
    s_lshl_b32 s74, s74, 13
    s_add_u32 s74, s74, 65536
    v_add_u32 v140, s74, v12
    ds_read2st64_b32 v[40:41], v140 offset0:0 offset1:1
    ds_read2st64_b32 v[42:43], v140 offset0:2 offset1:3
    ds_read2st64_b32 v[44:45], v140 offset0:4 offset1:5
    ds_read2st64_b32 v[46:47], v140 offset0:6 offset1:7
    s_add_u32 s74, s18, 3
    s_and_b32 s74, s74, 3
    s_lshl_b32 s74, s74, 13
    s_add_u32 s74, s74, 65536
    v_add_u32 v140, s74, v12
    ds_read2st64_b32 v[48:49], v140 offset0:0 offset1:1
    ds_read2st64_b32 v[50:51], v140 offset0:2 offset1:3
    ds_read2st64_b32 v[52:53], v140 offset0:4 offset1:5
    ds_read2st64_b32 v[54:55], v140 offset0:6 offset1:7
    s_waitcnt lgkmcnt(0)
    s_barrier
    s_lshl_b32 s74, s18, 20
    s_lshl_b32 s75, s18, 13
    s_add_u32 s76, s74, 557056
    s_add_u32 m0, s75, 65536
    s_nop 0
    buffer_load_dwordx4 v143, s[12:15], s76 offen  lds
    s_add_u32 s76, s74, 622592
    s_add_u32 m0, s75, 66560
    s_nop 0
    buffer_load_dwordx4 v143, s[12:15], s76 offen  lds
    s_add_u32 s76, s74, 688128
    s_add_u32 m0, s75, 67584
    s_nop 0
    buffer_load_dwordx4 v143, s[12:15], s76 offen  lds
    s_add_u32 s76, s74, 753664
    s_add_u32 m0, s75, 68608
    s_nop 0
    buffer_load_dwordx4 v143, s[12:15], s76 offen  lds
    s_add_u32 s76, s74, 819200
    s_add_u32 m0, s75, 69632
    s_nop 0
    buffer_load_dwordx4 v143, s[12:15], s76 offen  lds
    s_add_u32 s76, s74, 884736
    s_add_u32 m0, s75, 70656
    s_nop 0
    buffer_load_dwordx4 v143, s[12:15], s76 offen  lds
    s_add_u32 s76, s74, 950272
    s_add_u32 m0, s75, 71680
    s_nop 0
    buffer_load_dwordx4 v143, s[12:15], s76 offen  lds
    s_add_u32 s76, s74, 1015808
    s_add_u32 m0, s75, 72704
    s_nop 0
    buffer_load_dwordx4 v143, s[12:15], s76 offen  lds
    v_perm_b32 v104, v25, v24, s38
    v_perm_b32 v105, v27, v26, s38
    v_perm_b32 v106, v29, v28, s38
    v_perm_b32 v107, v31, v30, s38
    v_perm_b32 v56, v25, v24, s39
    v_perm_b32 v57, v27, v26, s39
    v_perm_b32 v58, v29, v28, s39
    v_perm_b32 v59, v31, v30, s39
    v_perm_b32 v16, v33, v32, s38
    v_perm_b32 v17, v35, v34, s38
    v_perm_b32 v18, v37, v36, s38
    v_perm_b32 v19, v39, v38, s38
    v_accvgpr_write_b32 a0, v16
    v_accvgpr_write_b32 a1, v17
    v_accvgpr_write_b32 a2, v18
    v_accvgpr_write_b32 a3, v19
    v_perm_b32 v20, v33, v32, s39
    v_perm_b32 v21, v35, v34, s39
    v_perm_b32 v22, v37, v36, s39
    v_perm_b32 v23, v39, v38, s39
    v_accvgpr_write_b32 a8, v20
    v_accvgpr_write_b32 a9, v21
    v_accvgpr_write_b32 a10, v22
    v_accvgpr_write_b32 a11, v23
    v_perm_b32 v16, v41, v40, s38
    v_perm_b32 v17, v43, v42, s38
    v_perm_b32 v18, v45, v44, s38
    v_perm_b32 v19, v47, v46, s38
    v_accvgpr_write_b32 a32, v16
    v_accvgpr_write_b32 a33, v17
    v_accvgpr_write_b32 a34, v18
    v_accvgpr_write_b32 a35, v19
    v_perm_b32 v20, v41, v40, s39
    v_perm_b32 v21, v43, v42, s39
    v_perm_b32 v22, v45, v44, s39
    v_perm_b32 v23, v47, v46, s39
    v_accvgpr_write_b32 a40, v20
    v_accvgpr_write_b32 a41, v21
    v_accvgpr_write_b32 a42, v22
    v_accvgpr_write_b32 a43, v23
    v_perm_b32 v16, v49, v48, s38
    v_perm_b32 v17, v51, v50, s38
    v_perm_b32 v18, v53, v52, s38
    v_perm_b32 v19, v55, v54, s38
    v_accvgpr_write_b32 a64, v16
    v_accvgpr_write_b32 a65, v17
    v_accvgpr_write_b32 a66, v18
    v_accvgpr_write_b32 a67, v19
    v_perm_b32 v20, v49, v48, s39
    v_perm_b32 v21, v51, v50, s39
    v_perm_b32 v22, v53, v52, s39
    v_perm_b32 v23, v55, v54, s39
    v_accvgpr_write_b32 a72, v20
    v_accvgpr_write_b32 a73, v21
    v_accvgpr_write_b32 a74, v22
    v_accvgpr_write_b32 a75, v23
    v_lshlrev_b32 v138, 3, v0
    s_lshl_b32 s74, s19, 13
    s_and_b32 s75, s18, 1
    s_lshl_b32 s75, s75, 24
    s_add_u32 s74, s74, s75
    s_lshr_b32 s75, s18, 1
    s_lshl_b32 s75, s75, 18
    s_add_u32 s74, s74, s75
    s_add_u32 s74, s74, 33554432
    buffer_load_dword v139, v138, s[8:11], s74 offen sc1
    s_mov_b32 s80, s72
    s_and_b32 s81, s73, 0xffff
    s_mov_b32 s82, 8192
    s_mov_b32 s83, 0x00020000
    buffer_load_dword v139, v138, s[80:83], 0 offen
    s_getpc_b64 s[80:81]
L_rec_pc:
    s_and_b32 s81, s81, 0xffff
    s_mov_b32 s82, L_exit-L_rec_pc
    s_mov_b32 s83, 0x00020000
    s_lshl_b32 s74, s18, 13
    buffer_load_dword v139, v138, s[80:83], s74 offen
    s_waitcnt vmcnt(19)
    s_barrier
    s_add_u32 s74, s18, 0
    s_and_b32 s74, s74, 3
    s_lshl_b32 s74, s74, 13
    s_add_u32 s74, s74, 0
    v_add_u32 v140, s74, v12
    ds_read2st64_b32 v[24:25], v140 offset0:0 offset1:1
    ds_read2st64_b32 v[26:27], v140 offset0:2 offset1:3
    ds_read2st64_b32 v[28:29], v140 offset0:4 offset1:5
    ds_read2st64_b32 v[30:31], v140 offset0:6 offset1:7
    s_add_u32 s74, s18, 1
    s_and_b32 s74, s74, 3
    s_lshl_b32 s74, s74, 13
    s_add_u32 s74, s74, 0
    v_add_u32 v140, s74, v12
    ds_read2st64_b32 v[32:33], v140 offset0:0 offset1:1
    ds_read2st64_b32 v[34:35], v140 offset0:2 offset1:3
    ds_read2st64_b32 v[36:37], v140 offset0:4 offset1:5
    ds_read2st64_b32 v[38:39], v140 offset0:6 offset1:7
    s_add_u32 s74, s18, 2
    s_and_b32 s74, s74, 3
    s_lshl_b32 s74, s74, 13
    s_add_u32 s74, s74, 0
    v_add_u32 v140, s74, v12
    ds_read2st64_b32 v[40:41], v140 offset0:0 offset1:1
    ds_read2st64_b32 v[42:43], v140 offset0:2 offset1:3
    ds_read2st64_b32 v[44:45], v140 offset0:4 offset1:5
    ds_read2st64_b32 v[46:47], v140 offset0:6 offset1:7
    s_add_u32 s74, s18, 3
    s_and_b32 s74, s74, 3
    s_lshl_b32 s74, s74, 13
    s_add_u32 s74, s74, 0
    v_add_u32 v140, s74, v12
    ds_read2st64_b32 v[48:49], v140 offset0:0 offset1:1
    ds_read2st64_b32 v[50:51], v140 offset0:2 offset1:3
    ds_read2st64_b32 v[52:53], v140 offset0:4 offset1:5
    ds_read2st64_b32 v[54:55], v140 offset0:6 offset1:7
    s_waitcnt lgkmcnt(0)
    s_barrier
    v_perm_b32 v108, v25, v24, s38
    v_perm_b32 v109, v27, v26, s38
    v_perm_b32 v110, v29, v28, s38
    v_perm_b32 v111, v31, v30, s38
    v_perm_b32 v60, v25, v24, s39
    v_perm_b32 v61, v27, v26, s39
    v_perm_b32 v62, v29, v28, s39
    v_perm_b32 v63, v31, v30, s39
    v_perm_b32 v16, v33, v32, s38
    v_perm_b32 v17, v35, v34, s38
    v_perm_b32 v18, v37, v36, s38
    v_perm_b32 v19, v39, v38, s38
    v_accvgpr_write_b32 a4, v16
    v_accvgpr_write_b32 a5, v17
    v_accvgpr_write_b32 a6, v18
    v_accvgpr_write_b32 a7, v19
    v_perm_b32 v20, v33, v32, s39
    v_perm_b32 v21, v35, v34, s39
    v_perm_b32 v22, v37, v36, s39
    v_perm_b32 v23, v39, v38, s39
    v_accvgpr_write_b32 a12, v20
    v_accvgpr_write_b32 a13, v21
    v_accvgpr_write_b32 a14, v22
    v_accvgpr_write_b32 a15, v23
    v_perm_b32 v16, v41, v40, s38
    v_perm_b32 v17, v43, v42, s38
    v_perm_b32 v18, v45, v44, s38
    v_perm_b32 v19, v47, v46, s38
    v_accvgpr_write_b32 a36, v16
    v_accvgpr_write_b32 a37, v17
    v_accvgpr_write_b32 a38, v18
    v_accvgpr_write_b32 a39, v19
    v_perm_b32 v20, v41, v40, s39
    v_perm_b32 v21, v43, v42, s39
    v_perm_b32 v22, v45, v44, s39
    v_perm_b32 v23, v47, v46, s39
    v_accvgpr_write_b32 a44, v20
    v_accvgpr_write_b32 a45, v21
    v_accvgpr_write_b32 a46, v22
    v_accvgpr_write_b32 a47, v23
    v_perm_b32 v16, v49, v48, s38
    v_perm_b32 v17, v51, v50, s38
    v_perm_b32 v18, v53, v52, s38
    v_perm_b32 v19, v55, v54, s38
    v_accvgpr_write_b32 a68, v16
    v_accvgpr_write_b32 a69, v17
    v_accvgpr_write_b32 a70, v18
    v_accvgpr_write_b32 a71, v19
    v_perm_b32 v20, v49, v48, s39
    v_perm_b32 v21, v51, v50, s39
    v_perm_b32 v22, v53, v52, s39
    v_perm_b32 v23, v55, v54, s39
    v_accvgpr_write_b32 a76, v20
    v_accvgpr_write_b32 a77, v21
    v_accvgpr_write_b32 a78, v22
    v_accvgpr_write_b32 a79, v23
    v_bfe_u32 v138, v0, 2, 3
    v_mov_b32 v136, 32
    v_mov_b32 v143, 0x80
    v_cmp_eq_u32 vcc, 0, v138
    s_nop 1
    v_cndmask_b32 v136, v143, v136, vcc
    s_cmp_eq_u32 s18, 0
    s_cbranch_scc0 L_rec_np
    global_load_dword v143, v138, s[16:17] offset:132 sc1
L_rec_np:
    s_waitcnt vmcnt(11)
    s_barrier
    s_add_u32 s74, s18, 0
    s_and_b32 s74, s74, 3
    s_lshl_b32 s74, s74, 13
    s_add_u32 s74, s74, 32768
    v_add_u32 v140, s74, v12
    ds_read2st64_b32 v[24:25], v140 offset0:0 offset1:1
    ds_read2st64_b32 v[26:27], v140 offset0:2 offset1:3
    ds_read2st64_b32 v[28:29], v140 offset0:4 offset1:5
    ds_read2st64_b32 v[30:31], v140 offset0:6 offset1:7
    s_add_u32 s74, s18, 1
    s_and_b32 s74, s74, 3
    s_lshl_b32 s74, s74, 13
    s_add_u32 s74, s74, 32768
    v_add_u32 v140, s74, v12
    ds_read2st64_b32 v[32:33], v140 offset0:0 offset1:1
    ds_read2st64_b32 v[34:35], v140 offset0:2 offset1:3
    ds_read2st64_b32 v[36:37], v140 offset0:4 offset1:5
    ds_read2st64_b32 v[38:39], v140 offset0:6 offset1:7
    s_add_u32 s74, s18, 2
    s_and_b32 s74, s74, 3
    s_lshl_b32 s74, s74, 13
    s_add_u32 s74, s74, 32768
    v_add_u32 v140, s74, v12
    ds_read2st64_b32 v[40:41], v140 offset0:0 offset1:1
    ds_read2st64_b32 v[42:43], v140 offset0:2 offset1:3
    ds_read2st64_b32 v[44:45], v140 offset0:4 offset1:5
    ds_read2st64_b32 v[46:47], v140 offset0:6 offset1:7
    s_add_u32 s74, s18, 3
    s_and_b32 s74, s74, 3
    s_lshl_b32 s74, s74, 13
    s_add_u32 s74, s74, 32768
    v_add_u32 v140, s74, v12
    ds_read2st64_b32 v[48:49], v140 offset0:0 offset1:1
    ds_read2st64_b32 v[50:51], v140 offset0:2 offset1:3
    ds_read2st64_b32 v[52:53], v140 offset0:4 offset1:5
    ds_read2st64_b32 v[54:55], v140 offset0:6 offset1:7
    s_waitcnt lgkmcnt(0)
    s_barrier
    v_perm_b32 v64, v25, v24, s38
    v_perm_b32 v65, v27, v26, s38
    v_perm_b32 v66, v29, v28, s38
    v_perm_b32 v67, v31, v30, s38
    v_perm_b32 v72, v25, v24, s39
    v_perm_b32 v73, v27, v26, s39
    v_perm_b32 v74, v29, v28, s39
    v_perm_b32 v75, v31, v30, s39
    v_perm_b32 v16, v33, v32, s38
    v_perm_b32 v17, v35, v34, s38
    v_perm_b32 v18, v37, v36, s38
    v_perm_b32 v19, v39, v38, s38
    v_accvgpr_write_b32 a16, v16
    v_accvgpr_write_b32 a17, v17
    v_accvgpr_write_b32 a18, v18
    v_accvgpr_write_b32 a19, v19
    v_perm_b32 v20, v33, v32, s39
    v_perm_b32 v21, v35, v34, s39
    v_perm_b32 v22, v37, v36, s39
    v_perm_b32 v23, v39, v38, s39
    v_accvgpr_write_b32 a24, v20
    v_accvgpr_write_b32 a25, v21
    v_accvgpr_write_b32 a26, v22
    v_accvgpr_write_b32 a27, v23
    v_perm_b32 v16, v41, v40, s38
    v_perm_b32 v17, v43, v42, s38
    v_perm_b32 v18, v45, v44, s38
    v_perm_b32 v19, v47, v46, s38
    v_accvgpr_write_b32 a48, v16
    v_accvgpr_write_b32 a49, v17
    v_accvgpr_write_b32 a50, v18
    v_accvgpr_write_b32 a51, v19
    v_perm_b32 v20, v41, v40, s39
    v_perm_b32 v21, v43, v42, s39
    v_perm_b32 v22, v45, v44, s39
    v_perm_b32 v23, v47, v46, s39
    v_accvgpr_write_b32 a56, v20
    v_accvgpr_write_b32 a57, v21
    v_accvgpr_write_b32 a58, v22
    v_accvgpr_write_b32 a59, v23
    v_perm_b32 v16, v49, v48, s38
    v_perm_b32 v17, v51, v50, s38
    v_perm_b32 v18, v53, v52, s38
    v_perm_b32 v19, v55, v54, s38
    v_accvgpr_write_b32 a80, v16
    v_accvgpr_write_b32 a81, v17
    v_accvgpr_write_b32 a82, v18
    v_accvgpr_write_b32 a83, v19
    v_perm_b32 v20, v49, v48, s39
    v_perm_b32 v21, v51, v50, s39
    v_perm_b32 v22, v53, v52, s39
    v_perm_b32 v23, v55, v54, s39
    v_accvgpr_write_b32 a88, v20
    v_accvgpr_write_b32 a89, v21
    v_accvgpr_write_b32 a90, v22
    v_accvgpr_write_b32 a91, v23
    s_waitcnt vmcnt(3)
    s_barrier
    s_add_u32 s74, s18, 0
    s_and_b32 s74, s74, 3
    s_lshl_b32 s74, s74, 13
    s_add_u32 s74, s74, 65536
    v_add_u32 v140, s74, v12
    ds_read2st64_b32 v[24:25], v140 offset0:0 offset1:1
    ds_read2st64_b32 v[26:27], v140 offset0:2 offset1:3
    ds_read2st64_b32 v[28:29], v140 offset0:4 offset1:5
    ds_read2st64_b32 v[30:31], v140 offset0:6 offset1:7
    s_add_u32 s74, s18, 1
    s_and_b32 s74, s74, 3
    s_lshl_b32 s74, s74, 13
    s_add_u32 s74, s74, 65536
    v_add_u32 v140, s74, v12
    ds_read2st64_b32 v[32:33], v140 offset0:0 offset1:1
    ds_read2st64_b32 v[34:35], v140 offset0:2 offset1:3
    ds_read2st64_b32 v[36:37], v140 offset0:4 offset1:5
    ds_read2st64_b32 v[38:39], v140 offset0:6 offset1:7
    s_add_u32 s74, s18, 2
    s_and_b32 s74, s74, 3
    s_lshl_b32 s74, s74, 13
    s_add_u32 s74, s74, 65536
    v_add_u32 v140, s74, v12
    ds_read2st64_b32 v[40:41], v140 offset0:0 offset1:1
    ds_read2st64_b32 v[42:43], v140 offset0:2 offset1:3
    ds_read2st64_b32 v[44:45], v140 offset0:4 offset1:5
    ds_read2st64_b32 v[46:47], v140 offset0:6 offset1:7
    s_add_u32 s74, s18, 3
    s_and_b32 s74, s74, 3
    s_lshl_b32 s74, s74, 13
    s_add_u32 s74, s74, 65536
    v_add_u32 v140, s74, v12
    ds_read2st64_b32 v[48:49], v140 offset0:0 offset1:1
    ds_read2st64_b32 v[50:51], v140 offset0:2 offset1:3
    ds_read2st64_b32 v[52:53], v140 offset0:4 offset1:5
    ds_read2st64_b32 v[54:55], v140 offset0:6 offset1:7
    s_waitcnt lgkmcnt(0)
    s_cmp_eq_u32 s18, 0
    s_cbranch_scc0 L_rec_pk
    s_mov_b32 s36, 0
L_rec_pl:
    s_waitcnt vmcnt(0)
    v_cmp_gt_u32 vcc, v136, v143
    s_add_u32 s36, s36, 1
    s_cmp_ge_u32 s36, 200000
    s_cbranch_scc1 L_rec_pk
    s_cbranch_vccz L_rec_pk
    global_load_dword v143, v138, s[16:17] offset:132 sc1
    s_branch L_rec_pl
L_rec_pk:
    s_barrier
    v_perm_b32 v68, v25, v24, s38
    v_perm_b32 v69, v27, v26, s38
    v_perm_b32 v70, v29, v28, s38
    v_perm_b32 v71, v31, v30, s38
    v_perm_b32 v76, v25, v24, s39
    v_perm_b32 v77, v27, v26, s39
    v_perm_b32 v78, v29, v28, s39
    v_perm_b32 v79, v31, v30, s39
    v_perm_b32 v16, v33, v32, s38
    v_perm_b32 v17, v35, v34, s38
    v_perm_b32 v18, v37, v36, s38
    v_perm_b32 v19, v39, v38, s38
    v_accvgpr_write_b32 a20, v16
    v_accvgpr_write_b32 a21, v17
    v_accvgpr_write_b32 a22, v18
    v_accvgpr_write_b32 a23, v19
    v_perm_b32 v20, v33, v32, s39
    v_perm_b32 v21, v35, v34, s39
    v_perm_b32 v22, v37, v36, s39
    v_perm_b32 v23, v39, v38, s39
    v_accvgpr_write_b32 a28, v20
    v_accvgpr_write_b32 a29, v21
    v_accvgpr_write_b32 a30, v22
    v_accvgpr_write_b32 a31, v23
    v_perm_b32 v16, v41, v40, s38
    v_perm_b32 v17, v43, v42, s38
    v_perm_b32 v18, v45, v44, s38
    v_perm_b32 v19, v47, v46, s38
    v_accvgpr_write_b32 a52, v16
    v_accvgpr_write_b32 a53, v17
    v_accvgpr_write_b32 a54, v18
    v_accvgpr_write_b32 a55, v19
    v_perm_b32 v20, v41, v40, s39
    v_perm_b32 v21, v43, v42, s39
    v_perm_b32 v22, v45, v44, s39
    v_perm_b32 v23, v47, v46, s39
    v_accvgpr_write_b32 a60, v20
    v_accvgpr_write_b32 a61, v21
    v_accvgpr_write_b32 a62, v22
    v_accvgpr_write_b32 a63, v23
    v_perm_b32 v16, v49, v48, s38
    v_perm_b32 v17, v51, v50, s38
    v_perm_b32 v18, v53, v52, s38
    v_perm_b32 v19, v55, v54, s38
    v_accvgpr_write_b32 a84, v16
    v_accvgpr_write_b32 a85, v17
    v_accvgpr_write_b32 a86, v18
    v_accvgpr_write_b32 a87, v19
    v_perm_b32 v20, v49, v48, s39
    v_perm_b32 v21, v51, v50, s39
    v_perm_b32 v22, v53, v52, s39
    v_perm_b32 v23, v55, v54, s39
    v_accvgpr_write_b32 a92, v20
    v_accvgpr_write_b32 a93, v21
    v_accvgpr_write_b32 a94, v22
    v_accvgpr_write_b32 a95, v23
    s_mov_b32 m0, 14912
    ds_write_b128 v141, v[112:115] offset:14336
    ds_write_b128 v141, v[116:119] offset:15360
    ds_write_b128 v141, v[120:123] offset:16384
    ds_write_b128 v141, v[124:127] offset:17408
    ds_write_b128 v141, v[128:131] offset:18432
    ds_write_b128 v141, v[132:135] offset:19456
    ds_write_b128 v141, v[56:59] offset:0
    ds_write_b128 v141, v[60:63] offset:1024
    ds_write_b128 v141, v[64:67] offset:2048
    ds_write_b128 v141, v[68:71] offset:3072
    ds_write_b128 v141, v[72:75] offset:4096
    ds_write_b128 v141, v[76:79] offset:5120
    ds_write_b128 v141, v[80:83] offset:6144
    ds_write_b128 v141, v[84:87] offset:7168
    ds_write_b128 v141, v[88:91] offset:8192
    ds_write_b128 v141, v[92:95] offset:9216
    ds_write_b128 v141, v[96:99] offset:10240
    ds_write_b128 v141, v[100:103] offset:11264
    ds_write_b128 v141, v[104:107] offset:12288
    ds_write_b128 v141, v[108:111] offset:13312
    v_bfe_u32 v24, v0, 4, 4
    v_and_b32 v37, 3, v24
    v_lshrrev_b32 v36, 2, v24
    v_mov_b32 v38, 0
    v_mov_b32 v39, 0x3f80
    v_cmp_eq_u32 vcc, 0, v37
    s_nop 1
    v_cndmask_b32 v38, v38, v39, vcc
    v_mov_b32 v39, 0x3f800000
    v_cmp_eq_u32 vcc, 1, v37
    s_nop 1
    v_cndmask_b32 v38, v38, v39, vcc
    v_cmp_eq_u32 vcc, 0, v36
    s_nop 1
    v_cndmask_b32 v20, 0, v38, vcc
    v_cmp_eq_u32 vcc, 1, v36
    s_nop 1
    v_cndmask_b32 v21, 0, v38, vcc
    v_cmp_eq_u32 vcc, 2, v36
    s_nop 1
    v_cndmask_b32 v22, 0, v38, vcc
    v_cmp_eq_u32 vcc, 3, v36
    s_nop 1
    v_cndmask_b32 v23, 0, v38, vcc
    v_mov_b32 v16, 0x3f003f00
    v_mov_b32 v17, 0x3f003f00
    v_mov_b32 v18, 0x3f003f00
    v_mov_b32 v19, 0x3f003f00
    s_cmp_eq_u32 s18, 1
    s_cbranch_scc1 L_rec_w1
    s_cmp_eq_u32 s18, 2
    s_cbranch_scc1 L_rec_w2
    s_cmp_eq_u32 s18, 3
    s_cbranch_scc1 L_rec_w3
L_rec_w0:
    v_add_u32 v1, 131072, v0
    v_bfe_u32 v10, v0, 7, 1
    v_lshl_add_u32 v10, v10, 3, v5
    s_mov_b32 s4, 0xff00ff00
    s_mov_b32 s5, 0xff00ff00
    s_mov_b32 s45, 1
    s_mov_b32 s46, 0x000f000f
    s_mov_b32 s47, 0x000f000f
    s_mov_b32 s40, 1572864
    s_mov_b32 s12, s72
    s_and_b32 s13, s73, 0xffff
    s_mov_b32 s14, 8192
    s_mov_b32 s15, 0x00020000
    buffer_load_dword v24, v15, s[12:15], 0 offen offset:0
    buffer_load_dword v25, v15, s[12:15], 0 offen offset:16
    buffer_load_dword v26, v15, s[12:15], 0 offen offset:32
    buffer_load_dword v27, v15, s[12:15], 0 offen offset:48
    buffer_load_dword v28, v15, s[12:15], 0 offen offset:8
    buffer_load_dword v29, v15, s[12:15], 0 offen offset:24
    buffer_load_dword v30, v15, s[12:15], 0 offen offset:40
    buffer_load_dword v31, v15, s[12:15], 0 offen offset:56
    s_mov_b32 s20, 0
    s_mov_b32 s21, 0
    s_mov_b32 s27, 532480
    s_mov_b32 s28, 524288
    s_mov_b32 s29, 540672
    s_lshl_b32 s30, s19, 13
    s_add_u32 s30, s30, 33554432
    s_mov_b32 s32, 1048576
    s_cmp_eq_u32 s19, 0
    s_cselect_b32 s44, 0, 0x80
    s_waitcnt vmcnt(8) lgkmcnt(0)
    v_mov_b64 v[120:121], 0
    v_mov_b64 v[122:123], 0
    v_mov_b64 v[124:125], 0
    v_mov_b64 v[126:127], 0
    v_mov_b64 v[128:129], 0
    v_mov_b64 v[130:131], 0
    v_mov_b64 v[132:133], 0
    v_mov_b64 v[134:135], 0
    v_mov_b64 v[136:137], 0
    v_mov_b64 v[138:139], 0
    v_mov_b64 v[140:141], 0
    v_mov_b64 v[142:143], 0
    s_add_u32 s22, s21, 4096
    s_lshl_b32 s37, s19, 13
    s_add_u32 s37, s21, s37
    s_add_u32 s23, s37, 0
    s_xor_b32 s24, s23, 0x40000
    s_add_u32 s31, s30, 17039360
    s_add_u32 s41, s30, 262144
    s_add_u32 s37, s30, 16777216
    buffer_load_dwordx4 v[112:115], v0, s[8:11], s37 offen sc1
    buffer_load_dwordx4 v[116:119], v0, s[8:11], s37 offen offset:1024 sc1
    s_waitcnt vmcnt(0)
    s_waitcnt lgkmcnt(0)
    v_lshlrev_b32 v15, 3, v0
    v_mov_b32 v13, -1
    s_mov_b32 s36, 0x7fffffff
    s_barrier
.p2align 6
L_top_w0:
    s_waitcnt vmcnt(3)
L_top_w0_nw:
    v_cmp_eq_u32 vcc, -1, v27
    v_smfmac_f32_16x16x64_bf16 v[120:123], v[24:27], v[104:111], v11
    ds_write_b128 v0, v[24:27] offset:0
    v_smfmac_f32_16x16x64_bf16 v[124:127], v[24:27], v[56:63], v11
    s_cbranch_vccnz L_retry_w0_0
L_go_w0_0:
    v_smfmac_f32_16x16x64_bf16 v[128:131], v[24:27], v[80:87], v11
    v_smfmac_f32_16x16x64_bf16 v[132:135], v[24:27], v[88:95], v11
    s_waitcnt lgkmcnt(0)
    s_barrier
    v_smfmac_f32_16x16x64_bf16 v[136:139], v[24:27], a[152:159], v11
    ds_read_b128 v[32:35], v0 offset:2048
    s_waitcnt vmcnt(2)
    v_cmp_eq_u32 vcc, -1, v31
    v_smfmac_f32_16x16x64_bf16 v[140:143], v[24:27], a[160:167], v11
    ds_write_b128 v0, v[28:31] offset:1024
    s_cbranch_vccnz L_retry_w0
L_go_w0:
    v_smfmac_f32_16x16x64_bf16 v[120:123], v[28:31], v[64:71], v11
    ds_read_b128 v[40:43], v0 offset:4096
    v_smfmac_f32_16x16x64_bf16 v[124:127], v[28:31], v[72:79], v11
    buffer_load_dwordx4 v[104:107], v9, s[8:11], s30 offen sc1
    v_smfmac_f32_16x16x64_bf16 v[128:131], v[28:31], v[96:103], v11
    ds_read_b128 v[48:51], v0 offset:6144
    v_smfmac_f32_16x16x64_bf16 v[132:135], v[28:31], a[96:103], v11
    buffer_load_dwordx4 v[108:111], v9, s[8:11], s30 offen offset:1024 sc1
    s_waitcnt lgkmcnt(3)
    v_smfmac_f32_16x16x64_bf16 v[120:123], v[32:35], a[0:7], v11
    s_waitcnt lgkmcnt(2)
    s_barrier
    ds_read_b128 v[36:39], v0 offset:3072
    v_smfmac_f32_16x16x64_bf16 v[124:127], v[32:35], a[8:15], v11
    ds_read_b128 v[56:59], v0 offset:30720
    s_waitcnt lgkmcnt(3)
    v_smfmac_f32_16x16x64_bf16 v[120:123], v[40:43], a[32:39], v11
    ds_read_b128 v[44:47], v0 offset:5120
    v_smfmac_f32_16x16x64_bf16 v[124:127], v[40:43], a[40:47], v11
    buffer_store_dword v54, v8, s[8:11], s32 offen sc1
    s_waitcnt lgkmcnt(3)
    v_smfmac_f32_16x16x64_bf16 v[120:123], v[48:51], a[64:71], v11
    ds_read_b128 v[52:55], v0 offset:7168
    v_smfmac_f32_16x16x64_bf16 v[124:127], v[48:51], a[72:79], v11
    ds_read_b128 v[60:63], v0 offset:31744
    s_waitcnt lgkmcnt(4)
    v_smfmac_f32_16x16x64_bf16 v[120:123], v[36:39], a[16:23], v11
    ds_read_b128 v[64:67], v0 offset:32768
    buffer_store_dword v13, v0, s[8:11], s24 offen offset:0
    v_smfmac_f32_16x16x64_bf16 v[124:127], v[36:39], a[24:31], v11
    ds_read_b128 v[68:71], v0 offset:33792
    s_waitcnt lgkmcnt(4)
    v_smfmac_f32_16x16x64_bf16 v[120:123], v[44:47], a[48:55], v11
    ds_read_b128 v[72:75], v0 offset:34816
    buffer_store_dword v13, v0, s[8:11], s24 offen offset:1024
    v_smfmac_f32_16x16x64_bf16 v[124:127], v[44:47], a[56:63], v11
    ds_read_b128 v[76:79], v0 offset:35840
    s_waitcnt lgkmcnt(5)
    v_smfmac_f32_16x16x64_bf16 v[120:123], v[52:55], a[80:87], v11
    ds_read_b128 v[80:83], v1 offset:0
    buffer_store_dword v13, v8, s[8:11], s29 offen
    v_smfmac_f32_16x16x64_bf16 v[124:127], v[52:55], a[88:95], v11
    ds_read_b128 v[84:87], v1 offset:1024
    v_smfmac_f32_16x16x64_bf16 v[128:131], v[44:47], a[104:111], v11
    ds_read_b128 v[88:91], v1 offset:2048
    v_smfmac_f32_16x16x64_bf16 v[132:135], v[44:47], a[112:119], v11
    ds_read_b128 v[92:95], v1 offset:3072
    v_permlane32_swap_b32 v120, v122
    v_permlane32_swap_b32 v121, v123
    s_waitcnt lgkmcnt(2)
    v_smfmac_f32_16x16x64_bf16 v[128:131], v[32:35], v[56:63], v11
    ds_read_b128 v[96:99], v1 offset:4096
    v_permlane32_swap_b32 v124, v126
    v_permlane32_swap_b32 v125, v127
    v_smfmac_f32_16x16x64_bf16 v[132:135], v[32:35], v[64:71], v11
    ds_read_b128 v[100:103], v1 offset:5120
    v_add_f32 v120, v120, v122
    v_add_f32 v124, v124, v126
    v_cvt_pk_bf16_f32 v12, v120, v124
    v_smfmac_f32_16x16x64_bf16 v[128:131], v[36:39], v[72:79], v11
    ds_write_b32 v2, v12 offset:10304
    v_add_f32 v121, v121, v123
    v_add_f32 v125, v125, v127
    v_cvt_pk_bf16_f32 v13, v121, v125
    v_smfmac_f32_16x16x64_bf16 v[132:135], v[36:39], v[80:87], v11
    ds_write_b32 v2, v13 offset:10688
    s_waitcnt lgkmcnt(2)
    v_smfmac_f32_16x16x64_bf16 v[128:131], v[40:43], v[88:95], v11
    v_smfmac_f32_16x16x64_bf16 v[132:135], v[40:43], v[96:103], v11
    v_smfmac_f32_16x16x64_bf16 v[128:131], v[48:51], a[120:127], v11
    v_smfmac_f32_16x16x64_bf16 v[132:135], v[48:51], a[128:135], v11
    s_waitcnt lgkmcnt(0)
    s_barrier
    ds_read_b128 v[56:59], v4 offset:0
    v_smfmac_f32_16x16x64_bf16 v[128:131], v[52:55], a[136:143], v11
    ds_read_b128 v[60:63], v4 offset:64
    v_smfmac_f32_16x16x64_bf16 v[132:135], v[52:55], a[144:151], v11
    ds_read_b128 v[64:67], v3 offset:0
    v_smfmac_f32_16x16x64_bf16 v[136:139], v[28:31], a[168:175], v11
    ds_read_b128 v[68:71], v3 offset:64
    v_smfmac_f32_16x16x64_bf16 v[140:143], v[28:31], a[176:183], v11
    ds_read_b128 v[72:75], v3 offset:128
    s_waitcnt vmcnt(4)
    s_waitcnt lgkmcnt(3)
    v_mfma_f32_16x16x32_bf16 v[96:99], v[104:107], v[56:59], 0.5
    v_cvt_pk_bf16_f32 v128, v128, v132
    v_cvt_pk_bf16_f32 v129, v129, v133
    v_mfma_f32_16x16x32_bf16 v[96:99], v[108:111], v[60:63], v[96:99]
    ds_write2_b32 v2, v128, v129 offset0:0 offset1:80
    v_cvt_pk_bf16_f32 v130, v130, v134
    v_cvt_pk_bf16_f32 v131, v131, v135
    v_smfmac_f32_16x16x64_bf16 v[136:139], v[32:35], a[184:191], v11
    ds_write2_b32 v2, v130, v131 offset0:160 offset1:240
    ds_read_b128 v[76:79], v3 offset:192
    v_smfmac_f32_16x16x64_bf16 v[140:143], v[32:35], a[192:199], v11
    s_nop 0
    v_permlane32_swap_b32 v96, v98
    v_smfmac_f32_16x16x64_bf16 v[136:139], v[36:39], a[200:207], v11
    v_permlane32_swap_b32 v97, v99
    v_smfmac_f32_16x16x64_bf16 v[140:143], v[36:39], a[208:215], v11
    v_add_f32_dpp v96, v98, v96 row_ror:8 row_mask:0xf bank_mask:0xf
    v_add_f32_dpp v97, v99, v97 row_ror:8 row_mask:0xf bank_mask:0xf
    v_exp_f32 v96, v96
    s_waitcnt lgkmcnt(1)
    s_barrier
    v_smfmac_f32_16x16x64_bf16 v[136:139], v[40:43], a[216:223], v11
    ds_read_b128 v[80:83], v14 offset:0
    v_exp_f32 v97, v97
    v_smfmac_f32_16x16x64_bf16 v[140:143], v[40:43], a[224:231], v11
    ds_read_b128 v[84:87], v14 offset:64
    v_cvt_pk_bf16_f32 v96, v96, v97
    v_smfmac_f32_16x16x64_bf16 v[136:139], v[44:47], a[232:239], v11
    ds_read_b128 v[88:91], v14 offset:128
    v_smfmac_f32_16x16x64_bf16 v[140:143], v[44:47], a[240:247], v11
    ds_read_b128 v[92:95], v14 offset:192
    ds_write_b32 v6, v96
    s_waitcnt lgkmcnt(4)
    v_mfma_f32_16x16x32_bf16 v[104:107], v[80:83], v[64:67], 0
    v_mov_b64 v[56:57], 0
    s_waitcnt lgkmcnt(3)
    v_mfma_f32_16x16x32_bf16 v[104:107], v[84:87], v[68:71], v[104:107]
    v_mov_b64 v[58:59], 0
    s_waitcnt lgkmcnt(2)
    v_mfma_f32_16x16x32_bf16 v[104:107], v[88:91], v[72:75], v[104:107]
    v_mov_b64 v[60:61], 0
    s_waitcnt lgkmcnt(1)
    v_mfma_f32_16x16x32_bf16 v[104:107], v[92:95], v[76:79], v[104:107]
    s_waitcnt lgkmcnt(0)
    s_barrier
    v_smfmac_f32_16x16x64_bf16 v[136:139], v[48:51], a[248:255], v11
    ds_read_b128 v[100:103], v5
    v_mov_b64 v[62:63], 0
    v_smfmac_f32_16x16x64_bf16 v[140:143], v[48:51], v[144:151], v11
    s_nop 1
    v_permlane32_swap_b32 v104, v106
    v_smfmac_f32_16x16x64_bf16 v[136:139], v[52:55], v[152:159], v11
    ds_read_b128 v[64:67], v1 offset:6144
    v_permlane32_swap_b32 v105, v107
    v_smfmac_f32_16x16x64_bf16 v[140:143], v[52:55], v[160:167], v11
    ds_read_b128 v[68:71], v1 offset:7168
    v_add_f32 v104, v104, v106
    v_add_f32 v105, v105, v107
    s_waitcnt lgkmcnt(2)
    v_mfma_f32_16x16x32_bf16 v[108:111], v[16:19], v[100:103], 0
    v_mul_f32 v104, s34, v104
    v_mul_f32 v105, s34, v105
    v_mfma_f32_16x16x32_bf16 v[120:123], v[112:115], v[100:103], 0
    v_exp_f32 v106, v104
    v_mfma_f32_16x16x32_bf16 v[124:127], v[116:119], v[100:103], 0
    v_exp_f32 v107, v105
    s_nop 0
    v_cvt_pk_bf16_f32 v104, v106, v107
    v_cvt_pk_bf16_f32 v105, v106, v107
    v_cvt_pk_bf16_f32 v128, v136, v137
    v_cvt_pk_bf16_f32 v129, v138, v139
    v_permlane32_swap_b32 v104, v105
    v_mov_b64 v[132:133], 0
    v_mov_b64 v[134:135], 0
    v_mfma_f32_16x16x16_bf16 v[108:111], v[16:17], v[104:105], v[108:111]
    v_cvt_pk_bf16_f32 v130, v140, v141
    v_cvt_pk_bf16_f32 v131, v142, v143
    v_mfma_f32_16x16x16_bf16 v[120:123], v[128:129], v[104:105], v[120:123]
    v_mov_b64 v[96:97], 0
    v_mov_b64 v[98:99], 0
    v_mfma_f32_16x16x16_bf16 v[124:127], v[130:131], v[104:105], v[124:127]
    ds_read_b128 v[72:75], v1 offset:8192
    s_nop 0
    v_rcp_f32 v12, v108
    v_add_u32 v15, 3565158400, v108
    v_cmp_lt_u32 vcc, s42, v15
L_fbr_w0:
    v_mul_f32 v120, v120, v12
    v_mul_f32 v121, v121, v12
    v_mul_f32 v122, v122, v12
    v_mul_f32 v123, v123, v12
    v_pk_mul_f32 v[124:125], v[124:125], v[12:13] op_sel_hi:[1,0]
    v_pk_mul_f32 v[126:127], v[126:127], v[12:13] op_sel_hi:[1,0]
    v_cvt_pk_bf16_f32 v40, v120, v124
    v_cvt_pk_bf16_f32 v42, v122, v126
    v_cvt_pk_bf16_f32 v41, v121, v125
    v_cvt_pk_bf16_f32 v43, v123, v127
    v_cndmask_b32 v120, v40, v42, s[4:5]
    v_cndmask_b32 v121, v41, v43, s[4:5]
    s_cbranch_vccnz L_fb_w0
    ds_write_b64 v10, v[120:121] offset:1024
    v_smfmac_f32_16x16x64_bf16 v[56:59], v[40:43], v[168:175], v11
    buffer_load_dwordx4 v[112:115], v0, s[8:11], s31 offen sc1
    v_mov_b64 v[136:137], 0
    v_smfmac_f32_16x16x64_bf16 v[60:63], v[40:43], v[176:183], v11
    v_mov_b64 v[138:139], 0
    v_smfmac_f32_16x16x64_bf16 v[132:135], v[40:43], v[184:191], v11
    v_mov_b64 v[140:141], 0
    s_waitcnt lgkmcnt(0)
    s_barrier
    ds_read_b128 v[44:47], v5 offset:1536
    v_mov_b64 v[142:143], 0
    ds_read_b128 v[48:51], v5 offset:2048
    ds_read_b128 v[52:55], v5 offset:2560
    v_smfmac_f32_16x16x64_bf16 v[96:99], v[40:43], v[192:199], v11
    buffer_load_dwordx4 v[116:119], v0, s[8:11], s31 offen offset:1024 sc1
    ds_read_b128 v[76:79], v1 offset:9216
    v_mov_b64 v[120:121], 0
    s_add_u32 s20, s20, 1
    s_waitcnt lgkmcnt(3)
    v_smfmac_f32_16x16x64_bf16 v[56:59], v[44:47], v[200:207], v11
    ds_read_b128 v[80:83], v1 offset:10240
    v_smfmac_f32_16x16x64_bf16 v[60:63], v[44:47], v[208:215], v11
    ds_read_b128 v[84:87], v1 offset:11264
    s_waitcnt lgkmcnt(4)
    v_smfmac_f32_16x16x64_bf16 v[56:59], v[48:51], v[224:231], v11
    ds_read_b128 v[88:91], v1 offset:12288
    v_smfmac_f32_16x16x64_bf16 v[60:63], v[48:51], v[232:239], v11
    ds_read_b128 v[92:95], v1 offset:13312
    s_waitcnt lgkmcnt(5)
    v_smfmac_f32_16x16x64_bf16 v[56:59], v[52:55], v[240:247], v11
    ds_read_b128 v[24:27], v1 offset:14336
    v_smfmac_f32_16x16x64_bf16 v[60:63], v[52:55], v[248:255], v11
    ds_read_b128 v[28:31], v1 offset:15360
    v_smfmac_f32_16x16x64_bf16 v[132:135], v[44:47], v[216:223], v11
    s_add_u32 s40, s27, 0
    s_add_u32 s32, s32, 8192
    s_mov_b32 s37, s29
    v_smfmac_f32_16x16x64_bf16 v[96:99], v[44:47], v[64:71], v11
    s_mov_b32 s29, s28
    s_waitcnt lgkmcnt(4)
    v_cvt_pk_bf16_f32 v32, v56, v60
    v_smfmac_f32_16x16x64_bf16 v[132:135], v[48:51], v[72:79], v11
    v_cvt_pk_bf16_f32 v33, v57, v61
    v_cvt_pk_bf16_f32 v34, v58, v62
    v_cvt_pk_bf16_f32 v35, v59, v63
    v_smfmac_f32_16x16x64_bf16 v[96:99], v[48:51], v[80:87], v11
    buffer_store_dwordx4 v[32:35], v7, s[8:11], s21 offen
    s_waitcnt lgkmcnt(0)
    v_smfmac_f32_16x16x64_bf16 v[132:135], v[52:55], v[88:95], v11
    v_smfmac_f32_16x16x64_bf16 v[96:99], v[52:55], v[24:31], v11
    s_mov_b32 s28, s27
    s_mov_b32 s27, s37
    s_add_u32 s30, s30, 262144
    v_mov_b64 v[122:123], 0
    v_mov_b64 v[124:125], 0
    v_mov_b64 v[126:127], 0
    s_nop 1
    v_cvt_pk_bf16_f32 v36, v132, v96
    v_cvt_pk_bf16_f32 v37, v133, v97
    v_cvt_pk_bf16_f32 v38, v134, v98
    v_cvt_pk_bf16_f32 v39, v135, v99
    buffer_store_dwordx4 v[36:39], v7, s[8:11], s22 offen
    s_mov_b32 s25, s23
    s_barrier
    ds_read_b128 v[56:59], v0 offset:16384
    ds_read_b128 v[60:63], v0 offset:17408
    s_waitcnt lgkmcnt(0)
    ds_read_b128 v[64:67], v0 offset:18432
    ds_read_b128 v[68:71], v0 offset:19456
    s_waitcnt lgkmcnt(0)
    s_xor_b32 s21, s21, 0x40000
    s_add_u32 s45, s20, 1
    s_add_u32 s22, s21, 4096
    s_lshl_b32 s37, s19, 13
    s_add_u32 s37, s21, s37
    buffer_load_dwordx4 v[40:43], v0, s[8:11], s25 offen offset:0 sc1
    buffer_load_dwordx4 v[44:47], v0, s[8:11], s25 offen offset:1024 sc1
    ds_read_b128 v[72:75], v0 offset:20480
    ds_read_b128 v[76:79], v0 offset:21504
    s_waitcnt lgkmcnt(0)
    ds_read_b128 v[80:83], v0 offset:22528
    ds_read_b128 v[84:87], v0 offset:23552
    s_waitcnt lgkmcnt(0)
    buffer_load_dwordx4 v[40:43], v0, s[8:11], s25 offen offset:0 sc1
    buffer_load_dwordx4 v[44:47], v0, s[8:11], s25 offen offset:1024 sc1
    ds_read_b128 v[88:91], v0 offset:24576
    ds_read_b128 v[92:95], v0 offset:25600
    ds_read_b128 v[96:99], v0 offset:26624
    ds_read_b128 v[100:103], v0 offset:27648
    s_waitcnt lgkmcnt(0)
    s_mov_b32 s36, 0
L_red_1_w:
    s_waitcnt vmcnt(2)
    v_max_u32 v12, v40, v44
    v_cmp_eq_u32 vcc, -1, v12
L_red_1_m:
    v_mfma_f32_16x16x32_bf16 v[52:55], v[20:23], v[40:43], 0
    v_mfma_f32_16x16x32_bf16 v[52:55], v[20:23], v[44:47], v[52:55]
    s_cmp_eq_u32 s20, 63
    s_nop 2
    s_cbranch_vccnz L_red_1_e
    s_nop 2
    v_add_f32_dpp v52, v52, v52 row_ror:4 row_mask:0xf bank_mask:0xf
    v_add_f32_dpp v53, v53, v53 row_ror:4 row_mask:0xf bank_mask:0xf
    s_nop 0
    v_add_f32_dpp v52, v52, v52 row_ror:8 row_mask:0xf bank_mask:0xf
    v_add_f32_dpp v53, v53, v53 row_ror:8 row_mask:0xf bank_mask:0xf
    v_cvt_pk_bf16_f32 v54, v52, v53
    buffer_store_dword v54, v8, s[8:11], s28 offen
    s_cbranch_scc0 L_rec_on_w0
    buffer_store_dword v54, v8, s[8:11], s32 offen sc1
    s_branch L_rec_done_w0
L_rec_on_w0:
    s_mov_b32 s36, 0
    s_add_u32 s23, s37, 0
    s_xor_b32 s24, s23, 0x40000
    s_add_u32 s31, s30, 17039360
    s_add_u32 s41, s30, 262144
    s_barrier
    buffer_load_dwordx4 v[24:27], v0, s[8:11], s40 offen offset:0 sc1
    ds_read_b128 v[104:107], v0 offset:28672
    s_waitcnt lgkmcnt(0)
    buffer_load_dwordx4 v[28:31], v0, s[8:11], s40 offen offset:1024 sc1
    v_mov_b64 v[128:129], 0
    v_mov_b64 v[130:131], 0
    v_mov_b64 v[132:133], 0
    v_mov_b64 v[134:135], 0
    v_lshlrev_b32 v15, 3, v0
    v_mov_b32 v13, -1
    buffer_load_dwordx4 v[24:27], v0, s[8:11], s40 offen offset:0 sc1
    ds_read_b128 v[108:111], v0 offset:29696
    s_waitcnt lgkmcnt(0)
    buffer_load_dwordx4 v[28:31], v0, s[8:11], s40 offen offset:1024 sc1
    s_branch L_top_w0
L_red_1_e:
    s_mov_b64 exec, vcc
    buffer_load_dwordx4 v[40:43], v0, s[8:11], s25 offen offset:0 sc1
    buffer_load_dwordx4 v[44:47], v0, s[8:11], s25 offen offset:1024 sc1
    s_mov_b64 exec, -1
    s_add_u32 s36, s36, 1
    s_cmp_lt_u32 s36, 30000
    s_cbranch_scc1 L_red_1_w
    s_mov_b64 vcc, 0
    s_branch L_red_1_m
L_retry_w0:
    s_mov_b64 exec, vcc
    buffer_load_dwordx4 v[28:31], v0, s[8:11], s40 offen offset:1024 sc1
    s_mov_b64 exec, -1
    s_add_u32 s36, s36, 1
    s_cmp_lt_u32 s36, 30000
    s_waitcnt vmcnt(3)
    v_cmp_eq_u32 vcc, -1, v31
    ds_write_b128 v0, v[28:31] offset:1024
    s_cbranch_scc0 L_go_w0
    s_cbranch_vccnz L_retry_w0
    s_branch L_go_w0
L_retry_w0_0:
    s_mov_b64 exec, vcc
    buffer_load_dwordx4 v[24:27], v0, s[8:11], s40 offen offset:0 sc1
    s_mov_b64 exec, -1
    buffer_load_dwordx4 v[28:31], v0, s[8:11], s40 offen offset:1024 sc1
    s_add_u32 s36, s36, 1
    s_cmp_lt_u32 s36, 30000
    s_cbranch_scc0 L_go_w0_0
    v_mov_b64 v[120:121], 0
    v_mov_b64 v[122:123], 0
    v_mov_b64 v[124:125], 0
    v_mov_b64 v[126:127], 0
    s_waitcnt vmcnt(3)
    s_branch L_top_w0_nw
L_fb_w0:
    s_waitcnt lgkmcnt(0)
    s_add_u32 s37, s30, 4096
    buffer_load_dwordx4 v[24:27], v0, s[8:11], s30 offen offset:0 sc1
    buffer_load_dwordx4 v[28:31], v0, s[8:11], s30 offen offset:1024 sc1
    buffer_load_dwordx4 v[32:35], v0, s[8:11], s30 offen offset:2048 sc1
    buffer_load_dwordx4 v[36:39], v0, s[8:11], s30 offen offset:3072 sc1
    buffer_load_dwordx4 v[40:43], v0, s[8:11], s37 offen offset:0 sc1
    buffer_load_dwordx4 v[44:47], v0, s[8:11], s37 offen offset:1024 sc1
    buffer_load_dwordx4 v[48:51], v0, s[8:11], s37 offen offset:2048 sc1
    buffer_load_dwordx4 v[52:55], v0, s[8:11], s37 offen offset:3072 sc1
    ds_read_b128 v[64:67], v3 offset:0
    ds_read_b128 v[80:83], v14 offset:0
    ds_read_b128 v[68:71], v3 offset:64
    ds_read_b128 v[84:87], v14 offset:64
    ds_read_b128 v[72:75], v3 offset:128
    ds_read_b128 v[88:91], v14 offset:128
    ds_read_b128 v[76:79], v3 offset:192
    ds_read_b128 v[92:95], v14 offset:192
    s_waitcnt vmcnt(0) lgkmcnt(0)
    v_mfma_f32_16x16x32_bf16 v[56:59], v[24:27], v[64:67], 0
    v_mfma_f32_16x16x32_bf16 v[60:63], v[40:43], v[64:67], 0
    v_mfma_f32_16x16x32_bf16 v[104:107], v[80:83], v[64:67], 0
    v_mfma_f32_16x16x32_bf16 v[56:59], v[28:31], v[68:71], v[56:59]
    v_mfma_f32_16x16x32_bf16 v[60:63], v[44:47], v[68:71], v[60:63]
    v_mfma_f32_16x16x32_bf16 v[104:107], v[84:87], v[68:71], v[104:107]
    v_mfma_f32_16x16x32_bf16 v[56:59], v[32:35], v[72:75], v[56:59]
    v_mfma_f32_16x16x32_bf16 v[60:63], v[48:51], v[72:75], v[60:63]
    v_mfma_f32_16x16x32_bf16 v[104:107], v[88:91], v[72:75], v[104:107]
    v_mfma_f32_16x16x32_bf16 v[56:59], v[36:39], v[76:79], v[56:59]
    v_mfma_f32_16x16x32_bf16 v[60:63], v[52:55], v[76:79], v[60:63]
    v_mfma_f32_16x16x32_bf16 v[104:107], v[92:95], v[76:79], v[104:107]
    s_nop 7
    v_permlane32_swap_b32 v104, v106
    v_permlane32_swap_b32 v105, v107
    v_add_f32 v104, v104, v106
    v_add_f32 v105, v105, v107
    v_mul_f32 v104, s34, v104
    v_mul_f32 v105, s34, v105
    v_max3_f32 v12, v56, v57, v58
    v_max3_f32 v12, v12, v59, v60
    v_max3_f32 v12, v12, v61, v62
    v_max3_f32 v12, v12, v63, v104
    v_max_f32 v12, v12, v105
    v_mov_b32 v13, v12
    s_nop 1
    v_permlane16_swap_b32 v12, v13
    v_max_f32 v12, v12, v13
    v_mov_b32 v13, v12
    s_nop 1
    v_permlane32_swap_b32 v12, v13
    v_max_f32 v12, v12, v13
    v_add_f32 v13, -1.0, v12
    v_sub_f32 v56, v56, v13
    v_exp_f32 v56, v56
    v_sub_f32 v57, v57, v13
    v_exp_f32 v57, v57
    v_sub_f32 v58, v58, v13
    v_exp_f32 v58, v58
    v_sub_f32 v59, v59, v13
    v_exp_f32 v59, v59
    v_sub_f32 v60, v60, v13
    v_exp_f32 v60, v60
    v_sub_f32 v61, v61, v13
    v_exp_f32 v61, v61
    v_sub_f32 v62, v62, v13
    v_exp_f32 v62, v62
    v_sub_f32 v63, v63, v13
    v_exp_f32 v63, v63
    v_sub_f32 v104, v104, v12
    v_exp_f32 v104, v104
    v_sub_f32 v105, v105, v12
    v_exp_f32 v105, v105
    v_cvt_pk_bf16_f32 v100, v56, v57
    v_cvt_pk_bf16_f32 v101, v58, v59
    v_cvt_pk_bf16_f32 v102, v60, v61
    v_cvt_pk_bf16_f32 v103, v62, v63
    v_cvt_pk_bf16_f32 v104, v104, v105
    v_mov_b32 v105, v104
    s_nop 1
    v_permlane32_swap_b32 v104, v105
    v_mfma_f32_16x16x32_bf16 v[108:111], v[16:19], v[100:103], 0
    v_mfma_f32_16x16x32_bf16 v[120:123], v[112:115], v[100:103], 0
    v_mfma_f32_16x16x32_bf16 v[124:127], v[116:119], v[100:103], 0
    v_mfma_f32_16x16x16_bf16 v[108:111], v[16:17], v[104:105], v[108:111]
    v_mfma_f32_16x16x16_bf16 v[120:123], v[128:129], v[104:105], v[120:123]
    v_mfma_f32_16x16x16_bf16 v[124:127], v[130:131], v[104:105], v[124:127]
    ds_read_b128 v[64:67], v1 offset:6144
    ds_read_b128 v[68:71], v1 offset:7168
    ds_read_b128 v[72:75], v1 offset:8192
    v_mov_b64 v[56:57], 0
    v_mov_b64 v[58:59], 0
    v_mov_b64 v[60:61], 0
    v_mov_b64 v[62:63], 0
    v_mov_b64 v[132:133], 0
    v_mov_b64 v[134:135], 0
    v_mov_b64 v[96:97], 0
    v_mov_b64 v[98:99], 0
    s_mov_b64 vcc, 0
    v_mov_b32 v13, 0
    v_rcp_f32 v12, v108
    s_waitcnt lgkmcnt(0)
    s_nop 7
    s_branch L_fbr_w0
L_rec_done_w0:
    s_waitcnt vmcnt(0)
    s_endpgm
L_rec_w1:
    v_add_u32 v1, 147456, v0
    v_bfe_u32 v10, v0, 7, 1
    v_lshl_add_u32 v10, v10, 3, v5
    s_mov_b32 s4, 0xff00ff00
    s_mov_b32 s5, 0xff00ff00
    s_mov_b32 s45, 1
    s_mov_b32 s46, 0x000f000f
    s_mov_b32 s47, 0x000f000f
    s_mov_b32 s40, 1574912
    s_mov_b32 s12, s72
    s_and_b32 s13, s73, 0xffff
    s_mov_b32 s14, 8192
    s_mov_b32 s15, 0x00020000
    buffer_load_dword v24, v15, s[12:15], 0 offen offset:256
    buffer_load_dword v25, v15, s[12:15], 0 offen offset:272
    buffer_load_dword v26, v15, s[12:15], 0 offen offset:288
    buffer_load_dword v27, v15, s[12:15], 0 offen offset:304
    buffer_load_dword v28, v15, s[12:15], 0 offen offset:264
    buffer_load_dword v29, v15, s[12:15], 0 offen offset:280
    buffer_load_dword v30, v15, s[12:15], 0 offen offset:296
    buffer_load_dword v31, v15, s[12:15], 0 offen offset:312
    s_mov_b32 s20, 0
    s_mov_b32 s21, 0
    s_mov_b32 s27, 532480
    s_mov_b32 s28, 524288
    s_mov_b32 s29, 540672
    s_lshl_b32 s30, s19, 13
    s_add_u32 s30, s30, 33554432
    s_mov_b32 s32, 1048576
    s_cmp_eq_u32 s19, 0
    s_cselect_b32 s44, 0, 0x80
    s_waitcnt vmcnt(8) lgkmcnt(0)
    v_mov_b64 v[120:121], 0
    v_mov_b64 v[122:123], 0
    v_mov_b64 v[124:125], 0
    v_mov_b64 v[126:127], 0
    v_mov_b64 v[128:129], 0
    v_mov_b64 v[130:131], 0
    v_mov_b64 v[132:133], 0
    v_mov_b64 v[134:135], 0
    v_mov_b64 v[136:137], 0
    v_mov_b64 v[138:139], 0
    v_mov_b64 v[140:141], 0
    v_mov_b64 v[142:143], 0
    s_add_u32 s22, s21, 4096
    s_lshl_b32 s37, s19, 13
    s_add_u32 s37, s21, s37
    s_add_u32 s23, s37, 2048
    s_xor_b32 s24, s23, 0x40000
    s_add_u32 s31, s30, 17041408
    s_add_u32 s41, s30, 17301504
    s_add_u32 s37, s30, 16779264
    buffer_load_dwordx4 v[112:115], v0, s[8:11], s37 offen sc1
    buffer_load_dwordx4 v[116:119], v0, s[8:11], s37 offen offset:1024 sc1
    s_waitcnt vmcnt(0)
    s_waitcnt lgkmcnt(0)
    v_lshlrev_b32 v15, 3, v0
    v_mov_b32 v13, -1
    s_mov_b32 s36, 0x7fffffff
    s_barrier
.p2align 6
L_top_w1:
    s_waitcnt vmcnt(3)
L_top_w1_nw:
    v_cmp_eq_u32 vcc, -1, v27
    v_smfmac_f32_16x16x64_bf16 v[120:123], v[24:27], v[104:111], v11
    ds_write_b128 v0, v[24:27] offset:2048
    v_smfmac_f32_16x16x64_bf16 v[124:127], v[24:27], v[56:63], v11
    s_cbranch_vccnz L_retry_w1_0
L_go_w1_0:
    v_smfmac_f32_16x16x64_bf16 v[128:131], v[24:27], v[80:87], v11
    v_smfmac_f32_16x16x64_bf16 v[132:135], v[24:27], v[88:95], v11
    s_waitcnt lgkmcnt(0)
    s_barrier
    v_smfmac_f32_16x16x64_bf16 v[136:139], v[24:27], a[152:159], v11
    ds_read_b128 v[32:35], v0 offset:4096
    s_waitcnt vmcnt(2)
    v_cmp_eq_u32 vcc, -1, v31
    v_smfmac_f32_16x16x64_bf16 v[140:143], v[24:27], a[160:167], v11
    ds_write_b128 v0, v[28:31] offset:3072
    s_cbranch_vccnz L_retry_w1
L_go_w1:
    v_smfmac_f32_16x16x64_bf16 v[120:123], v[28:31], v[64:71], v11
    ds_read_b128 v[40:43], v0 offset:6144
    v_smfmac_f32_16x16x64_bf16 v[124:127], v[28:31], v[72:79], v11
    buffer_load_dwordx4 v[104:107], v9, s[8:11], s30 offen sc1
    v_smfmac_f32_16x16x64_bf16 v[128:131], v[28:31], v[96:103], v11
    ds_read_b128 v[48:51], v0 offset:0
    v_smfmac_f32_16x16x64_bf16 v[132:135], v[28:31], a[96:103], v11
    buffer_load_dwordx4 v[108:111], v9, s[8:11], s30 offen offset:1024 sc1
    s_waitcnt lgkmcnt(3)
    v_smfmac_f32_16x16x64_bf16 v[120:123], v[32:35], a[0:7], v11
    s_waitcnt lgkmcnt(2)
    s_barrier
    ds_read_b128 v[36:39], v0 offset:5120
    v_smfmac_f32_16x16x64_bf16 v[124:127], v[32:35], a[8:15], v11
    ds_read_b128 v[56:59], v0 offset:51200
    s_waitcnt lgkmcnt(3)
    v_smfmac_f32_16x16x64_bf16 v[120:123], v[40:43], a[32:39], v11
    ds_read_b128 v[44:47], v0 offset:7168
    v_smfmac_f32_16x16x64_bf16 v[124:127], v[40:43], a[40:47], v11
    buffer_store_dword v54, v8, s[8:11], s32 offen sc1
    s_waitcnt lgkmcnt(3)
    v_smfmac_f32_16x16x64_bf16 v[120:123], v[48:51], a[64:71], v11
    ds_read_b128 v[52:55], v0 offset:1024
    v_smfmac_f32_16x16x64_bf16 v[124:127], v[48:51], a[72:79], v11
    ds_read_b128 v[60:63], v0 offset:52224
    s_waitcnt lgkmcnt(4)
    v_smfmac_f32_16x16x64_bf16 v[120:123], v[36:39], a[16:23], v11
    ds_read_b128 v[64:67], v0 offset:53248
    buffer_store_dword v13, v0, s[8:11], s24 offen offset:0
    v_smfmac_f32_16x16x64_bf16 v[124:127], v[36:39], a[24:31], v11
    ds_read_b128 v[68:71], v0 offset:54272
    s_waitcnt lgkmcnt(4)
    v_smfmac_f32_16x16x64_bf16 v[120:123], v[44:47], a[48:55], v11
    ds_read_b128 v[72:75], v0 offset:55296
    buffer_store_dword v13, v0, s[8:11], s24 offen offset:1024
    v_smfmac_f32_16x16x64_bf16 v[124:127], v[44:47], a[56:63], v11
    ds_read_b128 v[76:79], v0 offset:56320
    s_waitcnt lgkmcnt(5)
    v_smfmac_f32_16x16x64_bf16 v[120:123], v[52:55], a[80:87], v11
    ds_read_b128 v[80:83], v1 offset:0
    buffer_store_dword v13, v8, s[8:11], s29 offen
    v_smfmac_f32_16x16x64_bf16 v[124:127], v[52:55], a[88:95], v11
    ds_read_b128 v[84:87], v1 offset:1024
    v_smfmac_f32_16x16x64_bf16 v[128:131], v[44:47], a[104:111], v11
    ds_read_b128 v[88:91], v1 offset:2048
    v_smfmac_f32_16x16x64_bf16 v[132:135], v[44:47], a[112:119], v11
    ds_read_b128 v[92:95], v1 offset:3072
    v_permlane32_swap_b32 v120, v122
    v_permlane32_swap_b32 v121, v123
    s_waitcnt lgkmcnt(2)
    v_smfmac_f32_16x16x64_bf16 v[128:131], v[32:35], v[56:63], v11
    ds_read_b128 v[96:99], v1 offset:4096
    v_permlane32_swap_b32 v124, v126
    v_permlane32_swap_b32 v125, v127
    v_smfmac_f32_16x16x64_bf16 v[132:135], v[32:35], v[64:71], v11
    ds_read_b128 v[100:103], v1 offset:5120
    v_add_f32 v120, v120, v122
    v_add_f32 v124, v124, v126
    v_cvt_pk_bf16_f32 v12, v120, v124
    v_smfmac_f32_16x16x64_bf16 v[128:131], v[36:39], v[72:79], v11
    ds_write_b32 v2, v12 offset:10304
    v_add_f32 v121, v121, v123
    v_add_f32 v125, v125, v127
    v_cvt_pk_bf16_f32 v13, v121, v125
    v_smfmac_f32_16x16x64_bf16 v[132:135], v[36:39], v[80:87], v11
    ds_write_b32 v2, v13 offset:10688
    s_waitcnt lgkmcnt(2)
    v_smfmac_f32_16x16x64_bf16 v[128:131], v[40:43], v[88:95], v11
    v_smfmac_f32_16x16x64_bf16 v[132:135], v[40:43], v[96:103], v11
    v_smfmac_f32_16x16x64_bf16 v[128:131], v[48:51], a[120:127], v11
    v_smfmac_f32_16x16x64_bf16 v[132:135], v[48:51], a[128:135], v11
    s_waitcnt lgkmcnt(0)
    s_barrier
    ds_read_b128 v[56:59], v4 offset:0
    v_smfmac_f32_16x16x64_bf16 v[128:131], v[52:55], a[136:143], v11
    ds_read_b128 v[60:63], v4 offset:64
    v_smfmac_f32_16x16x64_bf16 v[132:135], v[52:55], a[144:151], v11
    ds_read_b128 v[64:67], v3 offset:0
    v_smfmac_f32_16x16x64_bf16 v[136:139], v[28:31], a[168:175], v11
    ds_read_b128 v[68:71], v3 offset:64
    v_smfmac_f32_16x16x64_bf16 v[140:143], v[28:31], a[176:183], v11
    ds_read_b128 v[72:75], v3 offset:128
    s_waitcnt vmcnt(4)
    s_waitcnt lgkmcnt(3)
    v_mfma_f32_16x16x32_bf16 v[96:99], v[104:107], v[56:59], 0.5
    v_cvt_pk_bf16_f32 v128, v128, v132
    v_cvt_pk_bf16_f32 v129, v129, v133
    v_mfma_f32_16x16x32_bf16 v[96:99], v[108:111], v[60:63], v[96:99]
    ds_write2_b32 v2, v128, v129 offset0:0 offset1:80
    v_cvt_pk_bf16_f32 v130, v130, v134
    v_cvt_pk_bf16_f32 v131, v131, v135
    v_smfmac_f32_16x16x64_bf16 v[136:139], v[32:35], a[184:191], v11
    ds_write2_b32 v2, v130, v131 offset0:160 offset1:240
    ds_read_b128 v[76:79], v3 offset:192
    v_smfmac_f32_16x16x64_bf16 v[140:143], v[32:35], a[192:199], v11
    s_nop 0
    s_cmp_ge_u32 s44, 0x80
    s_cbranch_scc1 L_kvi_2
    v_bfe_u32 v13, v0, 2, 4
    global_load_dword v13, v13, s[16:17] offset:136 sc1
L_kvi_2:
    v_permlane32_swap_b32 v96, v98
    v_smfmac_f32_16x16x64_bf16 v[136:139], v[36:39], a[200:207], v11
    v_permlane32_swap_b32 v97, v99
    v_smfmac_f32_16x16x64_bf16 v[140:143], v[36:39], a[208:215], v11
    v_add_f32_dpp v96, v98, v96 row_ror:8 row_mask:0xf bank_mask:0xf
    v_add_f32_dpp v97, v99, v97 row_ror:8 row_mask:0xf bank_mask:0xf
    v_exp_f32 v96, v96
    s_waitcnt lgkmcnt(1)
    s_barrier
    v_smfmac_f32_16x16x64_bf16 v[136:139], v[40:43], a[216:223], v11
    ds_read_b128 v[80:83], v14 offset:0
    v_exp_f32 v97, v97
    v_smfmac_f32_16x16x64_bf16 v[140:143], v[40:43], a[224:231], v11
    ds_read_b128 v[84:87], v14 offset:64
    v_cvt_pk_bf16_f32 v96, v96, v97
    v_smfmac_f32_16x16x64_bf16 v[136:139], v[44:47], a[232:239], v11
    ds_read_b128 v[88:91], v14 offset:128
    v_smfmac_f32_16x16x64_bf16 v[140:143], v[44:47], a[240:247], v11
    ds_read_b128 v[92:95], v14 offset:192
    ds_write_b32 v6, v96
    s_waitcnt lgkmcnt(4)
    v_mfma_f32_16x16x32_bf16 v[104:107], v[80:83], v[64:67], 0
    v_mov_b64 v[56:57], 0
    s_waitcnt lgkmcnt(3)
    v_mfma_f32_16x16x32_bf16 v[104:107], v[84:87], v[68:71], v[104:107]
    v_mov_b64 v[58:59], 0
    s_waitcnt lgkmcnt(2)
    v_mfma_f32_16x16x32_bf16 v[104:107], v[88:91], v[72:75], v[104:107]
    v_mov_b64 v[60:61], 0
    s_waitcnt lgkmcnt(1)
    v_mfma_f32_16x16x32_bf16 v[104:107], v[92:95], v[76:79], v[104:107]
    s_waitcnt lgkmcnt(0)
    s_barrier
    v_smfmac_f32_16x16x64_bf16 v[136:139], v[48:51], a[248:255], v11
    ds_read_b128 v[100:103], v5
    v_mov_b64 v[62:63], 0
    v_smfmac_f32_16x16x64_bf16 v[140:143], v[48:51], v[144:151], v11
    s_nop 1
    v_permlane32_swap_b32 v104, v106
    v_smfmac_f32_16x16x64_bf16 v[136:139], v[52:55], v[152:159], v11
    ds_read_b128 v[64:67], v1 offset:6144
    v_permlane32_swap_b32 v105, v107
    v_smfmac_f32_16x16x64_bf16 v[140:143], v[52:55], v[160:167], v11
    ds_read_b128 v[68:71], v1 offset:7168
    v_add_f32 v104, v104, v106
    v_add_f32 v105, v105, v107
    s_waitcnt lgkmcnt(2)
    v_mfma_f32_16x16x32_bf16 v[108:111], v[16:19], v[100:103], 0
    v_mul_f32 v104, s34, v104
    v_mul_f32 v105, s34, v105
    v_mfma_f32_16x16x32_bf16 v[120:123], v[112:115], v[100:103], 0
    v_exp_f32 v106, v104
    v_mfma_f32_16x16x32_bf16 v[124:127], v[116:119], v[100:103], 0
    v_exp_f32 v107, v105
    s_nop 0
    v_cvt_pk_bf16_f32 v104, v106, v107
    v_cvt_pk_bf16_f32 v105, v106, v107
    v_cvt_pk_bf16_f32 v128, v136, v137
    v_cvt_pk_bf16_f32 v129, v138, v139
    v_permlane32_swap_b32 v104, v105
    v_mov_b64 v[132:133], 0
    v_mov_b64 v[134:135], 0
    v_mfma_f32_16x16x16_bf16 v[108:111], v[16:17], v[104:105], v[108:111]
    v_cvt_pk_bf16_f32 v130, v140, v141
    v_cvt_pk_bf16_f32 v131, v142, v143
    v_mfma_f32_16x16x16_bf16 v[120:123], v[128:129], v[104:105], v[120:123]
    v_mov_b64 v[96:97], 0
    v_mov_b64 v[98:99], 0
    v_mfma_f32_16x16x16_bf16 v[124:127], v[130:131], v[104:105], v[124:127]
    ds_read_b128 v[72:75], v1 offset:8192
    s_nop 0
    v_rcp_f32 v12, v108
    v_add_u32 v15, 3565158400, v108
    v_cmp_lt_u32 vcc, s42, v15
L_fbr_w1:
    v_mul_f32 v120, v120, v12
    v_mul_f32 v121, v121, v12
    v_mul_f32 v122, v122, v12
    v_mul_f32 v123, v123, v12
    v_pk_mul_f32 v[124:125], v[124:125], v[12:13] op_sel_hi:[1,0]
    v_pk_mul_f32 v[126:127], v[126:127], v[12:13] op_sel_hi:[1,0]
    v_cvt_pk_bf16_f32 v40, v120, v124
    v_cvt_pk_bf16_f32 v42, v122, v126
    v_cvt_pk_bf16_f32 v41, v121, v125
    v_cvt_pk_bf16_f32 v43, v123, v127
    v_cndmask_b32 v120, v40, v42, s[4:5]
    v_cndmask_b32 v121, v41, v43, s[4:5]
    s_cbranch_vccnz L_fb_w1
    ds_write_b64 v10, v[120:121] offset:1536
    v_smfmac_f32_16x16x64_bf16 v[56:59], v[40:43], v[168:175], v11
    buffer_load_dwordx4 v[112:115], v0, s[8:11], s31 offen sc1
    v_mov_b64 v[136:137], 0
    v_smfmac_f32_16x16x64_bf16 v[60:63], v[40:43], v[176:183], v11
    v_mov_b64 v[138:139], 0
    v_smfmac_f32_16x16x64_bf16 v[132:135], v[40:43], v[184:191], v11
    v_mov_b64 v[140:141], 0
    s_waitcnt lgkmcnt(0)
    s_barrier
    ds_read_b128 v[44:47], v5 offset:2048
    v_mov_b64 v[142:143], 0
    ds_read_b128 v[48:51], v5 offset:2560
    ds_read_b128 v[52:55], v5 offset:1024
    v_smfmac_f32_16x16x64_bf16 v[96:99], v[40:43], v[192:199], v11
    buffer_load_dwordx4 v[116:119], v0, s[8:11], s31 offen offset:1024 sc1
    ds_read_b128 v[76:79], v1 offset:9216
    v_mov_b64 v[120:121], 0
    s_add_u32 s20, s20, 1
    s_waitcnt lgkmcnt(3)
    v_smfmac_f32_16x16x64_bf16 v[56:59], v[44:47], v[200:207], v11
    ds_read_b128 v[80:83], v1 offset:10240
    v_smfmac_f32_16x16x64_bf16 v[60:63], v[44:47], v[208:215], v11
    ds_read_b128 v[84:87], v1 offset:11264
    s_waitcnt lgkmcnt(4)
    v_smfmac_f32_16x16x64_bf16 v[56:59], v[48:51], v[224:231], v11
    ds_read_b128 v[88:91], v1 offset:12288
    v_smfmac_f32_16x16x64_bf16 v[60:63], v[48:51], v[232:239], v11
    ds_read_b128 v[92:95], v1 offset:13312
    s_waitcnt lgkmcnt(5)
    v_smfmac_f32_16x16x64_bf16 v[56:59], v[52:55], v[240:247], v11
    ds_read_b128 v[24:27], v1 offset:14336
    v_smfmac_f32_16x16x64_bf16 v[60:63], v[52:55], v[248:255], v11
    ds_read_b128 v[28:31], v1 offset:15360
    v_smfmac_f32_16x16x64_bf16 v[132:135], v[44:47], v[216:223], v11
    s_add_u32 s40, s27, 2048
    s_add_u32 s32, s32, 8192
    s_mov_b32 s37, s29
    v_smfmac_f32_16x16x64_bf16 v[96:99], v[44:47], v[64:71], v11
    s_mov_b32 s29, s28
    s_waitcnt lgkmcnt(4)
    v_cvt_pk_bf16_f32 v32, v56, v60
    v_smfmac_f32_16x16x64_bf16 v[132:135], v[48:51], v[72:79], v11
    v_cvt_pk_bf16_f32 v33, v57, v61
    v_cvt_pk_bf16_f32 v34, v58, v62
    v_cvt_pk_bf16_f32 v35, v59, v63
    v_smfmac_f32_16x16x64_bf16 v[96:99], v[48:51], v[80:87], v11
    buffer_store_dwordx4 v[32:35], v7, s[8:11], s21 offen
    s_waitcnt lgkmcnt(0)
    v_smfmac_f32_16x16x64_bf16 v[132:135], v[52:55], v[88:95], v11
    v_smfmac_f32_16x16x64_bf16 v[96:99], v[52:55], v[24:31], v11
    s_mov_b32 s28, s27
    s_mov_b32 s27, s37
    s_add_u32 s30, s30, 262144
    v_mov_b64 v[122:123], 0
    v_mov_b64 v[124:125], 0
    v_mov_b64 v[126:127], 0
    s_nop 1
    v_cvt_pk_bf16_f32 v36, v132, v96
    v_cvt_pk_bf16_f32 v37, v133, v97
    v_cvt_pk_bf16_f32 v38, v134, v98
    v_cvt_pk_bf16_f32 v39, v135, v99
    buffer_store_dwordx4 v[36:39], v7, s[8:11], s22 offen
    s_cmp_ge_u32 s44, 0x80
    s_cbranch_scc1 L_kv_3_ok
    s_add_u32 s37, s20, 2
    s_mov_b32 s36, 0
    s_waitcnt vmcnt(3)
L_kv_3:
    v_cmp_gt_u32 vcc, 0x80, v13
    s_add_u32 s36, s36, 1
    s_or_b32 s38, vcc_lo, 0x10
    s_ff1_i32_b32 s38, s38
    s_mul_i32 s38, s38, 6
    s_lshr_b32 s44, 539508800, s38
    s_and_b32 s44, s44, 63
    s_lshl_b32 s44, s44, 2
    s_cmp_ge_u32 s36, 200000
    s_cbranch_scc1 L_kv_3_ok
    s_cmp_lt_u32 s37, s44
    s_cbranch_scc1 L_kv_3_ok
    v_bfe_u32 v13, v0, 2, 4
    global_load_dword v13, v13, s[16:17] offset:136 sc1
    s_waitcnt vmcnt(0)
    s_branch L_kv_3
L_kv_3_ok:
    s_mov_b32 s25, s23
    s_barrier
    ds_read_b128 v[56:59], v0 offset:36864
    ds_read_b128 v[60:63], v0 offset:37888
    s_waitcnt lgkmcnt(0)
    ds_read_b128 v[64:67], v0 offset:38912
    ds_read_b128 v[68:71], v0 offset:39936
    s_waitcnt lgkmcnt(0)
    s_xor_b32 s21, s21, 0x40000
    s_add_u32 s45, s20, 1
    s_add_u32 s22, s21, 4096
    s_lshl_b32 s37, s19, 13
    s_add_u32 s37, s21, s37
    buffer_load_dwordx4 v[40:43], v0, s[8:11], s25 offen offset:0 sc1
    buffer_load_dwordx4 v[44:47], v0, s[8:11], s25 offen offset:1024 sc1
    ds_read_b128 v[72:75], v0 offset:40960
    ds_read_b128 v[76:79], v0 offset:41984
    s_waitcnt lgkmcnt(0)
    ds_read_b128 v[80:83], v0 offset:43008
    ds_read_b128 v[84:87], v0 offset:44032
    s_waitcnt lgkmcnt(0)
    buffer_load_dwordx4 v[40:43], v0, s[8:11], s25 offen offset:0 sc1
    buffer_load_dwordx4 v[44:47], v0, s[8:11], s25 offen offset:1024 sc1
    ds_read_b128 v[88:91], v0 offset:45056
    ds_read_b128 v[92:95], v0 offset:46080
    ds_read_b128 v[96:99], v0 offset:47104
    ds_read_b128 v[100:103], v0 offset:48128
    s_waitcnt lgkmcnt(0)
    s_mov_b32 s36, 0
L_red_4_w:
    s_waitcnt vmcnt(2)
    v_max_u32 v12, v40, v44
    v_cmp_eq_u32 vcc, -1, v12
L_red_4_m:
    v_mfma_f32_16x16x32_bf16 v[52:55], v[20:23], v[40:43], 0
    v_mfma_f32_16x16x32_bf16 v[52:55], v[20:23], v[44:47], v[52:55]
    s_cmp_eq_u32 s20, 63
    s_nop 2
    s_cbranch_vccnz L_red_4_e
    s_nop 2
    v_add_f32_dpp v52, v52, v52 row_ror:4 row_mask:0xf bank_mask:0xf
    v_add_f32_dpp v53, v53, v53 row_ror:4 row_mask:0xf bank_mask:0xf
    s_nop 0
    v_add_f32_dpp v52, v52, v52 row_ror:8 row_mask:0xf bank_mask:0xf
    v_add_f32_dpp v53, v53, v53 row_ror:8 row_mask:0xf bank_mask:0xf
    v_cvt_pk_bf16_f32 v54, v52, v53
    buffer_store_dword v54, v8, s[8:11], s28 offen
    s_cbranch_scc0 L_rec_on_w1
    buffer_store_dword v54, v8, s[8:11], s32 offen sc1
    s_branch L_rec_done_w1
L_rec_on_w1:
    s_mov_b32 s36, 0
    s_add_u32 s23, s37, 2048
    s_xor_b32 s24, s23, 0x40000
    s_add_u32 s31, s30, 17041408
    s_add_u32 s41, s30, 17301504
    s_barrier
    buffer_load_dwordx4 v[24:27], v0, s[8:11], s40 offen offset:0 sc1
    ds_read_b128 v[104:107], v0 offset:49152
    s_waitcnt lgkmcnt(0)
    buffer_load_dwordx4 v[28:31], v0, s[8:11], s40 offen offset:1024 sc1
    v_mov_b64 v[128:129], 0
    v_mov_b64 v[130:131], 0
    v_mov_b64 v[132:133], 0
    v_mov_b64 v[134:135], 0
    v_lshlrev_b32 v15, 3, v0
    v_mov_b32 v13, -1
    buffer_load_dwordx4 v[24:27], v0, s[8:11], s40 offen offset:0 sc1
    ds_read_b128 v[108:111], v0 offset:50176
    s_waitcnt lgkmcnt(0)
    buffer_load_dwordx4 v[28:31], v0, s[8:11], s40 offen offset:1024 sc1
    s_branch L_top_w1
L_red_4_e:
    s_mov_b64 exec, vcc
    buffer_load_dwordx4 v[40:43], v0, s[8:11], s25 offen offset:0 sc1
    buffer_load_dwordx4 v[44:47], v0, s[8:11], s25 offen offset:1024 sc1
    s_mov_b64 exec, -1
    s_add_u32 s36, s36, 1
    s_cmp_lt_u32 s36, 30000
    s_cbranch_scc1 L_red_4_w
    s_mov_b64 vcc, 0
    s_branch L_red_4_m
L_retry_w1:
    s_mov_b64 exec, vcc
    buffer_load_dwordx4 v[28:31], v0, s[8:11], s40 offen offset:1024 sc1
    s_mov_b64 exec, -1
    s_add_u32 s36, s36, 1
    s_cmp_lt_u32 s36, 30000
    s_waitcnt vmcnt(3)
    v_cmp_eq_u32 vcc, -1, v31
    ds_write_b128 v0, v[28:31] offset:3072
    s_cbranch_scc0 L_go_w1
    s_cbranch_vccnz L_retry_w1
    s_branch L_go_w1
L_retry_w1_0:
    s_mov_b64 exec, vcc
    buffer_load_dwordx4 v[24:27], v0, s[8:11], s40 offen offset:0 sc1
    s_mov_b64 exec, -1
    buffer_load_dwordx4 v[28:31], v0, s[8:11], s40 offen offset:1024 sc1
    s_add_u32 s36, s36, 1
    s_cmp_lt_u32 s36, 30000
    s_cbranch_scc0 L_go_w1_0
    v_mov_b64 v[120:121], 0
    v_mov_b64 v[122:123], 0
    v_mov_b64 v[124:125], 0
    v_mov_b64 v[126:127], 0
    s_waitcnt vmcnt(3)
    s_branch L_top_w1_nw
L_fb_w1:
    s_waitcnt lgkmcnt(0)
    s_add_u32 s37, s30, 4096
    buffer_load_dwordx4 v[24:27], v0, s[8:11], s30 offen offset:0 sc1
    buffer_load_dwordx4 v[28:31], v0, s[8:11], s30 offen offset:1024 sc1
    buffer_load_dwordx4 v[32:35], v0, s[8:11], s30 offen offset:2048 sc1
    buffer_load_dwordx4 v[36:39], v0, s[8:11], s30 offen offset:3072 sc1
    buffer_load_dwordx4 v[40:43], v0, s[8:11], s37 offen offset:0 sc1
    buffer_load_dwordx4 v[44:47], v0, s[8:11], s37 offen offset:1024 sc1
    buffer_load_dwordx4 v[48:51], v0, s[8:11], s37 offen offset:2048 sc1
    buffer_load_dwordx4 v[52:55], v0, s[8:11], s37 offen offset:3072 sc1
    ds_read_b128 v[64:67], v3 offset:0
    ds_read_b128 v[80:83], v14 offset:0
    ds_read_b128 v[68:71], v3 offset:64
    ds_read_b128 v[84:87], v14 offset:64
    ds_read_b128 v[72:75], v3 offset:128
    ds_read_b128 v[88:91], v14 offset:128
    ds_read_b128 v[76:79], v3 offset:192
    ds_read_b128 v[92:95], v14 offset:192
    s_waitcnt vmcnt(0) lgkmcnt(0)
    v_mfma_f32_16x16x32_bf16 v[56:59], v[24:27], v[64:67], 0
    v_mfma_f32_16x16x32_bf16 v[60:63], v[40:43], v[64:67], 0
    v_mfma_f32_16x16x32_bf16 v[104:107], v[80:83], v[64:67], 0
    v_mfma_f32_16x16x32_bf16 v[56:59], v[28:31], v[68:71], v[56:59]
    v_mfma_f32_16x16x32_bf16 v[60:63], v[44:47], v[68:71], v[60:63]
    v_mfma_f32_16x16x32_bf16 v[104:107], v[84:87], v[68:71], v[104:107]
    v_mfma_f32_16x16x32_bf16 v[56:59], v[32:35], v[72:75], v[56:59]
    v_mfma_f32_16x16x32_bf16 v[60:63], v[48:51], v[72:75], v[60:63]
    v_mfma_f32_16x16x32_bf16 v[104:107], v[88:91], v[72:75], v[104:107]
    v_mfma_f32_16x16x32_bf16 v[56:59], v[36:39], v[76:79], v[56:59]
    v_mfma_f32_16x16x32_bf16 v[60:63], v[52:55], v[76:79], v[60:63]
    v_mfma_f32_16x16x32_bf16 v[104:107], v[92:95], v[76:79], v[104:107]
    s_nop 7
    v_permlane32_swap_b32 v104, v106
    v_permlane32_swap_b32 v105, v107
    v_add_f32 v104, v104, v106
    v_add_f32 v105, v105, v107
    v_mul_f32 v104, s34, v104
    v_mul_f32 v105, s34, v105
    v_max3_f32 v12, v56, v57, v58
    v_max3_f32 v12, v12, v59, v60
    v_max3_f32 v12, v12, v61, v62
    v_max3_f32 v12, v12, v63, v104
    v_max_f32 v12, v12, v105
    v_mov_b32 v13, v12
    s_nop 1
    v_permlane16_swap_b32 v12, v13
    v_max_f32 v12, v12, v13
    v_mov_b32 v13, v12
    s_nop 1
    v_permlane32_swap_b32 v12, v13
    v_max_f32 v12, v12, v13
    v_add_f32 v13, -1.0, v12
    v_sub_f32 v56, v56, v13
    v_exp_f32 v56, v56
    v_sub_f32 v57, v57, v13
    v_exp_f32 v57, v57
    v_sub_f32 v58, v58, v13
    v_exp_f32 v58, v58
    v_sub_f32 v59, v59, v13
    v_exp_f32 v59, v59
    v_sub_f32 v60, v60, v13
    v_exp_f32 v60, v60
    v_sub_f32 v61, v61, v13
    v_exp_f32 v61, v61
    v_sub_f32 v62, v62, v13
    v_exp_f32 v62, v62
    v_sub_f32 v63, v63, v13
    v_exp_f32 v63, v63
    v_sub_f32 v104, v104, v12
    v_exp_f32 v104, v104
    v_sub_f32 v105, v105, v12
    v_exp_f32 v105, v105
    v_cvt_pk_bf16_f32 v100, v56, v57
    v_cvt_pk_bf16_f32 v101, v58, v59
    v_cvt_pk_bf16_f32 v102, v60, v61
    v_cvt_pk_bf16_f32 v103, v62, v63
    v_cvt_pk_bf16_f32 v104, v104, v105
    v_mov_b32 v105, v104
    s_nop 1
    v_permlane32_swap_b32 v104, v105
    v_mfma_f32_16x16x32_bf16 v[108:111], v[16:19], v[100:103], 0
    v_mfma_f32_16x16x32_bf16 v[120:123], v[112:115], v[100:103], 0
    v_mfma_f32_16x16x32_bf16 v[124:127], v[116:119], v[100:103], 0
    v_mfma_f32_16x16x16_bf16 v[108:111], v[16:17], v[104:105], v[108:111]
    v_mfma_f32_16x16x16_bf16 v[120:123], v[128:129], v[104:105], v[120:123]
    v_mfma_f32_16x16x16_bf16 v[124:127], v[130:131], v[104:105], v[124:127]
    ds_read_b128 v[64:67], v1 offset:6144
    ds_read_b128 v[68:71], v1 offset:7168
    ds_read_b128 v[72:75], v1 offset:8192
    v_mov_b64 v[56:57], 0
    v_mov_b64 v[58:59], 0
    v_mov_b64 v[60:61], 0
    v_mov_b64 v[62:63], 0
    v_mov_b64 v[132:133], 0
    v_mov_b64 v[134:135], 0
    v_mov_b64 v[96:97], 0
    v_mov_b64 v[98:99], 0
    s_mov_b64 vcc, 0
    v_mov_b32 v13, 0
    v_rcp_f32 v12, v108
    s_waitcnt lgkmcnt(0)
    s_nop 7
    s_branch L_fbr_w1
L_rec_done_w1:
    s_waitcnt vmcnt(0)
    s_endpgm
L_rec_w2:
    v_add_u32 v1, 57344, v0
    v_bfe_u32 v10, v0, 7, 1
    v_lshl_add_u32 v10, v10, 3, v5
    s_mov_b32 s4, 0xff00ff00
    s_mov_b32 s5, 0xff00ff00
    s_mov_b32 s45, 1
    s_mov_b32 s46, 0x000f000f
    s_mov_b32 s47, 0x000f000f
    s_mov_b32 s40, 1576960
    s_mov_b32 s12, s72
    s_and_b32 s13, s73, 0xffff
    s_mov_b32 s14, 8192
    s_mov_b32 s15, 0x00020000
    buffer_load_dword v24, v15, s[12:15], 0 offen offset:512
    buffer_load_dword v25, v15, s[12:15], 0 offen offset:528
    buffer_load_dword v26, v15, s[12:15], 0 offen offset:544
    buffer_load_dword v27, v15, s[12:15], 0 offen offset:560
    buffer_load_dword v28, v15, s[12:15], 0 offen offset:520
    buffer_load_dword v29, v15, s[12:15], 0 offen offset:536
    buffer_load_dword v30, v15, s[12:15], 0 offen offset:552
    buffer_load_dword v31, v15, s[12:15], 0 offen offset:568
    s_mov_b32 s20, 0
    s_mov_b32 s21, 0
    s_mov_b32 s27, 532480
    s_mov_b32 s28, 524288
    s_mov_b32 s29, 540672
    s_lshl_b32 s30, s19, 13
    s_add_u32 s30, s30, 33554432
    s_mov_b32 s32, 1048576
    s_cmp_eq_u32 s19, 0
    s_cselect_b32 s44, 0, 0x80
    s_waitcnt vmcnt(8) lgkmcnt(0)
    v_mov_b64 v[120:121], 0
    v_mov_b64 v[122:123], 0
    v_mov_b64 v[124:125], 0
    v_mov_b64 v[126:127], 0
    v_mov_b64 v[128:129], 0
    v_mov_b64 v[130:131], 0
    v_mov_b64 v[132:133], 0
    v_mov_b64 v[134:135], 0
    v_mov_b64 v[136:137], 0
    v_mov_b64 v[138:139], 0
    v_mov_b64 v[140:141], 0
    v_mov_b64 v[142:143], 0
    s_add_u32 s22, s21, 4096
    s_lshl_b32 s37, s19, 13
    s_add_u32 s37, s21, s37
    s_add_u32 s23, s37, 4096
    s_xor_b32 s24, s23, 0x40000
    s_add_u32 s31, s30, 17043456
    s_add_u32 s41, s30, 262144
    s_add_u32 s37, s30, 16781312
    buffer_load_dwordx4 v[112:115], v0, s[8:11], s37 offen sc1
    buffer_load_dwordx4 v[116:119], v0, s[8:11], s37 offen offset:1024 sc1
    s_waitcnt vmcnt(0)
    s_waitcnt lgkmcnt(0)
    v_lshlrev_b32 v15, 3, v0
    v_mov_b32 v13, -1
    s_mov_b32 s36, 0x7fffffff
    s_barrier
.p2align 6
L_top_w2:
    s_waitcnt vmcnt(3)
L_top_w2_nw:
    v_cmp_eq_u32 vcc, -1, v27
    v_smfmac_f32_16x16x64_bf16 v[120:123], v[24:27], v[104:111], v11
    ds_write_b128 v0, v[24:27] offset:4096
    v_smfmac_f32_16x16x64_bf16 v[124:127], v[24:27], v[56:63], v11
    s_cbranch_vccnz L_retry_w2_0
L_go_w2_0:
    v_smfmac_f32_16x16x64_bf16 v[128:131], v[24:27], v[80:87], v11
    v_smfmac_f32_16x16x64_bf16 v[132:135], v[24:27], v[88:95], v11
    s_waitcnt lgkmcnt(0)
    s_barrier
    v_smfmac_f32_16x16x64_bf16 v[136:139], v[24:27], a[152:159], v11
    ds_read_b128 v[32:35], v0 offset:6144
    s_waitcnt vmcnt(2)
    v_cmp_eq_u32 vcc, -1, v31
    v_smfmac_f32_16x16x64_bf16 v[140:143], v[24:27], a[160:167], v11
    ds_write_b128 v0, v[28:31] offset:5120
    s_cbranch_vccnz L_retry_w2
L_go_w2:
    v_smfmac_f32_16x16x64_bf16 v[120:123], v[28:31], v[64:71], v11
    ds_read_b128 v[40:43], v0 offset:0
    v_smfmac_f32_16x16x64_bf16 v[124:127], v[28:31], v[72:79], v11
    buffer_load_dwordx4 v[104:107], v9, s[8:11], s30 offen sc1
    v_smfmac_f32_16x16x64_bf16 v[128:131], v[28:31], v[96:103], v11
    ds_read_b128 v[48:51], v0 offset:2048
    v_smfmac_f32_16x16x64_bf16 v[132:135], v[28:31], a[96:103], v11
    buffer_load_dwordx4 v[108:111], v9, s[8:11], s30 offen offset:1024 sc1
    s_waitcnt lgkmcnt(3)
    v_smfmac_f32_16x16x64_bf16 v[120:123], v[32:35], a[0:7], v11
    s_waitcnt lgkmcnt(2)
    s_barrier
    ds_read_b128 v[36:39], v0 offset:7168
    v_smfmac_f32_16x16x64_bf16 v[124:127], v[32:35], a[8:15], v11
    ds_read_b128 v[56:59], v1 offset:14336
    s_waitcnt lgkmcnt(3)
    v_smfmac_f32_16x16x64_bf16 v[120:123], v[40:43], a[32:39], v11
    ds_read_b128 v[44:47], v0 offset:1024
    buffer_load_dword v15, s[8:11], s41 offen sc1 lds
    v_smfmac_f32_16x16x64_bf16 v[124:127], v[40:43], a[40:47], v11
    buffer_store_dword v54, v8, s[8:11], s32 offen sc1
    s_waitcnt lgkmcnt(3)
    v_smfmac_f32_16x16x64_bf16 v[120:123], v[48:51], a[64:71], v11
    ds_read_b128 v[52:55], v0 offset:3072
    v_smfmac_f32_16x16x64_bf16 v[124:127], v[48:51], a[72:79], v11
    ds_read_b128 v[60:63], v1 offset:15360
    s_waitcnt lgkmcnt(4)
    v_smfmac_f32_16x16x64_bf16 v[120:123], v[36:39], a[16:23], v11
    ds_read_b128 v[64:67], v1 offset:16384
    buffer_store_dword v13, v0, s[8:11], s24 offen offset:0
    v_smfmac_f32_16x16x64_bf16 v[124:127], v[36:39], a[24:31], v11
    ds_read_b128 v[68:71], v1 offset:17408
    s_waitcnt lgkmcnt(4)
    v_smfmac_f32_16x16x64_bf16 v[120:123], v[44:47], a[48:55], v11
    ds_read_b128 v[72:75], v1 offset:18432
    buffer_store_dword v13, v0, s[8:11], s24 offen offset:1024
    v_smfmac_f32_16x16x64_bf16 v[124:127], v[44:47], a[56:63], v11
    ds_read_b128 v[76:79], v1 offset:19456
    s_waitcnt lgkmcnt(5)
    v_smfmac_f32_16x16x64_bf16 v[120:123], v[52:55], a[80:87], v11
    ds_read_b128 v[80:83], v1 offset:40960
    buffer_store_dword v13, v8, s[8:11], s29 offen
    v_smfmac_f32_16x16x64_bf16 v[124:127], v[52:55], a[88:95], v11
    ds_read_b128 v[84:87], v1 offset:41984
    v_smfmac_f32_16x16x64_bf16 v[128:131], v[44:47], a[104:111], v11
    ds_read_b128 v[88:91], v1 offset:43008
    v_smfmac_f32_16x16x64_bf16 v[132:135], v[44:47], a[112:119], v11
    ds_read_b128 v[92:95], v1 offset:44032
    v_permlane32_swap_b32 v120, v122
    v_permlane32_swap_b32 v121, v123
    s_waitcnt lgkmcnt(2)
    v_smfmac_f32_16x16x64_bf16 v[128:131], v[32:35], v[56:63], v11
    ds_read_b128 v[96:99], v1 offset:45056
    v_permlane32_swap_b32 v124, v126
    v_permlane32_swap_b32 v125, v127
    v_smfmac_f32_16x16x64_bf16 v[132:135], v[32:35], v[64:71], v11
    ds_read_b128 v[100:103], v1 offset:46080
    v_add_f32 v120, v120, v122
    v_add_f32 v124, v124, v126
    v_cvt_pk_bf16_f32 v12, v120, v124
    v_smfmac_f32_16x16x64_bf16 v[128:131], v[36:39], v[72:79], v11
    ds_write_b32 v2, v12 offset:10304
    v_add_f32 v121, v121, v123
    v_add_f32 v125, v125, v127
    v_cvt_pk_bf16_f32 v13, v121, v125
    v_smfmac_f32_16x16x64_bf16 v[132:135], v[36:39], v[80:87], v11
    ds_write_b32 v2, v13 offset:10688
    s_waitcnt lgkmcnt(2)
    v_smfmac_f32_16x16x64_bf16 v[128:131], v[40:43], v[88:95], v11
    v_smfmac_f32_16x16x64_bf16 v[132:135], v[40:43], v[96:103], v11
    v_smfmac_f32_16x16x64_bf16 v[128:131], v[48:51], a[120:127], v11
    v_smfmac_f32_16x16x64_bf16 v[132:135], v[48:51], a[128:135], v11
    s_waitcnt lgkmcnt(0)
    s_barrier
    ds_read_b128 v[56:59], v4 offset:0
    v_smfmac_f32_16x16x64_bf16 v[128:131], v[52:55], a[136:143], v11
    ds_read_b128 v[60:63], v4 offset:64
    v_smfmac_f32_16x16x64_bf16 v[132:135], v[52:55], a[144:151], v11
    ds_read_b128 v[64:67], v3 offset:0
    v_smfmac_f32_16x16x64_bf16 v[136:139], v[28:31], a[168:175], v11
    ds_read_b128 v[68:71], v3 offset:64
    v_smfmac_f32_16x16x64_bf16 v[140:143], v[28:31], a[176:183], v11
    ds_read_b128 v[72:75], v3 offset:128
    s_waitcnt vmcnt(5)
    s_waitcnt lgkmcnt(3)
    v_mfma_f32_16x16x32_bf16 v[96:99], v[104:107], v[56:59], 0.5
    v_cvt_pk_bf16_f32 v128, v128, v132
    v_cvt_pk_bf16_f32 v129, v129, v133
    v_mfma_f32_16x16x32_bf16 v[96:99], v[108:111], v[60:63], v[96:99]
    ds_write2_b32 v2, v128, v129 offset0:0 offset1:80
    v_cvt_pk_bf16_f32 v130, v130, v134
    v_cvt_pk_bf16_f32 v131, v131, v135
    v_smfmac_f32_16x16x64_bf16 v[136:139], v[32:35], a[184:191], v11
    ds_write2_b32 v2, v130, v131 offset0:160 offset1:240
    ds_read_b128 v[76:79], v3 offset:192
    v_smfmac_f32_16x16x64_bf16 v[140:143], v[32:35], a[192:199], v11
    s_nop 0
    v_permlane32_swap_b32 v96, v98
    v_smfmac_f32_16x16x64_bf16 v[136:139], v[36:39], a[200:207], v11
    v_permlane32_swap_b32 v97, v99
    v_smfmac_f32_16x16x64_bf16 v[140:143], v[36:39], a[208:215], v11
    v_add_f32_dpp v96, v98, v96 row_ror:8 row_mask:0xf bank_mask:0xf
    v_add_f32_dpp v97, v99, v97 row_ror:8 row_mask:0xf bank_mask:0xf
    v_exp_f32 v96, v96
    s_waitcnt lgkmcnt(1)
    s_barrier
    v_smfmac_f32_16x16x64_bf16 v[136:139], v[40:43], a[216:223], v11
    ds_read_b128 v[80:83], v14 offset:0
    v_exp_f32 v97, v97
    v_smfmac_f32_16x16x64_bf16 v[140:143], v[40:43], a[224:231], v11
    ds_read_b128 v[84:87], v14 offset:64
    v_cvt_pk_bf16_f32 v96, v96, v97
    v_smfmac_f32_16x16x64_bf16 v[136:139], v[44:47], a[232:239], v11
    ds_read_b128 v[88:91], v14 offset:128
    v_smfmac_f32_16x16x64_bf16 v[140:143], v[44:47], a[240:247], v11
    ds_read_b128 v[92:95], v14 offset:192
    ds_write_b32 v6, v96
    s_waitcnt lgkmcnt(4)
    v_mfma_f32_16x16x32_bf16 v[104:107], v[80:83], v[64:67], 0
    v_mov_b64 v[56:57], 0
    s_waitcnt lgkmcnt(3)
    v_mfma_f32_16x16x32_bf16 v[104:107], v[84:87], v[68:71], v[104:107]
    v_mov_b64 v[58:59], 0
    s_waitcnt lgkmcnt(2)
    v_mfma_f32_16x16x32_bf16 v[104:107], v[88:91], v[72:75], v[104:107]
    v_mov_b64 v[60:61], 0
    s_waitcnt lgkmcnt(1)
    v_mfma_f32_16x16x32_bf16 v[104:107], v[92:95], v[76:79], v[104:107]
    s_waitcnt lgkmcnt(0)
    s_barrier
    v_smfmac_f32_16x16x64_bf16 v[136:139], v[48:51], a[248:255], v11
    ds_read_b128 v[100:103], v5
    v_mov_b64 v[62:63], 0
    v_smfmac_f32_16x16x64_bf16 v[140:143], v[48:51], v[144:151], v11
    s_nop 1
    v_permlane32_swap_b32 v104, v106
    v_smfmac_f32_16x16x64_bf16 v[136:139], v[52:55], v[152:159], v11
    ds_read_b128 v[64:67], v1 offset:47104
    v_permlane32_swap_b32 v105, v107
    v_smfmac_f32_16x16x64_bf16 v[140:143], v[52:55], v[160:167], v11
    ds_read_b128 v[68:71], v1 offset:48128
    v_add_f32 v104, v104, v106
    v_add_f32 v105, v105, v107
    s_waitcnt lgkmcnt(2)
    v_mfma_f32_16x16x32_bf16 v[108:111], v[16:19], v[100:103], 0
    v_mul_f32 v104, s34, v104
    v_mul_f32 v105, s34, v105
    v_mfma_f32_16x16x32_bf16 v[120:123], v[112:115], v[100:103], 0
    v_exp_f32 v106, v104
    v_mfma_f32_16x16x32_bf16 v[124:127], v[116:119], v[100:103], 0
    v_exp_f32 v107, v105
    s_nop 0
    v_cvt_pk_bf16_f32 v104, v106, v107
    v_cvt_pk_bf16_f32 v105, v106, v107
    v_cvt_pk_bf16_f32 v128, v136, v137
    v_cvt_pk_bf16_f32 v129, v138, v139
    v_permlane32_swap_b32 v104, v105
    v_mov_b64 v[132:133], 0
    v_mov_b64 v[134:135], 0
    v_mfma_f32_16x16x16_bf16 v[108:111], v[16:17], v[104:105], v[108:111]
    v_cvt_pk_bf16_f32 v130, v140, v141
    v_cvt_pk_bf16_f32 v131, v142, v143
    v_mfma_f32_16x16x16_bf16 v[120:123], v[128:129], v[104:105], v[120:123]
    v_mov_b64 v[96:97], 0
    v_mov_b64 v[98:99], 0
    v_mfma_f32_16x16x16_bf16 v[124:127], v[130:131], v[104:105], v[124:127]
    ds_read_b128 v[72:75], v1 offset:49152
    s_nop 0
    v_rcp_f32 v12, v108
    v_add_u32 v15, 3565158400, v108
    v_cmp_lt_u32 vcc, s42, v15
L_fbr_w2:
    v_mul_f32 v120, v120, v12
    v_mul_f32 v121, v121, v12
    v_mul_f32 v122, v122, v12
    v_mul_f32 v123, v123, v12
    v_pk_mul_f32 v[124:125], v[124:125], v[12:13] op_sel_hi:[1,0]
    v_pk_mul_f32 v[126:127], v[126:127], v[12:13] op_sel_hi:[1,0]
    v_cvt_pk_bf16_f32 v40, v120, v124
    v_cvt_pk_bf16_f32 v42, v122, v126
    v_cvt_pk_bf16_f32 v41, v121, v125
    v_cvt_pk_bf16_f32 v43, v123, v127
    v_cndmask_b32 v120, v40, v42, s[4:5]
    v_cndmask_b32 v121, v41, v43, s[4:5]
    s_cbranch_vccnz L_fb_w2
    ds_write_b64 v10, v[120:121] offset:2048
    v_smfmac_f32_16x16x64_bf16 v[56:59], v[40:43], v[168:175], v11
    buffer_load_dwordx4 v[112:115], v0, s[8:11], s31 offen sc1
    v_mov_b64 v[136:137], 0
    v_smfmac_f32_16x16x64_bf16 v[60:63], v[40:43], v[176:183], v11
    v_mov_b64 v[138:139], 0
    v_smfmac_f32_16x16x64_bf16 v[132:135], v[40:43], v[184:191], v11
    v_mov_b64 v[140:141], 0
    s_waitcnt lgkmcnt(0)
    s_barrier
    ds_read_b128 v[44:47], v5 offset:2560
    v_mov_b64 v[142:143], 0
    ds_read_b128 v[48:51], v5 offset:1024
    ds_read_b128 v[52:55], v5 offset:1536
    v_smfmac_f32_16x16x64_bf16 v[96:99], v[40:43], v[192:199], v11
    buffer_load_dwordx4 v[116:119], v0, s[8:11], s31 offen offset:1024 sc1
    ds_read_b128 v[76:79], v1 offset:50176
    v_mov_b64 v[120:121], 0
    s_add_u32 s20, s20, 1
    s_waitcnt lgkmcnt(3)
    v_smfmac_f32_16x16x64_bf16 v[56:59], v[44:47], v[200:207], v11
    ds_read_b128 v[80:83], v1 offset:51200
    v_smfmac_f32_16x16x64_bf16 v[60:63], v[44:47], v[208:215], v11
    ds_read_b128 v[84:87], v1 offset:52224
    s_waitcnt lgkmcnt(4)
    v_smfmac_f32_16x16x64_bf16 v[56:59], v[48:51], v[224:231], v11
    ds_read_b128 v[88:91], v1 offset:53248
    v_smfmac_f32_16x16x64_bf16 v[60:63], v[48:51], v[232:239], v11
    ds_read_b128 v[92:95], v1 offset:54272
    s_waitcnt lgkmcnt(5)
    v_smfmac_f32_16x16x64_bf16 v[56:59], v[52:55], v[240:247], v11
    ds_read_b128 v[24:27], v1 offset:55296
    v_smfmac_f32_16x16x64_bf16 v[60:63], v[52:55], v[248:255], v11
    ds_read_b128 v[28:31], v1 offset:56320
    v_smfmac_f32_16x16x64_bf16 v[132:135], v[44:47], v[216:223], v11
    s_add_u32 s40, s27, 4096
    s_add_u32 s32, s32, 8192
    s_mov_b32 s37, s29
    v_smfmac_f32_16x16x64_bf16 v[96:99], v[44:47], v[64:71], v11
    s_mov_b32 s29, s28
    s_waitcnt lgkmcnt(4)
    v_cvt_pk_bf16_f32 v32, v56, v60
    v_smfmac_f32_16x16x64_bf16 v[132:135], v[48:51], v[72:79], v11
    v_cvt_pk_bf16_f32 v33, v57, v61
    v_cvt_pk_bf16_f32 v34, v58, v62
    v_cvt_pk_bf16_f32 v35, v59, v63
    v_smfmac_f32_16x16x64_bf16 v[96:99], v[48:51], v[80:87], v11
    buffer_store_dwordx4 v[32:35], v7, s[8:11], s21 offen
    s_waitcnt lgkmcnt(0)
    v_smfmac_f32_16x16x64_bf16 v[132:135], v[52:55], v[88:95], v11
    v_smfmac_f32_16x16x64_bf16 v[96:99], v[52:55], v[24:31], v11
    s_mov_b32 s28, s27
    s_mov_b32 s27, s37
    s_add_u32 s30, s30, 262144
    v_mov_b64 v[122:123], 0
    v_mov_b64 v[124:125], 0
    v_mov_b64 v[126:127], 0
    s_nop 1
    v_cvt_pk_bf16_f32 v36, v132, v96
    v_cvt_pk_bf16_f32 v37, v133, v97
    v_cvt_pk_bf16_f32 v38, v134, v98
    v_cvt_pk_bf16_f32 v39, v135, v99
    buffer_store_dwordx4 v[36:39], v7, s[8:11], s22 offen
    s_mov_b32 s25, s23
    s_barrier
    ds_read_b128 v[56:59], v1 offset:0
    ds_read_b128 v[60:63], v1 offset:1024
    ds_read_b128 v[64:67], v1 offset:2048
    s_waitcnt lgkmcnt(0)
    ds_read_b128 v[68:71], v1 offset:3072
    ds_read_b128 v[72:75], v1 offset:4096
    ds_read_b128 v[76:79], v1 offset:5120
    s_waitcnt lgkmcnt(0)
    ds_read_b128 v[80:83], v1 offset:6144
    ds_read_b128 v[84:87], v1 offset:7168
    s_waitcnt lgkmcnt(0)
    s_xor_b32 s21, s21, 0x40000
    s_add_u32 s45, s20, 1
    s_add_u32 s22, s21, 4096
    s_lshl_b32 s37, s19, 13
    s_add_u32 s37, s21, s37
    buffer_load_dwordx4 v[40:43], v0, s[8:11], s25 offen offset:0 sc1
    buffer_load_dwordx4 v[44:47], v0, s[8:11], s25 offen offset:1024 sc1
    ds_read_b128 v[88:91], v1 offset:8192
    ds_read_b128 v[92:95], v1 offset:9216
    s_waitcnt lgkmcnt(0)
    ds_read_b128 v[96:99], v1 offset:10240
    ds_read_b128 v[100:103], v1 offset:11264
    s_waitcnt lgkmcnt(0)
    buffer_load_dwordx4 v[40:43], v0, s[8:11], s25 offen offset:0 sc1
    buffer_load_dwordx4 v[44:47], v0, s[8:11], s25 offen offset:1024 sc1
    s_mov_b32 s36, 0
L_red_5_w:
    s_waitcnt vmcnt(2)
    v_max_u32 v12, v40, v44
    v_cmp_eq_u32 vcc, -1, v12
L_red_5_m:
    v_mfma_f32_16x16x32_bf16 v[52:55], v[20:23], v[40:43], 0
    v_mfma_f32_16x16x32_bf16 v[52:55], v[20:23], v[44:47], v[52:55]
    s_cmp_eq_u32 s20, 63
    s_nop 2
    s_cbranch_vccnz L_red_5_e
    s_nop 2
    v_add_f32_dpp v52, v52, v52 row_ror:4 row_mask:0xf bank_mask:0xf
    v_add_f32_dpp v53, v53, v53 row_ror:4 row_mask:0xf bank_mask:0xf
    s_nop 0
    v_add_f32_dpp v52, v52, v52 row_ror:8 row_mask:0xf bank_mask:0xf
    v_add_f32_dpp v53, v53, v53 row_ror:8 row_mask:0xf bank_mask:0xf
    v_cvt_pk_bf16_f32 v54, v52, v53
    buffer_store_dword v54, v8, s[8:11], s28 offen
    s_cbranch_scc0 L_rec_on_w2
    buffer_store_dword v54, v8, s[8:11], s32 offen sc1
    s_branch L_rec_done_w2
L_rec_on_w2:
    s_mov_b32 s36, 0
    s_add_u32 s23, s37, 4096
    s_xor_b32 s24, s23, 0x40000
    s_add_u32 s31, s30, 17043456
    s_add_u32 s41, s30, 262144
    s_barrier
    buffer_load_dwordx4 v[24:27], v0, s[8:11], s40 offen offset:0 sc1
    ds_read_b128 v[104:107], v1 offset:12288
    s_waitcnt lgkmcnt(0)
    buffer_load_dwordx4 v[28:31], v0, s[8:11], s40 offen offset:1024 sc1
    v_mov_b64 v[128:129], 0
    v_mov_b64 v[130:131], 0
    v_mov_b64 v[132:133], 0
    v_mov_b64 v[134:135], 0
    v_lshlrev_b32 v15, 3, v0
    v_mov_b32 v13, -1
    buffer_load_dwordx4 v[24:27], v0, s[8:11], s40 offen offset:0 sc1
    ds_read_b128 v[108:111], v1 offset:13312
    s_waitcnt lgkmcnt(0)
    buffer_load_dwordx4 v[28:31], v0, s[8:11], s40 offen offset:1024 sc1
    s_branch L_top_w2
L_red_5_e:
    s_mov_b64 exec, vcc
    buffer_load_dwordx4 v[40:43], v0, s[8:11], s25 offen offset:0 sc1
    buffer_load_dwordx4 v[44:47], v0, s[8:11], s25 offen offset:1024 sc1
    s_mov_b64 exec, -1
    s_add_u32 s36, s36, 1
    s_cmp_lt_u32 s36, 30000
    s_cbranch_scc1 L_red_5_w
    s_mov_b64 vcc, 0
    s_branch L_red_5_m
L_retry_w2:
    s_mov_b64 exec, vcc
    buffer_load_dwordx4 v[28:31], v0, s[8:11], s40 offen offset:1024 sc1
    s_mov_b64 exec, -1
    s_add_u32 s36, s36, 1
    s_cmp_lt_u32 s36, 30000
    s_waitcnt vmcnt(3)
    v_cmp_eq_u32 vcc, -1, v31
    ds_write_b128 v0, v[28:31] offset:5120
    s_cbranch_scc0 L_go_w2
    s_cbranch_vccnz L_retry_w2
    s_branch L_go_w2
L_retry_w2_0:
    s_mov_b64 exec, vcc
    buffer_load_dwordx4 v[24:27], v0, s[8:11], s40 offen offset:0 sc1
    s_mov_b64 exec, -1
    buffer_load_dwordx4 v[28:31], v0, s[8:11], s40 offen offset:1024 sc1
    s_add_u32 s36, s36, 1
    s_cmp_lt_u32 s36, 30000
    s_cbranch_scc0 L_go_w2_0
    v_mov_b64 v[120:121], 0
    v_mov_b64 v[122:123], 0
    v_mov_b64 v[124:125], 0
    v_mov_b64 v[126:127], 0
    s_waitcnt vmcnt(3)
    s_branch L_top_w2_nw
L_fb_w2:
    s_waitcnt lgkmcnt(0)
    s_add_u32 s37, s30, 4096
    buffer_load_dwordx4 v[24:27], v0, s[8:11], s30 offen offset:0 sc1
    buffer_load_dwordx4 v[28:31], v0, s[8:11], s30 offen offset:1024 sc1
    buffer_load_dwordx4 v[32:35], v0, s[8:11], s30 offen offset:2048 sc1
    buffer_load_dwordx4 v[36:39], v0, s[8:11], s30 offen offset:3072 sc1
    buffer_load_dwordx4 v[40:43], v0, s[8:11], s37 offen offset:0 sc1
    buffer_load_dwordx4 v[44:47], v0, s[8:11], s37 offen offset:1024 sc1
    buffer_load_dwordx4 v[48:51], v0, s[8:11], s37 offen offset:2048 sc1
    buffer_load_dwordx4 v[52:55], v0, s[8:11], s37 offen offset:3072 sc1
    ds_read_b128 v[64:67], v3 offset:0
    ds_read_b128 v[80:83], v14 offset:0
    ds_read_b128 v[68:71], v3 offset:64
    ds_read_b128 v[84:87], v14 offset:64
    ds_read_b128 v[72:75], v3 offset:128
    ds_read_b128 v[88:91], v14 offset:128
    ds_read_b128 v[76:79], v3 offset:192
    ds_read_b128 v[92:95], v14 offset:192
    s_waitcnt vmcnt(0) lgkmcnt(0)
    v_mfma_f32_16x16x32_bf16 v[56:59], v[24:27], v[64:67], 0
    v_mfma_f32_16x16x32_bf16 v[60:63], v[40:43], v[64:67], 0
    v_mfma_f32_16x16x32_bf16 v[104:107], v[80:83], v[64:67], 0
    v_mfma_f32_16x16x32_bf16 v[56:59], v[28:31], v[68:71], v[56:59]
    v_mfma_f32_16x16x32_bf16 v[60:63], v[44:47], v[68:71], v[60:63]
    v_mfma_f32_16x16x32_bf16 v[104:107], v[84:87], v[68:71], v[104:107]
    v_mfma_f32_16x16x32_bf16 v[56:59], v[32:35], v[72:75], v[56:59]
    v_mfma_f32_16x16x32_bf16 v[60:63], v[48:51], v[72:75], v[60:63]
    v_mfma_f32_16x16x32_bf16 v[104:107], v[88:91], v[72:75], v[104:107]
    v_mfma_f32_16x16x32_bf16 v[56:59], v[36:39], v[76:79], v[56:59]
    v_mfma_f32_16x16x32_bf16 v[60:63], v[52:55], v[76:79], v[60:63]
    v_mfma_f32_16x16x32_bf16 v[104:107], v[92:95], v[76:79], v[104:107]
    s_nop 7
    v_permlane32_swap_b32 v104, v106
    v_permlane32_swap_b32 v105, v107
    v_add_f32 v104, v104, v106
    v_add_f32 v105, v105, v107
    v_mul_f32 v104, s34, v104
    v_mul_f32 v105, s34, v105
    v_max3_f32 v12, v56, v57, v58
    v_max3_f32 v12, v12, v59, v60
    v_max3_f32 v12, v12, v61, v62
    v_max3_f32 v12, v12, v63, v104
    v_max_f32 v12, v12, v105
    v_mov_b32 v13, v12
    s_nop 1
    v_permlane16_swap_b32 v12, v13
    v_max_f32 v12, v12, v13
    v_mov_b32 v13, v12
    s_nop 1
    v_permlane32_swap_b32 v12, v13
    v_max_f32 v12, v12, v13
    v_add_f32 v13, -1.0, v12
    v_sub_f32 v56, v56, v13
    v_exp_f32 v56, v56
    v_sub_f32 v57, v57, v13
    v_exp_f32 v57, v57
    v_sub_f32 v58, v58, v13
    v_exp_f32 v58, v58
    v_sub_f32 v59, v59, v13
    v_exp_f32 v59, v59
    v_sub_f32 v60, v60, v13
    v_exp_f32 v60, v60
    v_sub_f32 v61, v61, v13
    v_exp_f32 v61, v61
    v_sub_f32 v62, v62, v13
    v_exp_f32 v62, v62
    v_sub_f32 v63, v63, v13
    v_exp_f32 v63, v63
    v_sub_f32 v104, v104, v12
    v_exp_f32 v104, v104
    v_sub_f32 v105, v105, v12
    v_exp_f32 v105, v105
    v_cvt_pk_bf16_f32 v100, v56, v57
    v_cvt_pk_bf16_f32 v101, v58, v59
    v_cvt_pk_bf16_f32 v102, v60, v61
    v_cvt_pk_bf16_f32 v103, v62, v63
    v_cvt_pk_bf16_f32 v104, v104, v105
    v_mov_b32 v105, v104
    s_nop 1
    v_permlane32_swap_b32 v104, v105
    v_mfma_f32_16x16x32_bf16 v[108:111], v[16:19], v[100:103], 0
    v_mfma_f32_16x16x32_bf16 v[120:123], v[112:115], v[100:103], 0
    v_mfma_f32_16x16x32_bf16 v[124:127], v[116:119], v[100:103], 0
    v_mfma_f32_16x16x16_bf16 v[108:111], v[16:17], v[104:105], v[108:111]
    v_mfma_f32_16x16x16_bf16 v[120:123], v[128:129], v[104:105], v[120:123]
    v_mfma_f32_16x16x16_bf16 v[124:127], v[130:131], v[104:105], v[124:127]
    ds_read_b128 v[64:67], v1 offset:47104
    ds_read_b128 v[68:71], v1 offset:48128
    ds_read_b128 v[72:75], v1 offset:49152
    v_mov_b64 v[56:57], 0
    v_mov_b64 v[58:59], 0
    v_mov_b64 v[60:61], 0
    v_mov_b64 v[62:63], 0
    v_mov_b64 v[132:133], 0
    v_mov_b64 v[134:135], 0
    v_mov_b64 v[96:97], 0
    v_mov_b64 v[98:99], 0
    s_mov_b64 vcc, 0
    v_mov_b32 v13, 0
    v_rcp_f32 v12, v108
    s_waitcnt lgkmcnt(0)
    s_nop 7
    s_branch L_fbr_w2
L_rec_done_w2:
    s_waitcnt vmcnt(0)
    s_endpgm
L_rec_w3:
    v_add_u32 v1, 77824, v0
    v_bfe_u32 v10, v0, 7, 1
    v_lshl_add_u32 v10, v10, 3, v5
    s_mov_b32 s4, 0xff00ff00
    s_mov_b32 s5, 0xff00ff00
    s_mov_b32 s45, 1
    s_mov_b32 s46, 0x000f000f
    s_mov_b32 s47, 0x000f000f
    s_mov_b32 s40, 1579008
    s_mov_b32 s12, s72
    s_and_b32 s13, s73, 0xffff
    s_mov_b32 s14, 8192
    s_mov_b32 s15, 0x00020000
    buffer_load_dword v24, v15, s[12:15], 0 offen offset:768
    buffer_load_dword v25, v15, s[12:15], 0 offen offset:784
    buffer_load_dword v26, v15, s[12:15], 0 offen offset:800
    buffer_load_dword v27, v15, s[12:15], 0 offen offset:816
    buffer_load_dword v28, v15, s[12:15], 0 offen offset:776
    buffer_load_dword v29, v15, s[12:15], 0 offen offset:792
    buffer_load_dword v30, v15, s[12:15], 0 offen offset:808
    buffer_load_dword v31, v15, s[12:15], 0 offen offset:824
    s_mov_b32 s20, 0
    s_mov_b32 s21, 0
    s_mov_b32 s27, 532480
    s_mov_b32 s28, 524288
    s_mov_b32 s29, 540672
    s_lshl_b32 s30, s19, 13
    s_add_u32 s30, s30, 33554432
    s_mov_b32 s32, 1048576
    s_cmp_eq_u32 s19, 0
    s_cselect_b32 s44, 0, 0x80
    s_waitcnt vmcnt(8) lgkmcnt(0)
    v_mov_b64 v[120:121], 0
    v_mov_b64 v[122:123], 0
    v_mov_b64 v[124:125], 0
    v_mov_b64 v[126:127], 0
    v_mov_b64 v[128:129], 0
    v_mov_b64 v[130:131], 0
    v_mov_b64 v[132:133], 0
    v_mov_b64 v[134:135], 0
    v_mov_b64 v[136:137], 0
    v_mov_b64 v[138:139], 0
    v_mov_b64 v[140:141], 0
    v_mov_b64 v[142:143], 0
    s_add_u32 s22, s21, 4096
    s_lshl_b32 s37, s19, 13
    s_add_u32 s37, s21, s37
    s_add_u32 s23, s37, 6144
    s_xor_b32 s24, s23, 0x40000
    s_add_u32 s31, s30, 17045504
    s_add_u32 s41, s30, 17301504
    s_add_u32 s37, s30, 16783360
    buffer_load_dwordx4 v[112:115], v0, s[8:11], s37 offen sc1
    buffer_load_dwordx4 v[116:119], v0, s[8:11], s37 offen offset:1024 sc1
    s_waitcnt vmcnt(0)
    s_waitcnt lgkmcnt(0)
    v_lshlrev_b32 v15, 3, v0
    v_mov_b32 v13, -1
    s_mov_b32 s36, 0x7fffffff
    s_barrier
.p2align 6
L_top_w3:
    s_waitcnt vmcnt(3)
L_top_w3_nw:
    v_cmp_eq_u32 vcc, -1, v27
    v_smfmac_f32_16x16x64_bf16 v[120:123], v[24:27], v[104:111], v11
    ds_write_b128 v0, v[24:27] offset:6144
    v_smfmac_f32_16x16x64_bf16 v[124:127], v[24:27], v[56:63], v11
    s_cbranch_vccnz L_retry_w3_0
L_go_w3_0:
    v_smfmac_f32_16x16x64_bf16 v[128:131], v[24:27], v[80:87], v11
    v_smfmac_f32_16x16x64_bf16 v[132:135], v[24:27], v[88:95], v11
    s_waitcnt lgkmcnt(0)
    s_barrier
    v_smfmac_f32_16x16x64_bf16 v[136:139], v[24:27], a[152:159], v11
    ds_read_b128 v[32:35], v0 offset:0
    s_waitcnt vmcnt(2)
    v_cmp_eq_u32 vcc, -1, v31
    v_smfmac_f32_16x16x64_bf16 v[140:143], v[24:27], a[160:167], v11
    ds_write_b128 v0, v[28:31] offset:7168
    s_cbranch_vccnz L_retry_w3
L_go_w3:
    v_smfmac_f32_16x16x64_bf16 v[120:123], v[28:31], v[64:71], v11
    ds_read_b128 v[40:43], v0 offset:2048
    v_smfmac_f32_16x16x64_bf16 v[124:127], v[28:31], v[72:79], v11
    buffer_load_dwordx4 v[104:107], v9, s[8:11], s30 offen sc1
    v_smfmac_f32_16x16x64_bf16 v[128:131], v[28:31], v[96:103], v11
    ds_read_b128 v[48:51], v0 offset:4096
    v_smfmac_f32_16x16x64_bf16 v[132:135], v[28:31], a[96:103], v11
    buffer_load_dwordx4 v[108:111], v9, s[8:11], s30 offen offset:1024 sc1
    s_waitcnt lgkmcnt(3)
    v_smfmac_f32_16x16x64_bf16 v[120:123], v[32:35], a[0:7], v11
    s_waitcnt lgkmcnt(2)
    s_barrier
    ds_read_b128 v[36:39], v0 offset:1024
    v_smfmac_f32_16x16x64_bf16 v[124:127], v[32:35], a[8:15], v11
    ds_read_b128 v[56:59], v1 offset:14336
    s_waitcnt lgkmcnt(3)
    v_smfmac_f32_16x16x64_bf16 v[120:123], v[40:43], a[32:39], v11
    ds_read_b128 v[44:47], v0 offset:3072
    buffer_load_dword v15, s[8:11], s41 offen sc1 lds
    v_smfmac_f32_16x16x64_bf16 v[124:127], v[40:43], a[40:47], v11
    buffer_store_dword v54, v8, s[8:11], s32 offen sc1
    s_waitcnt lgkmcnt(3)
    v_smfmac_f32_16x16x64_bf16 v[120:123], v[48:51], a[64:71], v11
    ds_read_b128 v[52:55], v0 offset:5120
    v_smfmac_f32_16x16x64_bf16 v[124:127], v[48:51], a[72:79], v11
    ds_read_b128 v[60:63], v1 offset:15360
    s_waitcnt lgkmcnt(4)
    v_smfmac_f32_16x16x64_bf16 v[120:123], v[36:39], a[16:23], v11
    ds_read_b128 v[64:67], v1 offset:16384
    buffer_store_dword v13, v0, s[8:11], s24 offen offset:0
    v_smfmac_f32_16x16x64_bf16 v[124:127], v[36:39], a[24:31], v11
    ds_read_b128 v[68:71], v1 offset:17408
    s_waitcnt lgkmcnt(4)
    v_smfmac_f32_16x16x64_bf16 v[120:123], v[44:47], a[48:55], v11
    ds_read_b128 v[72:75], v1 offset:18432
    buffer_store_dword v13, v0, s[8:11], s24 offen offset:1024
    v_smfmac_f32_16x16x64_bf16 v[124:127], v[44:47], a[56:63], v11
    ds_read_b128 v[76:79], v1 offset:19456
    s_waitcnt lgkmcnt(5)
    v_smfmac_f32_16x16x64_bf16 v[120:123], v[52:55], a[80:87], v11
    ds_read_b128 v[80:83], v1 offset:36864
    buffer_store_dword v13, v8, s[8:11], s29 offen
    v_smfmac_f32_16x16x64_bf16 v[124:127], v[52:55], a[88:95], v11
    ds_read_b128 v[84:87], v1 offset:37888
    v_smfmac_f32_16x16x64_bf16 v[128:131], v[44:47], a[104:111], v11
    ds_read_b128 v[88:91], v1 offset:38912
    v_smfmac_f32_16x16x64_bf16 v[132:135], v[44:47], a[112:119], v11
    ds_read_b128 v[92:95], v1 offset:39936
    v_permlane32_swap_b32 v120, v122
    v_permlane32_swap_b32 v121, v123
    s_waitcnt lgkmcnt(2)
    v_smfmac_f32_16x16x64_bf16 v[128:131], v[32:35], v[56:63], v11
    ds_read_b128 v[96:99], v1 offset:40960
    v_permlane32_swap_b32 v124, v126
    v_permlane32_swap_b32 v125, v127
    v_smfmac_f32_16x16x64_bf16 v[132:135], v[32:35], v[64:71], v11
    ds_read_b128 v[100:103], v1 offset:41984
    v_add_f32 v120, v120, v122
    v_add_f32 v124, v124, v126
    v_cvt_pk_bf16_f32 v12, v120, v124
    v_smfmac_f32_16x16x64_bf16 v[128:131], v[36:39], v[72:79], v11
    ds_write_b32 v2, v12 offset:10304
    v_add_f32 v121, v121, v123
    v_add_f32 v125, v125, v127
    v_cvt_pk_bf16_f32 v13, v121, v125
    v_smfmac_f32_16x16x64_bf16 v[132:135], v[36:39], v[80:87], v11
    ds_write_b32 v2, v13 offset:10688
    s_waitcnt lgkmcnt(2)
    v_smfmac_f32_16x16x64_bf16 v[128:131], v[40:43], v[88:95], v11
    v_smfmac_f32_16x16x64_bf16 v[132:135], v[40:43], v[96:103], v11
    v_smfmac_f32_16x16x64_bf16 v[128:131], v[48:51], a[120:127], v11
    v_smfmac_f32_16x16x64_bf16 v[132:135], v[48:51], a[128:135], v11
    s_waitcnt lgkmcnt(0)
    s_barrier
    ds_read_b128 v[56:59], v4 offset:0
    v_smfmac_f32_16x16x64_bf16 v[128:131], v[52:55], a[136:143], v11
    ds_read_b128 v[60:63], v4 offset:64
    v_smfmac_f32_16x16x64_bf16 v[132:135], v[52:55], a[144:151], v11
    ds_read_b128 v[64:67], v3 offset:0
    v_smfmac_f32_16x16x64_bf16 v[136:139], v[28:31], a[168:175], v11
    ds_read_b128 v[68:71], v3 offset:64
    v_smfmac_f32_16x16x64_bf16 v[140:143], v[28:31], a[176:183], v11
    ds_read_b128 v[72:75], v3 offset:128
    s_waitcnt vmcnt(5)
    s_waitcnt lgkmcnt(3)
    v_mfma_f32_16x16x32_bf16 v[96:99], v[104:107], v[56:59], 0.5
    v_cvt_pk_bf16_f32 v128, v128, v132
    v_cvt_pk_bf16_f32 v129, v129, v133
    v_mfma_f32_16x16x32_bf16 v[96:99], v[108:111], v[60:63], v[96:99]
    ds_write2_b32 v2, v128, v129 offset0:0 offset1:80
    v_cvt_pk_bf16_f32 v130, v130, v134
    v_cvt_pk_bf16_f32 v131, v131, v135
    v_smfmac_f32_16x16x64_bf16 v[136:139], v[32:35], a[184:191], v11
    ds_write2_b32 v2, v130, v131 offset0:160 offset1:240
    ds_read_b128 v[76:79], v3 offset:192
    v_smfmac_f32_16x16x64_bf16 v[140:143], v[32:35], a[192:199], v11
    s_nop 0
    v_permlane32_swap_b32 v96, v98
    v_smfmac_f32_16x16x64_bf16 v[136:139], v[36:39], a[200:207], v11
    v_permlane32_swap_b32 v97, v99
    v_smfmac_f32_16x16x64_bf16 v[140:143], v[36:39], a[208:215], v11
    v_add_f32_dpp v96, v98, v96 row_ror:8 row_mask:0xf bank_mask:0xf
    v_add_f32_dpp v97, v99, v97 row_ror:8 row_mask:0xf bank_mask:0xf
    v_exp_f32 v96, v96
    s_waitcnt lgkmcnt(1)
    s_barrier
    v_smfmac_f32_16x16x64_bf16 v[136:139], v[40:43], a[216:223], v11
    ds_read_b128 v[80:83], v14 offset:0
    v_exp_f32 v97, v97
    v_smfmac_f32_16x16x64_bf16 v[140:143], v[40:43], a[224:231], v11
    ds_read_b128 v[84:87], v14 offset:64
    v_cvt_pk_bf16_f32 v96, v96, v97
    v_smfmac_f32_16x16x64_bf16 v[136:139], v[44:47], a[232:239], v11
    ds_read_b128 v[88:91], v14 offset:128
    v_smfmac_f32_16x16x64_bf16 v[140:143], v[44:47], a[240:247], v11
    ds_read_b128 v[92:95], v14 offset:192
    ds_write_b32 v6, v96
    s_waitcnt lgkmcnt(4)
    v_mfma_f32_16x16x32_bf16 v[104:107], v[80:83], v[64:67], 0
    v_mov_b64 v[56:57], 0
    s_waitcnt lgkmcnt(3)
    v_mfma_f32_16x16x32_bf16 v[104:107], v[84:87], v[68:71], v[104:107]
    v_mov_b64 v[58:59], 0
    s_waitcnt lgkmcnt(2)
    v_mfma_f32_16x16x32_bf16 v[104:107], v[88:91], v[72:75], v[104:107]
    v_mov_b64 v[60:61], 0
    s_waitcnt lgkmcnt(1)
    v_mfma_f32_16x16x32_bf16 v[104:107], v[92:95], v[76:79], v[104:107]
    s_waitcnt lgkmcnt(0)
    s_barrier
    v_smfmac_f32_16x16x64_bf16 v[136:139], v[48:51], a[248:255], v11
    ds_read_b128 v[100:103], v5
    v_mov_b64 v[62:63], 0
    v_smfmac_f32_16x16x64_bf16 v[140:143], v[48:51], v[144:151], v11
    s_nop 1
    v_permlane32_swap_b32 v104, v106
    v_smfmac_f32_16x16x64_bf16 v[136:139], v[52:55], v[152:159], v11
    ds_read_b128 v[64:67], v1 offset:43008
    v_permlane32_swap_b32 v105, v107
    v_smfmac_f32_16x16x64_bf16 v[140:143], v[52:55], v[160:167], v11
    ds_read_b128 v[68:71], v1 offset:44032
    v_add_f32 v104, v104, v106
    v_add_f32 v105, v105, v107
    s_waitcnt lgkmcnt(2)
    v_mfma_f32_16x16x32_bf16 v[108:111], v[16:19], v[100:103], 0
    v_mul_f32 v104, s34, v104
    v_mul_f32 v105, s34, v105
    v_mfma_f32_16x16x32_bf16 v[120:123], v[112:115], v[100:103], 0
    v_exp_f32 v106, v104
    v_mfma_f32_16x16x32_bf16 v[124:127], v[116:119], v[100:103], 0
    v_exp_f32 v107, v105
    s_nop 0
    v_cvt_pk_bf16_f32 v104, v106, v107
    v_cvt_pk_bf16_f32 v105, v106, v107
    v_cvt_pk_bf16_f32 v128, v136, v137
    v_cvt_pk_bf16_f32 v129, v138, v139
    v_permlane32_swap_b32 v104, v105
    v_mov_b64 v[132:133], 0
    v_mov_b64 v[134:135], 0
    v_mfma_f32_16x16x16_bf16 v[108:111], v[16:17], v[104:105], v[108:111]
    v_cvt_pk_bf16_f32 v130, v140, v141
    v_cvt_pk_bf16_f32 v131, v142, v143
    v_mfma_f32_16x16x16_bf16 v[120:123], v[128:129], v[104:105], v[120:123]
    v_mov_b64 v[96:97], 0
    v_mov_b64 v[98:99], 0
    v_mfma_f32_16x16x16_bf16 v[124:127], v[130:131], v[104:105], v[124:127]
    ds_read_b128 v[72:75], v1 offset:45056
    s_nop 0
    v_rcp_f32 v12, v108
    v_add_u32 v15, 3565158400, v108
    v_cmp_lt_u32 vcc, s42, v15
L_fbr_w3:
    v_mul_f32 v120, v120, v12
    v_mul_f32 v121, v121, v12
    v_mul_f32 v122, v122, v12
    v_mul_f32 v123, v123, v12
    v_pk_mul_f32 v[124:125], v[124:125], v[12:13] op_sel_hi:[1,0]
    v_pk_mul_f32 v[126:127], v[126:127], v[12:13] op_sel_hi:[1,0]
    v_cvt_pk_bf16_f32 v40, v120, v124
    v_cvt_pk_bf16_f32 v42, v122, v126
    v_cvt_pk_bf16_f32 v41, v121, v125
    v_cvt_pk_bf16_f32 v43, v123, v127
    v_cndmask_b32 v120, v40, v42, s[4:5]
    v_cndmask_b32 v121, v41, v43, s[4:5]
    s_cbranch_vccnz L_fb_w3
    ds_write_b64 v10, v[120:121] offset:2560
    v_smfmac_f32_16x16x64_bf16 v[56:59], v[40:43], v[168:175], v11
    buffer_load_dwordx4 v[112:115], v0, s[8:11], s31 offen sc1
    v_mov_b64 v[136:137], 0
    v_smfmac_f32_16x16x64_bf16 v[60:63], v[40:43], v[176:183], v11
    v_mov_b64 v[138:139], 0
    v_smfmac_f32_16x16x64_bf16 v[132:135], v[40:43], v[184:191], v11
    v_mov_b64 v[140:141], 0
    s_waitcnt lgkmcnt(0)
    s_barrier
    ds_read_b128 v[44:47], v5 offset:1024
    v_mov_b64 v[142:143], 0
    ds_read_b128 v[48:51], v5 offset:1536
    ds_read_b128 v[52:55], v5 offset:2048
    v_smfmac_f32_16x16x64_bf16 v[96:99], v[40:43], v[192:199], v11
    buffer_load_dwordx4 v[116:119], v0, s[8:11], s31 offen offset:1024 sc1
    ds_read_b128 v[76:79], v1 offset:46080
    v_mov_b64 v[120:121], 0
    s_add_u32 s20, s20, 1
    s_waitcnt lgkmcnt(3)
    v_smfmac_f32_16x16x64_bf16 v[56:59], v[44:47], v[200:207], v11
    ds_read_b128 v[80:83], v1 offset:47104
    v_smfmac_f32_16x16x64_bf16 v[60:63], v[44:47], v[208:215], v11
    ds_read_b128 v[84:87], v1 offset:48128
    s_waitcnt lgkmcnt(4)
    v_smfmac_f32_16x16x64_bf16 v[56:59], v[48:51], v[224:231], v11
    ds_read_b128 v[88:91], v1 offset:49152
    v_smfmac_f32_16x16x64_bf16 v[60:63], v[48:51], v[232:239], v11
    ds_read_b128 v[92:95], v1 offset:50176
    s_waitcnt lgkmcnt(5)
    v_smfmac_f32_16x16x64_bf16 v[56:59], v[52:55], v[240:247], v11
    ds_read_b128 v[24:27], v1 offset:51200
    v_smfmac_f32_16x16x64_bf16 v[60:63], v[52:55], v[248:255], v11
    ds_read_b128 v[28:31], v1 offset:52224
    v_smfmac_f32_16x16x64_bf16 v[132:135], v[44:47], v[216:223], v11
    s_add_u32 s40, s27, 6144
    s_add_u32 s32, s32, 8192
    s_mov_b32 s37, s29
    v_smfmac_f32_16x16x64_bf16 v[96:99], v[44:47], v[64:71], v11
    s_mov_b32 s29, s28
    s_waitcnt lgkmcnt(4)
    v_cvt_pk_bf16_f32 v32, v56, v60
    v_smfmac_f32_16x16x64_bf16 v[132:135], v[48:51], v[72:79], v11
    v_cvt_pk_bf16_f32 v33, v57, v61
    v_cvt_pk_bf16_f32 v34, v58, v62
    v_cvt_pk_bf16_f32 v35, v59, v63
    v_smfmac_f32_16x16x64_bf16 v[96:99], v[48:51], v[80:87], v11
    buffer_store_dwordx4 v[32:35], v7, s[8:11], s21 offen
    s_waitcnt lgkmcnt(0)
    v_smfmac_f32_16x16x64_bf16 v[132:135], v[52:55], v[88:95], v11
    v_smfmac_f32_16x16x64_bf16 v[96:99], v[52:55], v[24:31], v11
    s_mov_b32 s28, s27
    s_mov_b32 s27, s37
    s_add_u32 s30, s30, 262144
    v_mov_b64 v[122:123], 0
    v_mov_b64 v[124:125], 0
    v_mov_b64 v[126:127], 0
    s_nop 1
    v_cvt_pk_bf16_f32 v36, v132, v96
    v_cvt_pk_bf16_f32 v37, v133, v97
    v_cvt_pk_bf16_f32 v38, v134, v98
    v_cvt_pk_bf16_f32 v39, v135, v99
    buffer_store_dwordx4 v[36:39], v7, s[8:11], s22 offen
    s_mov_b32 s25, s23
    s_barrier
    ds_read_b128 v[56:59], v1 offset:0
    ds_read_b128 v[60:63], v1 offset:1024
    ds_read_b128 v[64:67], v1 offset:2048
    s_waitcnt lgkmcnt(0)
    ds_read_b128 v[68:71], v1 offset:3072
    ds_read_b128 v[72:75], v1 offset:4096
    ds_read_b128 v[76:79], v1 offset:5120
    s_waitcnt lgkmcnt(0)
    ds_read_b128 v[80:83], v1 offset:6144
    ds_read_b128 v[84:87], v1 offset:7168
    s_waitcnt lgkmcnt(0)
    s_xor_b32 s21, s21, 0x40000
    s_add_u32 s45, s20, 1
    s_add_u32 s22, s21, 4096
    s_lshl_b32 s37, s19, 13
    s_add_u32 s37, s21, s37
    buffer_load_dwordx4 v[40:43], v0, s[8:11], s25 offen offset:0 sc1
    buffer_load_dwordx4 v[44:47], v0, s[8:11], s25 offen offset:1024 sc1
    ds_read_b128 v[88:91], v1 offset:8192
    ds_read_b128 v[92:95], v1 offset:9216
    s_waitcnt lgkmcnt(0)
    ds_read_b128 v[96:99], v1 offset:10240
    ds_read_b128 v[100:103], v1 offset:11264
    s_waitcnt lgkmcnt(0)
    buffer_load_dwordx4 v[40:43], v0, s[8:11], s25 offen offset:0 sc1
    buffer_load_dwordx4 v[44:47], v0, s[8:11], s25 offen offset:1024 sc1
    s_mov_b32 s36, 0
L_red_6_w:
    s_waitcnt vmcnt(2)
    v_max_u32 v12, v40, v44
    v_cmp_eq_u32 vcc, -1, v12
L_red_6_m:
    v_mfma_f32_16x16x32_bf16 v[52:55], v[20:23], v[40:43], 0
    v_mfma_f32_16x16x32_bf16 v[52:55], v[20:23], v[44:47], v[52:55]
    s_cmp_eq_u32 s20, 63
    s_nop 2
    s_cbranch_vccnz L_red_6_e
    s_nop 2
    v_add_f32_dpp v52, v52, v52 row_ror:4 row_mask:0xf bank_mask:0xf
    v_add_f32_dpp v53, v53, v53 row_ror:4 row_mask:0xf bank_mask:0xf
    s_nop 0
    v_add_f32_dpp v52, v52, v52 row_ror:8 row_mask:0xf bank_mask:0xf
    v_add_f32_dpp v53, v53, v53 row_ror:8 row_mask:0xf bank_mask:0xf
    v_cvt_pk_bf16_f32 v54, v52, v53
    buffer_store_dword v54, v8, s[8:11], s28 offen
    s_cbranch_scc0 L_rec_on_w3
    buffer_store_dword v54, v8, s[8:11], s32 offen sc1
    s_branch L_rec_done_w3
L_rec_on_w3:
    s_mov_b32 s36, 0
    s_add_u32 s23, s37, 6144
    s_xor_b32 s24, s23, 0x40000
    s_add_u32 s31, s30, 17045504
    s_add_u32 s41, s30, 17301504
    s_barrier
    buffer_load_dwordx4 v[24:27], v0, s[8:11], s40 offen offset:0 sc1
    ds_read_b128 v[104:107], v1 offset:12288
    s_waitcnt lgkmcnt(0)
    buffer_load_dwordx4 v[28:31], v0, s[8:11], s40 offen offset:1024 sc1
    v_mov_b64 v[128:129], 0
    v_mov_b64 v[130:131], 0
    v_mov_b64 v[132:133], 0
    v_mov_b64 v[134:135], 0
    v_lshlrev_b32 v15, 3, v0
    v_mov_b32 v13, -1
    buffer_load_dwordx4 v[24:27], v0, s[8:11], s40 offen offset:0 sc1
    ds_read_b128 v[108:111], v1 offset:13312
    s_waitcnt lgkmcnt(0)
    buffer_load_dwordx4 v[28:31], v0, s[8:11], s40 offen offset:1024 sc1
    s_branch L_top_w3
L_red_6_e:
    s_mov_b64 exec, vcc
    buffer_load_dwordx4 v[40:43], v0, s[8:11], s25 offen offset:0 sc1
    buffer_load_dwordx4 v[44:47], v0, s[8:11], s25 offen offset:1024 sc1
    s_mov_b64 exec, -1
    s_add_u32 s36, s36, 1
    s_cmp_lt_u32 s36, 30000
    s_cbranch_scc1 L_red_6_w
    s_mov_b64 vcc, 0
    s_branch L_red_6_m
L_retry_w3:
    s_mov_b64 exec, vcc
    buffer_load_dwordx4 v[28:31], v0, s[8:11], s40 offen offset:1024 sc1
    s_mov_b64 exec, -1
    s_add_u32 s36, s36, 1
    s_cmp_lt_u32 s36, 30000
    s_waitcnt vmcnt(3)
    v_cmp_eq_u32 vcc, -1, v31
    ds_write_b128 v0, v[28:31] offset:7168
    s_cbranch_scc0 L_go_w3
    s_cbranch_vccnz L_retry_w3
    s_branch L_go_w3
L_retry_w3_0:
    s_mov_b64 exec, vcc
    buffer_load_dwordx4 v[24:27], v0, s[8:11], s40 offen offset:0 sc1
    s_mov_b64 exec, -1
    buffer_load_dwordx4 v[28:31], v0, s[8:11], s40 offen offset:1024 sc1
    s_add_u32 s36, s36, 1
    s_cmp_lt_u32 s36, 30000
    s_cbranch_scc0 L_go_w3_0
    v_mov_b64 v[120:121], 0
    v_mov_b64 v[122:123], 0
    v_mov_b64 v[124:125], 0
    v_mov_b64 v[126:127], 0
    s_waitcnt vmcnt(3)
    s_branch L_top_w3_nw
L_fb_w3:
    s_waitcnt lgkmcnt(0)
    s_add_u32 s37, s30, 4096
    buffer_load_dwordx4 v[24:27], v0, s[8:11], s30 offen offset:0 sc1
    buffer_load_dwordx4 v[28:31], v0, s[8:11], s30 offen offset:1024 sc1
    buffer_load_dwordx4 v[32:35], v0, s[8:11], s30 offen offset:2048 sc1
    buffer_load_dwordx4 v[36:39], v0, s[8:11], s30 offen offset:3072 sc1
    buffer_load_dwordx4 v[40:43], v0, s[8:11], s37 offen offset:0 sc1
    buffer_load_dwordx4 v[44:47], v0, s[8:11], s37 offen offset:1024 sc1
    buffer_load_dwordx4 v[48:51], v0, s[8:11], s37 offen offset:2048 sc1
    buffer_load_dwordx4 v[52:55], v0, s[8:11], s37 offen offset:3072 sc1
    ds_read_b128 v[64:67], v3 offset:0
    ds_read_b128 v[80:83], v14 offset:0
    ds_read_b128 v[68:71], v3 offset:64
    ds_read_b128 v[84:87], v14 offset:64
    ds_read_b128 v[72:75], v3 offset:128
    ds_read_b128 v[88:91], v14 offset:128
    ds_read_b128 v[76:79], v3 offset:192
    ds_read_b128 v[92:95], v14 offset:192
    s_waitcnt vmcnt(0) lgkmcnt(0)
    v_mfma_f32_16x16x32_bf16 v[56:59], v[24:27], v[64:67], 0
    v_mfma_f32_16x16x32_bf16 v[60:63], v[40:43], v[64:67], 0
    v_mfma_f32_16x16x32_bf16 v[104:107], v[80:83], v[64:67], 0
    v_mfma_f32_16x16x32_bf16 v[56:59], v[28:31], v[68:71], v[56:59]
    v_mfma_f32_16x16x32_bf16 v[60:63], v[44:47], v[68:71], v[60:63]
    v_mfma_f32_16x16x32_bf16 v[104:107], v[84:87], v[68:71], v[104:107]
    v_mfma_f32_16x16x32_bf16 v[56:59], v[32:35], v[72:75], v[56:59]
    v_mfma_f32_16x16x32_bf16 v[60:63], v[48:51], v[72:75], v[60:63]
    v_mfma_f32_16x16x32_bf16 v[104:107], v[88:91], v[72:75], v[104:107]
    v_mfma_f32_16x16x32_bf16 v[56:59], v[36:39], v[76:79], v[56:59]
    v_mfma_f32_16x16x32_bf16 v[60:63], v[52:55], v[76:79], v[60:63]
    v_mfma_f32_16x16x32_bf16 v[104:107], v[92:95], v[76:79], v[104:107]
    s_nop 7
    v_permlane32_swap_b32 v104, v106
    v_permlane32_swap_b32 v105, v107
    v_add_f32 v104, v104, v106
    v_add_f32 v105, v105, v107
    v_mul_f32 v104, s34, v104
    v_mul_f32 v105, s34, v105
    v_max3_f32 v12, v56, v57, v58
    v_max3_f32 v12, v12, v59, v60
    v_max3_f32 v12, v12, v61, v62
    v_max3_f32 v12, v12, v63, v104
    v_max_f32 v12, v12, v105
    v_mov_b32 v13, v12
    s_nop 1
    v_permlane16_swap_b32 v12, v13
    v_max_f32 v12, v12, v13
    v_mov_b32 v13, v12
    s_nop 1
    v_permlane32_swap_b32 v12, v13
    v_max_f32 v12, v12, v13
    v_add_f32 v13, -1.0, v12
    v_sub_f32 v56, v56, v13
    v_exp_f32 v56, v56
    v_sub_f32 v57, v57, v13
    v_exp_f32 v57, v57
    v_sub_f32 v58, v58, v13
    v_exp_f32 v58, v58
    v_sub_f32 v59, v59, v13
    v_exp_f32 v59, v59
    v_sub_f32 v60, v60, v13
    v_exp_f32 v60, v60
    v_sub_f32 v61, v61, v13
    v_exp_f32 v61, v61
    v_sub_f32 v62, v62, v13
    v_exp_f32 v62, v62
    v_sub_f32 v63, v63, v13
    v_exp_f32 v63, v63
    v_sub_f32 v104, v104, v12
    v_exp_f32 v104, v104
    v_sub_f32 v105, v105, v12
    v_exp_f32 v105, v105
    v_cvt_pk_bf16_f32 v100, v56, v57
    v_cvt_pk_bf16_f32 v101, v58, v59
    v_cvt_pk_bf16_f32 v102, v60, v61
    v_cvt_pk_bf16_f32 v103, v62, v63
    v_cvt_pk_bf16_f32 v104, v104, v105
    v_mov_b32 v105, v104
    s_nop 1
    v_permlane32_swap_b32 v104, v105
    v_mfma_f32_16x16x32_bf16 v[108:111], v[16:19], v[100:103], 0
    v_mfma_f32_16x16x32_bf16 v[120:123], v[112:115], v[100:103], 0
    v_mfma_f32_16x16x32_bf16 v[124:127], v[116:119], v[100:103], 0
    v_mfma_f32_16x16x16_bf16 v[108:111], v[16:17], v[104:105], v[108:111]
    v_mfma_f32_16x16x16_bf16 v[120:123], v[128:129], v[104:105], v[120:123]
    v_mfma_f32_16x16x16_bf16 v[124:127], v[130:131], v[104:105], v[124:127]
    ds_read_b128 v[64:67], v1 offset:43008
    ds_read_b128 v[68:71], v1 offset:44032
    ds_read_b128 v[72:75], v1 offset:45056
    v_mov_b64 v[56:57], 0
    v_mov_b64 v[58:59], 0
    v_mov_b64 v[60:61], 0
    v_mov_b64 v[62:63], 0
    v_mov_b64 v[132:133], 0
    v_mov_b64 v[134:135], 0
    v_mov_b64 v[96:97], 0
    v_mov_b64 v[98:99], 0
    s_mov_b64 vcc, 0
    v_mov_b32 v13, 0
    v_rcp_f32 v12, v108
    s_waitcnt lgkmcnt(0)
    s_nop 7
    s_branch L_fbr_w3
L_rec_done_w3:
    s_waitcnt vmcnt(0)
    s_endpgm
L_exit:
    s_endpgm
L_worker:
    s_load_dwordx2 s[64:65], s[0:1], 0
    s_load_dwordx4 s[68:71], s[0:1], 16
    s_load_dwordx2 s[72:73], s[0:1], 32
    s_load_dwordx4 s[76:79], s[0:1], 56
    v_and_b32 v24, 63, v0
    v_and_b32 v25, 15, v24
    v_lshrrev_b32 v26, 4, v24
    v_lshlrev_b32 v1, 4, v24
    s_mov_b32 s28, s8
    s_mov_b32 s29, s9
    s_mov_b32 s30, s10
    s_mov_b32 s31, 0x00020000
    s_mov_b32 s34, 1024
    s_mov_b32 s33, 131072
    s_mov_b32 s42, 16
    s_and_b32 s47, s61, 3
    s_lshl_b32 s32, s47, 15
    s_lshr_b32 s48, s61, 2
    s_waitcnt lgkmcnt(0)
    s_cmp_eq_u32 s60, 7
    s_cbranch_scc1 L_g1_b
    s_sub_u32 s49, s60, 1
    s_cmp_ge_u32 s48, 6
    s_cbranch_scc1 L_g1_m1
    s_mul_i32 s49, s49, 6
    s_add_u32 s46, s49, s48
    s_cmp_ge_u32 s46, 32
    s_cbranch_scc1 L_g1_m2
    s_and_b32 s49, s46, 1
    s_lshr_b32 s48, s46, 1
    s_branch L_g1_m3
L_g1_m1:
    s_lshl_b32 s49, s49, 1
    s_add_u32 s46, s49, s48
    s_add_u32 s46, s46, 14
L_g1_m2:
    s_sub_u32 s48, s46, 20
    s_mov_b32 s49, 2
L_g1_m3:
    s_mov_b32 s50, 8192
    s_mov_b32 s37, 1048576
    s_mul_i32 s36, s47, 262144
    s_mov_b32 s20, s64
    s_and_b32 s21, s65, 0xffff
    s_mov_b32 s22, 2097152
    s_mov_b32 s23, 0x00020000
    s_mov_b32 s45, 4
    s_cmp_eq_u32 s49, 1
    s_cbranch_scc1 L_g1_v
    s_cmp_eq_u32 s49, 2
    s_cbranch_scc1 L_g1_q
L_g1_k:
    s_mov_b32 s24, s70
    s_and_b32 s25, s71, 0xffff
    s_mov_b32 s26, 4194304
    s_mov_b32 s27, 0x00020000
    s_add_u32 s36, s36, 33554432
    s_mov_b32 s40, 0x3e0293ee
    s_mov_b32 s41, 0x3e0293ee
    s_mov_b32 s43, 0
    s_mov_b32 s44, 136
    s_branch L_g1_go
L_g1_v:
    s_mov_b32 s24, s72
    s_and_b32 s25, s73, 0xffff
    s_mov_b32 s26, 4194304
    s_mov_b32 s27, 0x00020000
    s_add_u32 s36, s36, 50331648
    s_mov_b32 s40, 0x3f000000
    s_mov_b32 s41, 0x3f000000
    s_mov_b32 s43, 1
    s_mov_b32 s44, 136
    s_branch L_g1_go
L_g1_q:
    s_mov_b32 s24, s68
    s_and_b32 s25, s69, 0xffff
    s_mov_b32 s26, 4194304
    s_mov_b32 s27, 0x00020000
    s_add_u32 s36, s36, 67108864
    s_mov_b32 s40, 0x3f800000
    s_mov_b32 s41, 0x3f800000
    s_mov_b32 s43, 0
    s_mov_b32 s44, 96
    s_branch L_g1_go
L_g1_b:
    s_mul_i32 s48, s61, 52
    s_lshr_b32 s48, s48, 8
    s_mul_i32 s47, s48, 5
    s_sub_u32 s47, s61, s47
    s_lshl_b32 s32, s47, 15
    s_mov_b32 s33, 163840
    s_cmp_eq_u32 s47, 4
    s_cselect_b32 s42, 12, 13
    s_cmp_ge_u32 s48, 6
    s_cbranch_scc1 L_g1_pf
    s_mov_b32 s20, s76
    s_and_b32 s21, s77, 0xffff
    s_mov_b32 s22, 2097152
    s_mov_b32 s23, 0x00020000
    s_mov_b32 s24, s78
    s_and_b32 s25, s79, 0xffff
    s_mov_b32 s26, 1572864
    s_mov_b32 s27, 0x00020000
    s_mov_b32 s50, 3072
    s_mov_b32 s37, 491520
    s_mul_i32 s36, s47, 98304
    s_add_u32 s36, s36, 100663296
    s_mov_b32 s44, 36
    s_mov_b32 s45, 0
    s_cmp_lt_u32 s48, 2
    s_cselect_b32 s40, 0x3eb8aa3b, 1.0
    s_mov_b32 s41, s40
    s_cmp_ge_u32 s48, 4
    s_cselect_b32 s43, 1, 0
L_g1_go:
    s_lshl_b32 s51, s48, 9
    s_lshl_b32 s46, s18, 7
    s_add_u32 s51, s51, s46
    s_lshl_b32 s46, s48, 14
    s_add_u32 s36, s36, s46
    s_lshr_b32 s46, s18, 1
    s_lshl_b32 s46, s46, 13
    s_add_u32 s36, s36, s46
    s_and_b32 s46, s18, 1
    s_add_u32 s47, s43, 11
    s_lshl_b32 s46, s46, s47
    s_add_u32 s36, s36, s46
    s_sub_u32 s47, 9, s43
    v_lshlrev_b32 v4, s47, v26
    v_lshl_add_u32 v4, v25, 4, v4
    s_call_b64 s[52:53], L_gemm_a
    s_call_b64 s[52:53], L_gemm_b
    s_call_b64 s[52:53], L_gemm_c
    s_branch L_g1_done
L_g1_pf:
    s_cmp_eq_u32 s61, 30
    s_cbranch_scc0 L_g1_done
    s_load_dwordx2 s[64:65], s[0:1], 8
    v_and_b32 v27, 7, v25
    v_lshlrev_b32 v27, 10, v27
    v_lshl_add_u32 v27, v26, 6, v27
    v_lshrrev_b32 v28, 3, v25
    v_lshl_add_u32 v27, v28, 2, v27
    s_waitcnt lgkmcnt(0)
    s_mov_b32 s20, s64
    s_and_b32 s21, s65, 0xffff
    s_mov_b32 s22, 8192
    s_mov_b32 s23, 0x00020000
    s_lshl_b32 s46, s18, 8
    buffer_load_dword v32, v27, s[20:23], s46 offen offset:0
    buffer_load_dword v33, v27, s[20:23], s46 offen offset:16
    buffer_load_dword v34, v27, s[20:23], s46 offen offset:32
    buffer_load_dword v35, v27, s[20:23], s46 offen offset:48
    buffer_load_dword v36, v27, s[20:23], s46 offen offset:8
    buffer_load_dword v37, v27, s[20:23], s46 offen offset:24
    buffer_load_dword v38, v27, s[20:23], s46 offen offset:40
    buffer_load_dword v39, v27, s[20:23], s46 offen offset:56
    s_lshl_b32 s46, s18, 11
    s_add_u32 s46, s46, 1572864
    s_waitcnt vmcnt(0)
    buffer_store_dwordx4 v[32:35], v1, s[8:11], s46 offen offset:0 sc1
    buffer_store_dwordx4 v[36:39], v1, s[8:11], s46 offen offset:1024 sc1
    s_waitcnt vmcnt(0)
    v_mov_b32 v27, 32
    v_mov_b32 v28, 1
    s_mov_b64 exec, 1
    global_atomic_add v27, v28, s[16:17]
    s_mov_b64 exec, -1
L_g1_done:
    s_cmp_gt_u32 s60, 3
    s_cbranch_scc1 L_bpart
    s_cmp_gt_u32 s60, 3
    s_cbranch_scc1 L_noinit
    s_cmp_eq_u32 s18, 0
    s_cbranch_scc0 L_noinit
    s_lshl_b32 s46, s60, 9
    s_lshl_b32 s47, s61, 2
    s_add_u32 s46, s46, s47
    s_add_u32 s46, s46, 573440
    v_mov_b32 v24, 0
    v_mov_b32 v25, 1
    v_mov_b32 v26, 32
    v_lshlrev_b32 v27, 7, v0
    s_mov_b64 exec, 15
    buffer_store_dword v24, v27, s[8:11], s46 offen
    s_waitcnt vmcnt(0)
    s_mov_b64 exec, 1
    global_atomic_add v26, v25, s[16:17]
    s_mov_b64 exec, -1
L_noinit:
    s_mov_b32 s62, s61
    s_load_dwordx4 s[76:79], s[0:1], 24
    s_load_dwordx2 s[80:81], s[0:1], 40
    s_load_dwordx2 s[82:83], s[0:1], 80
    v_and_b32 v28, 63, v0
    v_and_b32 v29, 15, v28
    v_lshrrev_b32 v30, 4, v28
    v_and_b32 v31, 1, v30
    v_lshrrev_b32 v32, 1, v30
    v_lshrrev_b32 v33, 2, v29
    v_and_b32 v34, 3, v29
    v_lshlrev_b32 v1, 4, v28
    v_lshlrev_b32 v35, 2, v29
    s_lshl_b32 s46, s18, 6
    v_add_u32 v35, s46, v35
    v_mul_u32_u24 v36, 1312, v30
    v_add_u32 v2, v36, v35
    v_mul_u32_u24 v36, 1312, v33
    v_mul_u32_u24 v37, 320, v34
    v_add_u32 v36, v36, v37
    v_lshl_add_u32 v3, v30, 4, v36
    v_mov_b32 v4, 0x4444
    v_mov_b32 v36, 0xeeee
    v_cmp_lt_u32 vcc, 7, v29
    s_nop 1
    v_cndmask_b32 v4, v4, v36, vcc
    v_lshlrev_b32 v36, 4, v29
    v_lshl_add_u32 v36, v30, 10, v36
    s_lshl_b32 s46, s18, 8
    v_add_u32 v5, s46, v36
    v_lshl_add_u32 v38, v33, 3, v34
    v_lshlrev_b32 v36, 11, v38
    v_lshl_add_u32 v36, v30, 2, v36
    s_lshr_b32 s46, s62, 3
    s_lshl_b32 s46, s46, 8
    s_and_b32 s47, s62, 4
    s_lshl_b32 s47, s47, 11
    s_add_u32 s46, s46, s47
    s_and_b32 s47, s62, 3
    s_lshl_b32 s47, s47, 4
    s_add_u32 s46, s46, s47
    s_lshl_b32 s47, s18, 6
    s_add_u32 s46, s46, s47
    v_add_u32 v6, s46, v36
    s_lshl_b32 s46, s18, 15
    s_add_u32 s46, s46, 32768
    v_add_u32 v7, s46, v1
    v_bfe_u32 v8, v1, 2, 7
    v_mov_b32 v12, 0x3f003f00
    v_mov_b32 v13, 0x3f003f00
    v_mov_b32 v14, 0x3f003f00
    v_mov_b32 v15, 0x3f003f00
    v_mov_b32 v36, 0
    v_mov_b32 v37, 0x3f80
    v_cmp_eq_u32 vcc, 0, v34
    s_nop 1
    v_cndmask_b32 v36, v36, v37, vcc
    v_mov_b32 v37, 0x3f800000
    v_cmp_eq_u32 vcc, 1, v34
    s_nop 1
    v_cndmask_b32 v36, v36, v37, vcc
    v_cmp_eq_u32 vcc, 0, v33
    s_nop 1
    v_cndmask_b32 v16, 0, v36, vcc
    v_cmp_eq_u32 vcc, 1, v33
    s_nop 1
    v_cndmask_b32 v17, 0, v36, vcc
    v_cmp_eq_u32 vcc, 2, v33
    s_nop 1
    v_cndmask_b32 v18, 0, v36, vcc
    v_cmp_eq_u32 vcc, 3, v33
    s_nop 1
    v_cndmask_b32 v19, 0, v36, vcc
    s_and_b32 s46, s18, 1
    s_lshl_b32 s46, s46, 2
    v_add_u32 v38, s46, v38
    v_lshlrev_b32 v36, 3, v30
    v_sub_u32 v38, v38, v36
    v_mov_b32 v36, 0xf149f2ca
    v_mov_b32 v37, 1.0
    v_cmp_le_i32 vcc, 0, v38
    s_nop 1
    v_cndmask_b32 v20, v36, v37, vcc
    v_cmp_le_i32 vcc, 1, v38
    s_nop 1
    v_cndmask_b32 v21, v36, v37, vcc
    v_cmp_le_i32 vcc, 2, v38
    s_nop 1
    v_cndmask_b32 v22, v36, v37, vcc
    v_cmp_le_i32 vcc, 3, v38
    s_nop 1
    v_cndmask_b32 v23, v36, v37, vcc
    v_cmp_le_i32 vcc, 4, v38
    s_nop 1
    v_cndmask_b32 v24, v36, v37, vcc
    v_cmp_le_i32 vcc, 5, v38
    s_nop 1
    v_cndmask_b32 v25, v36, v37, vcc
    v_cmp_le_i32 vcc, 6, v38
    s_nop 1
    v_cndmask_b32 v26, v36, v37, vcc
    v_cmp_le_i32 vcc, 7, v38
    s_nop 1
    v_cndmask_b32 v27, v36, v37, vcc
    s_mov_b32 s67, 0x3e0293ee
    v_lshlrev_b32 v36, 17, v30
    s_lshl_b32 s46, s62, 8
    v_add_u32 v36, s46, v36
    v_add_u32 v240, v36, v35
    v_lshl_add_u32 v241, v29, 3, v36
    s_lshr_b32 s46, s18, 1
    s_lshl_b32 s46, s46, 7
    s_and_b32 s47, s18, 1
    s_lshl_b32 s47, s47, 2
    s_add_u32 s46, s46, s47
    v_add_u32 v241, s46, v241
    v_lshlrev_b32 v36, 14, v30
    v_lshl_add_u32 v36, v35, 2, v36
    s_lshl_b32 s46, s62, 17
    v_add_u32 v242, s46, v36
    v_lshlrev_b32 v36, 11, v34
    v_lshl_add_u32 v36, v30, 8, v36
    v_lshl_add_u32 v36, v33, 6, v36
    s_lshl_b32 s46, s18, 15
    s_add_u32 s46, s46, 32768
    v_add_u32 v243, s46, v36
    s_waitcnt lgkmcnt(0)
    s_mov_b32 s24, s76
    s_and_b32 s25, s77, 0xffff
    s_mov_b32 s26, 4194304
    s_mov_b32 s27, 0x00020000
    s_mov_b32 s28, s78
    s_and_b32 s29, s79, 0xffff
    s_mov_b32 s30, 4194304
    s_mov_b32 s31, 0x00020000
    s_mov_b32 s32, s80
    s_and_b32 s33, s81, 0xffff
    s_mov_b32 s34, 4194304
    s_mov_b32 s35, 0x00020000
    s_mov_b32 s20, s82
    s_and_b32 s21, s83, 0xffff
    s_mov_b32 s22, 4194304
    s_mov_b32 s23, 0x00020000
    s_mov_b32 s47, 0x05040100
    s_mov_b32 s48, 0x07060302
    s_barrier
    s_mov_b32 s46, 0
    buffer_load_dwordx4 v[48:51], v242, s[32:35], s46 offen
    s_mov_b32 s46, 1024
    buffer_load_dwordx4 v[52:55], v242, s[32:35], s46 offen
    s_mov_b32 s46, 4096
    buffer_load_dwordx4 v[56:59], v242, s[32:35], s46 offen
    s_mov_b32 s46, 5120
    buffer_load_dwordx4 v[60:63], v242, s[32:35], s46 offen
    s_mov_b32 s46, 8192
    buffer_load_dwordx4 v[64:67], v242, s[32:35], s46 offen
    s_mov_b32 s46, 9216
    buffer_load_dwordx4 v[68:71], v242, s[32:35], s46 offen
    s_mov_b32 s46, 12288
    buffer_load_dwordx4 v[72:75], v242, s[32:35], s46 offen
    s_mov_b32 s46, 13312
    buffer_load_dwordx4 v[76:79], v242, s[32:35], s46 offen
    s_mov_b32 s46, 2048
    buffer_load_dwordx4 v[80:83], v242, s[32:35], s46 offen
    s_mov_b32 s46, 3072
    buffer_load_dwordx4 v[84:87], v242, s[32:35], s46 offen
    s_mov_b32 s46, 6144
    buffer_load_dwordx4 v[88:91], v242, s[32:35], s46 offen
    s_mov_b32 s46, 7168
    buffer_load_dwordx4 v[92:95], v242, s[32:35], s46 offen
    s_mov_b32 s46, 10240
    buffer_load_dwordx4 v[96:99], v242, s[32:35], s46 offen
    s_mov_b32 s46, 11264
    buffer_load_dwordx4 v[100:103], v242, s[32:35], s46 offen
    s_mov_b32 s46, 14336
    buffer_load_dwordx4 v[104:107], v242, s[32:35], s46 offen
    s_mov_b32 s46, 15360
    buffer_load_dwordx4 v[108:111], v242, s[32:35], s46 offen
    s_mov_b32 s46, 65536
    buffer_load_dwordx4 v[112:115], v242, s[32:35], s46 offen
    s_mov_b32 s46, 66560
    buffer_load_dwordx4 v[116:119], v242, s[32:35], s46 offen
    s_mov_b32 s46, 69632
    buffer_load_dwordx4 v[120:123], v242, s[32:35], s46 offen
    s_mov_b32 s46, 70656
    buffer_load_dwordx4 v[124:127], v242, s[32:35], s46 offen
    s_mov_b32 s46, 73728
    buffer_load_dwordx4 v[128:131], v242, s[32:35], s46 offen
    s_mov_b32 s46, 74752
    buffer_load_dwordx4 v[132:135], v242, s[32:35], s46 offen
    s_mov_b32 s46, 77824
    buffer_load_dwordx4 v[136:139], v242, s[32:35], s46 offen
    s_mov_b32 s46, 78848
    buffer_load_dwordx4 v[140:143], v242, s[32:35], s46 offen
    s_mov_b32 s46, 67584
    buffer_load_dwordx4 v[144:147], v242, s[32:35], s46 offen
    s_mov_b32 s46, 68608
    buffer_load_dwordx4 v[148:151], v242, s[32:35], s46 offen
    s_mov_b32 s46, 71680
    buffer_load_dwordx4 v[152:155], v242, s[32:35], s46 offen
    s_mov_b32 s46, 72704
    buffer_load_dwordx4 v[156:159], v242, s[32:35], s46 offen
    s_mov_b32 s46, 75776
    buffer_load_dwordx4 v[160:163], v242, s[32:35], s46 offen
    s_mov_b32 s46, 76800
    buffer_load_dwordx4 v[164:167], v242, s[32:35], s46 offen
    s_mov_b32 s46, 79872
    buffer_load_dwordx4 v[168:171], v242, s[32:35], s46 offen
    s_mov_b32 s46, 80896
    buffer_load_dwordx4 v[172:175], v242, s[32:35], s46 offen
    s_waitcnt vmcnt(24)
    v_perm_b32 v176, v52, v48, s47
    v_perm_b32 v177, v60, v56, s47
    v_perm_b32 v178, v68, v64, s47
    v_perm_b32 v179, v76, v72, s47
    ds_write_b128 v243, v[176:179] offset:0
    v_perm_b32 v180, v52, v48, s48
    v_perm_b32 v181, v60, v56, s48
    v_perm_b32 v182, v68, v64, s48
    v_perm_b32 v183, v76, v72, s48
    ds_write_b128 v243, v[180:183] offset:1024
    v_perm_b32 v184, v53, v49, s47
    v_perm_b32 v185, v61, v57, s47
    v_perm_b32 v186, v69, v65, s47
    v_perm_b32 v187, v77, v73, s47
    ds_write_b128 v243, v[184:187] offset:16
    v_perm_b32 v188, v53, v49, s48
    v_perm_b32 v189, v61, v57, s48
    v_perm_b32 v190, v69, v65, s48
    v_perm_b32 v191, v77, v73, s48
    ds_write_b128 v243, v[188:191] offset:1040
    v_perm_b32 v192, v54, v50, s47
    v_perm_b32 v193, v62, v58, s47
    v_perm_b32 v194, v70, v66, s47
    v_perm_b32 v195, v78, v74, s47
    ds_write_b128 v243, v[192:195] offset:32
    v_perm_b32 v196, v54, v50, s48
    v_perm_b32 v197, v62, v58, s48
    v_perm_b32 v198, v70, v66, s48
    v_perm_b32 v199, v78, v74, s48
    ds_write_b128 v243, v[196:199] offset:1056
    v_perm_b32 v200, v55, v51, s47
    v_perm_b32 v201, v63, v59, s47
    v_perm_b32 v202, v71, v67, s47
    v_perm_b32 v203, v79, v75, s47
    ds_write_b128 v243, v[200:203] offset:48
    v_perm_b32 v204, v55, v51, s48
    v_perm_b32 v205, v63, v59, s48
    v_perm_b32 v206, v71, v67, s48
    v_perm_b32 v207, v79, v75, s48
    ds_write_b128 v243, v[204:207] offset:1072
    s_waitcnt lgkmcnt(0)
    s_waitcnt vmcnt(16)
    v_perm_b32 v176, v84, v80, s47
    v_perm_b32 v177, v92, v88, s47
    v_perm_b32 v178, v100, v96, s47
    v_perm_b32 v179, v108, v104, s47
    ds_write_b128 v243, v[176:179] offset:8192
    v_perm_b32 v180, v84, v80, s48
    v_perm_b32 v181, v92, v88, s48
    v_perm_b32 v182, v100, v96, s48
    v_perm_b32 v183, v108, v104, s48
    ds_write_b128 v243, v[180:183] offset:9216
    v_perm_b32 v184, v85, v81, s47
    v_perm_b32 v185, v93, v89, s47
    v_perm_b32 v186, v101, v97, s47
    v_perm_b32 v187, v109, v105, s47
    ds_write_b128 v243, v[184:187] offset:8208
    v_perm_b32 v188, v85, v81, s48
    v_perm_b32 v189, v93, v89, s48
    v_perm_b32 v190, v101, v97, s48
    v_perm_b32 v191, v109, v105, s48
    ds_write_b128 v243, v[188:191] offset:9232
    v_perm_b32 v192, v86, v82, s47
    v_perm_b32 v193, v94, v90, s47
    v_perm_b32 v194, v102, v98, s47
    v_perm_b32 v195, v110, v106, s47
    ds_write_b128 v243, v[192:195] offset:8224
    v_perm_b32 v196, v86, v82, s48
    v_perm_b32 v197, v94, v90, s48
    v_perm_b32 v198, v102, v98, s48
    v_perm_b32 v199, v110, v106, s48
    ds_write_b128 v243, v[196:199] offset:9248
    v_perm_b32 v200, v87, v83, s47
    v_perm_b32 v201, v95, v91, s47
    v_perm_b32 v202, v103, v99, s47
    v_perm_b32 v203, v111, v107, s47
    ds_write_b128 v243, v[200:203] offset:8240
    v_perm_b32 v204, v87, v83, s48
    v_perm_b32 v205, v95, v91, s48
    v_perm_b32 v206, v103, v99, s48
    v_perm_b32 v207, v111, v107, s48
    ds_write_b128 v243, v[204:207] offset:9264
    s_waitcnt lgkmcnt(0)
    s_waitcnt vmcnt(8)
    v_perm_b32 v176, v116, v112, s47
    v_perm_b32 v177, v124, v120, s47
    v_perm_b32 v178, v132, v128, s47
    v_perm_b32 v179, v140, v136, s47
    ds_write_b128 v243, v[176:179] offset:16384
    v_perm_b32 v180, v116, v112, s48
    v_perm_b32 v181, v124, v120, s48
    v_perm_b32 v182, v132, v128, s48
    v_perm_b32 v183, v140, v136, s48
    ds_write_b128 v243, v[180:183] offset:17408
    v_perm_b32 v184, v117, v113, s47
    v_perm_b32 v185, v125, v121, s47
    v_perm_b32 v186, v133, v129, s47
    v_perm_b32 v187, v141, v137, s47
    ds_write_b128 v243, v[184:187] offset:16400
    v_perm_b32 v188, v117, v113, s48
    v_perm_b32 v189, v125, v121, s48
    v_perm_b32 v190, v133, v129, s48
    v_perm_b32 v191, v141, v137, s48
    ds_write_b128 v243, v[188:191] offset:17424
    v_perm_b32 v192, v118, v114, s47
    v_perm_b32 v193, v126, v122, s47
    v_perm_b32 v194, v134, v130, s47
    v_perm_b32 v195, v142, v138, s47
    ds_write_b128 v243, v[192:195] offset:16416
    v_perm_b32 v196, v118, v114, s48
    v_perm_b32 v197, v126, v122, s48
    v_perm_b32 v198, v134, v130, s48
    v_perm_b32 v199, v142, v138, s48
    ds_write_b128 v243, v[196:199] offset:17440
    v_perm_b32 v200, v119, v115, s47
    v_perm_b32 v201, v127, v123, s47
    v_perm_b32 v202, v135, v131, s47
    v_perm_b32 v203, v143, v139, s47
    ds_write_b128 v243, v[200:203] offset:16432
    v_perm_b32 v204, v119, v115, s48
    v_perm_b32 v205, v127, v123, s48
    v_perm_b32 v206, v135, v131, s48
    v_perm_b32 v207, v143, v139, s48
    ds_write_b128 v243, v[204:207] offset:17456
    s_waitcnt lgkmcnt(0)
    s_waitcnt vmcnt(0)
    v_perm_b32 v176, v148, v144, s47
    v_perm_b32 v177, v156, v152, s47
    v_perm_b32 v178, v164, v160, s47
    v_perm_b32 v179, v172, v168, s47
    ds_write_b128 v243, v[176:179] offset:24576
    v_perm_b32 v180, v148, v144, s48
    v_perm_b32 v181, v156, v152, s48
    v_perm_b32 v182, v164, v160, s48
    v_perm_b32 v183, v172, v168, s48
    ds_write_b128 v243, v[180:183] offset:25600
    v_perm_b32 v184, v149, v145, s47
    v_perm_b32 v185, v157, v153, s47
    v_perm_b32 v186, v165, v161, s47
    v_perm_b32 v187, v173, v169, s47
    ds_write_b128 v243, v[184:187] offset:24592
    v_perm_b32 v188, v149, v145, s48
    v_perm_b32 v189, v157, v153, s48
    v_perm_b32 v190, v165, v161, s48
    v_perm_b32 v191, v173, v169, s48
    ds_write_b128 v243, v[188:191] offset:25616
    v_perm_b32 v192, v150, v146, s47
    v_perm_b32 v193, v158, v154, s47
    v_perm_b32 v194, v166, v162, s47
    v_perm_b32 v195, v174, v170, s47
    ds_write_b128 v243, v[192:195] offset:24608
    v_perm_b32 v196, v150, v146, s48
    v_perm_b32 v197, v158, v154, s48
    v_perm_b32 v198, v166, v162, s48
    v_perm_b32 v199, v174, v170, s48
    ds_write_b128 v243, v[196:199] offset:25632
    v_perm_b32 v200, v151, v147, s47
    v_perm_b32 v201, v159, v155, s47
    v_perm_b32 v202, v167, v163, s47
    v_perm_b32 v203, v175, v171, s47
    ds_write_b128 v243, v[200:203] offset:24624
    v_perm_b32 v204, v151, v147, s48
    v_perm_b32 v205, v159, v155, s48
    v_perm_b32 v206, v167, v163, s48
    v_perm_b32 v207, v175, v171, s48
    ds_write_b128 v243, v[204:207] offset:25648
    s_waitcnt lgkmcnt(0)
    s_mov_b32 s46, 0
    buffer_load_dword v48, v240, s[24:27], s46 offen
    s_mov_b32 s46, 8192
    buffer_load_dword v49, v240, s[24:27], s46 offen
    s_mov_b32 s46, 16384
    buffer_load_dword v50, v240, s[24:27], s46 offen
    s_mov_b32 s46, 24576
    buffer_load_dword v51, v240, s[24:27], s46 offen
    s_mov_b32 s46, 65536
    buffer_load_dword v52, v240, s[24:27], s46 offen
    s_mov_b32 s46, 73728
    buffer_load_dword v53, v240, s[24:27], s46 offen
    s_mov_b32 s46, 81920
    buffer_load_dword v54, v240, s[24:27], s46 offen
    s_mov_b32 s46, 90112
    buffer_load_dword v55, v240, s[24:27], s46 offen
    s_mov_b32 s46, 524288
    buffer_load_dword v56, v240, s[24:27], s46 offen
    s_mov_b32 s46, 532480
    buffer_load_dword v57, v240, s[24:27], s46 offen
    s_mov_b32 s46, 540672
    buffer_load_dword v58, v240, s[24:27], s46 offen
    s_mov_b32 s46, 548864
    buffer_load_dword v59, v240, s[24:27], s46 offen
    s_mov_b32 s46, 589824
    buffer_load_dword v60, v240, s[24:27], s46 offen
    s_mov_b32 s46, 598016
    buffer_load_dword v61, v240, s[24:27], s46 offen
    s_mov_b32 s46, 606208
    buffer_load_dword v62, v240, s[24:27], s46 offen
    s_mov_b32 s46, 614400
    buffer_load_dword v63, v240, s[24:27], s46 offen
    s_mov_b32 s46, 32768
    buffer_load_dword v64, v240, s[24:27], s46 offen
    s_mov_b32 s46, 40960
    buffer_load_dword v65, v240, s[24:27], s46 offen
    s_mov_b32 s46, 49152
    buffer_load_dword v66, v240, s[24:27], s46 offen
    s_mov_b32 s46, 57344
    buffer_load_dword v67, v240, s[24:27], s46 offen
    s_mov_b32 s46, 98304
    buffer_load_dword v68, v240, s[24:27], s46 offen
    s_mov_b32 s46, 106496
    buffer_load_dword v69, v240, s[24:27], s46 offen
    s_mov_b32 s46, 114688
    buffer_load_dword v70, v240, s[24:27], s46 offen
    s_mov_b32 s46, 122880
    buffer_load_dword v71, v240, s[24:27], s46 offen
    s_mov_b32 s46, 557056
    buffer_load_dword v72, v240, s[24:27], s46 offen
    s_mov_b32 s46, 565248
    buffer_load_dword v73, v240, s[24:27], s46 offen
    s_mov_b32 s46, 573440
    buffer_load_dword v74, v240, s[24:27], s46 offen
    s_mov_b32 s46, 581632
    buffer_load_dword v75, v240, s[24:27], s46 offen
    s_mov_b32 s46, 622592
    buffer_load_dword v76, v240, s[24:27], s46 offen
    s_mov_b32 s46, 630784
    buffer_load_dword v77, v240, s[24:27], s46 offen
    s_mov_b32 s46, 638976
    buffer_load_dword v78, v240, s[24:27], s46 offen
    s_mov_b32 s46, 647168
    buffer_load_dword v79, v240, s[24:27], s46 offen
    s_mov_b32 s46, 1048576
    buffer_load_dword v80, v240, s[24:27], s46 offen
    s_mov_b32 s46, 1056768
    buffer_load_dword v81, v240, s[24:27], s46 offen
    s_mov_b32 s46, 1064960
    buffer_load_dword v82, v240, s[24:27], s46 offen
    s_mov_b32 s46, 1073152
    buffer_load_dword v83, v240, s[24:27], s46 offen
    s_mov_b32 s46, 1114112
    buffer_load_dword v84, v240, s[24:27], s46 offen
    s_mov_b32 s46, 1122304
    buffer_load_dword v85, v240, s[24:27], s46 offen
    s_mov_b32 s46, 1130496
    buffer_load_dword v86, v240, s[24:27], s46 offen
    s_mov_b32 s46, 1138688
    buffer_load_dword v87, v240, s[24:27], s46 offen
    s_mov_b32 s46, 1572864
    buffer_load_dword v88, v240, s[24:27], s46 offen
    s_mov_b32 s46, 1581056
    buffer_load_dword v89, v240, s[24:27], s46 offen
    s_mov_b32 s46, 1589248
    buffer_load_dword v90, v240, s[24:27], s46 offen
    s_mov_b32 s46, 1597440
    buffer_load_dword v91, v240, s[24:27], s46 offen
    s_mov_b32 s46, 1638400
    buffer_load_dword v92, v240, s[24:27], s46 offen
    s_mov_b32 s46, 1646592
    buffer_load_dword v93, v240, s[24:27], s46 offen
    s_mov_b32 s46, 1654784
    buffer_load_dword v94, v240, s[24:27], s46 offen
    s_mov_b32 s46, 1662976
    buffer_load_dword v95, v240, s[24:27], s46 offen
    s_waitcnt vmcnt(32)
    s_mov_b32 s46, 1081344
    buffer_load_dword v96, v240, s[24:27], s46 offen
    s_mov_b32 s46, 1089536
    buffer_load_dword v97, v240, s[24:27], s46 offen
    s_mov_b32 s46, 1097728
    buffer_load_dword v98, v240, s[24:27], s46 offen
    s_mov_b32 s46, 1105920
    buffer_load_dword v99, v240, s[24:27], s46 offen
    s_mov_b32 s46, 1146880
    buffer_load_dword v100, v240, s[24:27], s46 offen
    s_mov_b32 s46, 1155072
    buffer_load_dword v101, v240, s[24:27], s46 offen
    s_mov_b32 s46, 1163264
    buffer_load_dword v102, v240, s[24:27], s46 offen
    s_mov_b32 s46, 1171456
    buffer_load_dword v103, v240, s[24:27], s46 offen
    s_mov_b32 s46, 1605632
    buffer_load_dword v104, v240, s[24:27], s46 offen
    s_mov_b32 s46, 1613824
    buffer_load_dword v105, v240, s[24:27], s46 offen
    s_mov_b32 s46, 1622016
    buffer_load_dword v106, v240, s[24:27], s46 offen
    s_mov_b32 s46, 1630208
    buffer_load_dword v107, v240, s[24:27], s46 offen
    s_mov_b32 s46, 1671168
    buffer_load_dword v108, v240, s[24:27], s46 offen
    s_mov_b32 s46, 1679360
    buffer_load_dword v109, v240, s[24:27], s46 offen
    s_mov_b32 s46, 1687552
    buffer_load_dword v110, v240, s[24:27], s46 offen
    s_mov_b32 s46, 1695744
    buffer_load_dword v111, v240, s[24:27], s46 offen
    v_perm_b32 v176, v49, v48, s47
    v_perm_b32 v177, v51, v50, s47
    v_perm_b32 v178, v53, v52, s47
    v_perm_b32 v179, v55, v54, s47
    v_perm_b32 v180, v57, v56, s47
    v_perm_b32 v181, v59, v58, s47
    v_perm_b32 v182, v61, v60, s47
    v_perm_b32 v183, v63, v62, s47
    v_perm_b32 v184, v49, v48, s48
    v_perm_b32 v185, v51, v50, s48
    v_perm_b32 v186, v53, v52, s48
    v_perm_b32 v187, v55, v54, s48
    v_perm_b32 v188, v57, v56, s48
    v_perm_b32 v189, v59, v58, s48
    v_perm_b32 v190, v61, v60, s48
    v_perm_b32 v191, v63, v62, s48
    v_accvgpr_write_b32 a0, v176
    v_accvgpr_write_b32 a1, v177
    v_accvgpr_write_b32 a2, v178
    v_accvgpr_write_b32 a3, v179
    v_accvgpr_write_b32 a4, v180
    v_accvgpr_write_b32 a5, v181
    v_accvgpr_write_b32 a6, v182
    v_accvgpr_write_b32 a7, v183
    v_accvgpr_write_b32 a8, v184
    v_accvgpr_write_b32 a9, v185
    v_accvgpr_write_b32 a10, v186
    v_accvgpr_write_b32 a11, v187
    v_accvgpr_write_b32 a12, v188
    v_accvgpr_write_b32 a13, v189
    v_accvgpr_write_b32 a14, v190
    v_accvgpr_write_b32 a15, v191
    s_waitcnt vmcnt(32)
    s_mov_b32 s46, 2097152
    buffer_load_dword v48, v240, s[24:27], s46 offen
    s_mov_b32 s46, 2105344
    buffer_load_dword v49, v240, s[24:27], s46 offen
    s_mov_b32 s46, 2113536
    buffer_load_dword v50, v240, s[24:27], s46 offen
    s_mov_b32 s46, 2121728
    buffer_load_dword v51, v240, s[24:27], s46 offen
    s_mov_b32 s46, 2162688
    buffer_load_dword v52, v240, s[24:27], s46 offen
    s_mov_b32 s46, 2170880
    buffer_load_dword v53, v240, s[24:27], s46 offen
    s_mov_b32 s46, 2179072
    buffer_load_dword v54, v240, s[24:27], s46 offen
    s_mov_b32 s46, 2187264
    buffer_load_dword v55, v240, s[24:27], s46 offen
    s_mov_b32 s46, 2621440
    buffer_load_dword v56, v240, s[24:27], s46 offen
    s_mov_b32 s46, 2629632
    buffer_load_dword v57, v240, s[24:27], s46 offen
    s_mov_b32 s46, 2637824
    buffer_load_dword v58, v240, s[24:27], s46 offen
    s_mov_b32 s46, 2646016
    buffer_load_dword v59, v240, s[24:27], s46 offen
    s_mov_b32 s46, 2686976
    buffer_load_dword v60, v240, s[24:27], s46 offen
    s_mov_b32 s46, 2695168
    buffer_load_dword v61, v240, s[24:27], s46 offen
    s_mov_b32 s46, 2703360
    buffer_load_dword v62, v240, s[24:27], s46 offen
    s_mov_b32 s46, 2711552
    buffer_load_dword v63, v240, s[24:27], s46 offen
    v_perm_b32 v176, v65, v64, s47
    v_perm_b32 v177, v67, v66, s47
    v_perm_b32 v178, v69, v68, s47
    v_perm_b32 v179, v71, v70, s47
    v_perm_b32 v180, v73, v72, s47
    v_perm_b32 v181, v75, v74, s47
    v_perm_b32 v182, v77, v76, s47
    v_perm_b32 v183, v79, v78, s47
    v_perm_b32 v184, v65, v64, s48
    v_perm_b32 v185, v67, v66, s48
    v_perm_b32 v186, v69, v68, s48
    v_perm_b32 v187, v71, v70, s48
    v_perm_b32 v188, v73, v72, s48
    v_perm_b32 v189, v75, v74, s48
    v_perm_b32 v190, v77, v76, s48
    v_perm_b32 v191, v79, v78, s48
    v_accvgpr_write_b32 a16, v176
    v_accvgpr_write_b32 a17, v177
    v_accvgpr_write_b32 a18, v178
    v_accvgpr_write_b32 a19, v179
    v_accvgpr_write_b32 a20, v180
    v_accvgpr_write_b32 a21, v181
    v_accvgpr_write_b32 a22, v182
    v_accvgpr_write_b32 a23, v183
    v_accvgpr_write_b32 a24, v184
    v_accvgpr_write_b32 a25, v185
    v_accvgpr_write_b32 a26, v186
    v_accvgpr_write_b32 a27, v187
    v_accvgpr_write_b32 a28, v188
    v_accvgpr_write_b32 a29, v189
    v_accvgpr_write_b32 a30, v190
    v_accvgpr_write_b32 a31, v191
    s_waitcnt vmcnt(32)
    s_mov_b32 s46, 2129920
    buffer_load_dword v64, v240, s[24:27], s46 offen
    s_mov_b32 s46, 2138112
    buffer_load_dword v65, v240, s[24:27], s46 offen
    s_mov_b32 s46, 2146304
    buffer_load_dword v66, v240, s[24:27], s46 offen
    s_mov_b32 s46, 2154496
    buffer_load_dword v67, v240, s[24:27], s46 offen
    s_mov_b32 s46, 2195456
    buffer_load_dword v68, v240, s[24:27], s46 offen
    s_mov_b32 s46, 2203648
    buffer_load_dword v69, v240, s[24:27], s46 offen
    s_mov_b32 s46, 2211840
    buffer_load_dword v70, v240, s[24:27], s46 offen
    s_mov_b32 s46, 2220032
    buffer_load_dword v71, v240, s[24:27], s46 offen
    s_mov_b32 s46, 2654208
    buffer_load_dword v72, v240, s[24:27], s46 offen
    s_mov_b32 s46, 2662400
    buffer_load_dword v73, v240, s[24:27], s46 offen
    s_mov_b32 s46, 2670592
    buffer_load_dword v74, v240, s[24:27], s46 offen
    s_mov_b32 s46, 2678784
    buffer_load_dword v75, v240, s[24:27], s46 offen
    s_mov_b32 s46, 2719744
    buffer_load_dword v76, v240, s[24:27], s46 offen
    s_mov_b32 s46, 2727936
    buffer_load_dword v77, v240, s[24:27], s46 offen
    s_mov_b32 s46, 2736128
    buffer_load_dword v78, v240, s[24:27], s46 offen
    s_mov_b32 s46, 2744320
    buffer_load_dword v79, v240, s[24:27], s46 offen
    v_perm_b32 v176, v81, v80, s47
    v_perm_b32 v177, v83, v82, s47
    v_perm_b32 v178, v85, v84, s47
    v_perm_b32 v179, v87, v86, s47
    v_perm_b32 v180, v89, v88, s47
    v_perm_b32 v181, v91, v90, s47
    v_perm_b32 v182, v93, v92, s47
    v_perm_b32 v183, v95, v94, s47
    v_perm_b32 v184, v81, v80, s48
    v_perm_b32 v185, v83, v82, s48
    v_perm_b32 v186, v85, v84, s48
    v_perm_b32 v187, v87, v86, s48
    v_perm_b32 v188, v89, v88, s48
    v_perm_b32 v189, v91, v90, s48
    v_perm_b32 v190, v93, v92, s48
    v_perm_b32 v191, v95, v94, s48
    v_accvgpr_write_b32 a32, v176
    v_accvgpr_write_b32 a33, v177
    v_accvgpr_write_b32 a34, v178
    v_accvgpr_write_b32 a35, v179
    v_accvgpr_write_b32 a36, v180
    v_accvgpr_write_b32 a37, v181
    v_accvgpr_write_b32 a38, v182
    v_accvgpr_write_b32 a39, v183
    v_accvgpr_write_b32 a40, v184
    v_accvgpr_write_b32 a41, v185
    v_accvgpr_write_b32 a42, v186
    v_accvgpr_write_b32 a43, v187
    v_accvgpr_write_b32 a44, v188
    v_accvgpr_write_b32 a45, v189
    v_accvgpr_write_b32 a46, v190
    v_accvgpr_write_b32 a47, v191
    s_waitcnt vmcnt(32)
    s_mov_b32 s46, 3145728
    buffer_load_dword v80, v240, s[24:27], s46 offen
    s_mov_b32 s46, 3153920
    buffer_load_dword v81, v240, s[24:27], s46 offen
    s_mov_b32 s46, 3162112
    buffer_load_dword v82, v240, s[24:27], s46 offen
    s_mov_b32 s46, 3170304
    buffer_load_dword v83, v240, s[24:27], s46 offen
    s_mov_b32 s46, 3211264
    buffer_load_dword v84, v240, s[24:27], s46 offen
    s_mov_b32 s46, 3219456
    buffer_load_dword v85, v240, s[24:27], s46 offen
    s_mov_b32 s46, 3227648
    buffer_load_dword v86, v240, s[24:27], s46 offen
    s_mov_b32 s46, 3235840
    buffer_load_dword v87, v240, s[24:27], s46 offen
    s_mov_b32 s46, 3670016
    buffer_load_dword v88, v240, s[24:27], s46 offen
    s_mov_b32 s46, 3678208
    buffer_load_dword v89, v240, s[24:27], s46 offen
    s_mov_b32 s46, 3686400
    buffer_load_dword v90, v240, s[24:27], s46 offen
    s_mov_b32 s46, 3694592
    buffer_load_dword v91, v240, s[24:27], s46 offen
    s_mov_b32 s46, 3735552
    buffer_load_dword v92, v240, s[24:27], s46 offen
    s_mov_b32 s46, 3743744
    buffer_load_dword v93, v240, s[24:27], s46 offen
    s_mov_b32 s46, 3751936
    buffer_load_dword v94, v240, s[24:27], s46 offen
    s_mov_b32 s46, 3760128
    buffer_load_dword v95, v240, s[24:27], s46 offen
    v_perm_b32 v176, v97, v96, s47
    v_perm_b32 v177, v99, v98, s47
    v_perm_b32 v178, v101, v100, s47
    v_perm_b32 v179, v103, v102, s47
    v_perm_b32 v180, v105, v104, s47
    v_perm_b32 v181, v107, v106, s47
    v_perm_b32 v182, v109, v108, s47
    v_perm_b32 v183, v111, v110, s47
    v_perm_b32 v184, v97, v96, s48
    v_perm_b32 v185, v99, v98, s48
    v_perm_b32 v186, v101, v100, s48
    v_perm_b32 v187, v103, v102, s48
    v_perm_b32 v188, v105, v104, s48
    v_perm_b32 v189, v107, v106, s48
    v_perm_b32 v190, v109, v108, s48
    v_perm_b32 v191, v111, v110, s48
    v_accvgpr_write_b32 a48, v176
    v_accvgpr_write_b32 a49, v177
    v_accvgpr_write_b32 a50, v178
    v_accvgpr_write_b32 a51, v179
    v_accvgpr_write_b32 a52, v180
    v_accvgpr_write_b32 a53, v181
    v_accvgpr_write_b32 a54, v182
    v_accvgpr_write_b32 a55, v183
    v_accvgpr_write_b32 a56, v184
    v_accvgpr_write_b32 a57, v185
    v_accvgpr_write_b32 a58, v186
    v_accvgpr_write_b32 a59, v187
    v_accvgpr_write_b32 a60, v188
    v_accvgpr_write_b32 a61, v189
    v_accvgpr_write_b32 a62, v190
    v_accvgpr_write_b32 a63, v191
    s_waitcnt vmcnt(32)
    s_mov_b32 s46, 3178496
    buffer_load_dword v96, v240, s[24:27], s46 offen
    s_mov_b32 s46, 3186688
    buffer_load_dword v97, v240, s[24:27], s46 offen
    s_mov_b32 s46, 3194880
    buffer_load_dword v98, v240, s[24:27], s46 offen
    s_mov_b32 s46, 3203072
    buffer_load_dword v99, v240, s[24:27], s46 offen
    s_mov_b32 s46, 3244032
    buffer_load_dword v100, v240, s[24:27], s46 offen
    s_mov_b32 s46, 3252224
    buffer_load_dword v101, v240, s[24:27], s46 offen
    s_mov_b32 s46, 3260416
    buffer_load_dword v102, v240, s[24:27], s46 offen
    s_mov_b32 s46, 3268608
    buffer_load_dword v103, v240, s[24:27], s46 offen
    s_mov_b32 s46, 3702784
    buffer_load_dword v104, v240, s[24:27], s46 offen
    s_mov_b32 s46, 3710976
    buffer_load_dword v105, v240, s[24:27], s46 offen
    s_mov_b32 s46, 3719168
    buffer_load_dword v106, v240, s[24:27], s46 offen
    s_mov_b32 s46, 3727360
    buffer_load_dword v107, v240, s[24:27], s46 offen
    s_mov_b32 s46, 3768320
    buffer_load_dword v108, v240, s[24:27], s46 offen
    s_mov_b32 s46, 3776512
    buffer_load_dword v109, v240, s[24:27], s46 offen
    s_mov_b32 s46, 3784704
    buffer_load_dword v110, v240, s[24:27], s46 offen
    s_mov_b32 s46, 3792896
    buffer_load_dword v111, v240, s[24:27], s46 offen
    v_perm_b32 v176, v49, v48, s47
    v_perm_b32 v177, v51, v50, s47
    v_perm_b32 v178, v53, v52, s47
    v_perm_b32 v179, v55, v54, s47
    v_perm_b32 v180, v57, v56, s47
    v_perm_b32 v181, v59, v58, s47
    v_perm_b32 v182, v61, v60, s47
    v_perm_b32 v183, v63, v62, s47
    v_perm_b32 v184, v49, v48, s48
    v_perm_b32 v185, v51, v50, s48
    v_perm_b32 v186, v53, v52, s48
    v_perm_b32 v187, v55, v54, s48
    v_perm_b32 v188, v57, v56, s48
    v_perm_b32 v189, v59, v58, s48
    v_perm_b32 v190, v61, v60, s48
    v_perm_b32 v191, v63, v62, s48
    v_accvgpr_write_b32 a64, v176
    v_accvgpr_write_b32 a65, v177
    v_accvgpr_write_b32 a66, v178
    v_accvgpr_write_b32 a67, v179
    v_accvgpr_write_b32 a68, v180
    v_accvgpr_write_b32 a69, v181
    v_accvgpr_write_b32 a70, v182
    v_accvgpr_write_b32 a71, v183
    v_accvgpr_write_b32 a72, v184
    v_accvgpr_write_b32 a73, v185
    v_accvgpr_write_b32 a74, v186
    v_accvgpr_write_b32 a75, v187
    v_accvgpr_write_b32 a76, v188
    v_accvgpr_write_b32 a77, v189
    v_accvgpr_write_b32 a78, v190
    v_accvgpr_write_b32 a79, v191
    s_waitcnt vmcnt(32)
    s_mov_b32 s46, 0
    buffer_load_dword v48, v241, s[28:31], s46 offen
    s_mov_b32 s46, 8192
    buffer_load_dword v49, v241, s[28:31], s46 offen
    s_mov_b32 s46, 16384
    buffer_load_dword v50, v241, s[28:31], s46 offen
    s_mov_b32 s46, 24576
    buffer_load_dword v51, v241, s[28:31], s46 offen
    s_mov_b32 s46, 65536
    buffer_load_dword v52, v241, s[28:31], s46 offen
    s_mov_b32 s46, 73728
    buffer_load_dword v53, v241, s[28:31], s46 offen
    s_mov_b32 s46, 81920
    buffer_load_dword v54, v241, s[28:31], s46 offen
    s_mov_b32 s46, 90112
    buffer_load_dword v55, v241, s[28:31], s46 offen
    s_mov_b32 s46, 524288
    buffer_load_dword v56, v241, s[28:31], s46 offen
    s_mov_b32 s46, 532480
    buffer_load_dword v57, v241, s[28:31], s46 offen
    s_mov_b32 s46, 540672
    buffer_load_dword v58, v241, s[28:31], s46 offen
    s_mov_b32 s46, 548864
    buffer_load_dword v59, v241, s[28:31], s46 offen
    s_mov_b32 s46, 589824
    buffer_load_dword v60, v241, s[28:31], s46 offen
    s_mov_b32 s46, 598016
    buffer_load_dword v61, v241, s[28:31], s46 offen
    s_mov_b32 s46, 606208
    buffer_load_dword v62, v241, s[28:31], s46 offen
    s_mov_b32 s46, 614400
    buffer_load_dword v63, v241, s[28:31], s46 offen
    v_perm_b32 v176, v65, v64, s47
    v_perm_b32 v177, v67, v66, s47
    v_perm_b32 v178, v69, v68, s47
    v_perm_b32 v179, v71, v70, s47
    v_perm_b32 v180, v73, v72, s47
    v_perm_b32 v181, v75, v74, s47
    v_perm_b32 v182, v77, v76, s47
    v_perm_b32 v183, v79, v78, s47
    v_perm_b32 v184, v65, v64, s48
    v_perm_b32 v185, v67, v66, s48
    v_perm_b32 v186, v69, v68, s48
    v_perm_b32 v187, v71, v70, s48
    v_perm_b32 v188, v73, v72, s48
    v_perm_b32 v189, v75, v74, s48
    v_perm_b32 v190, v77, v76, s48
    v_perm_b32 v191, v79, v78, s48
    v_accvgpr_write_b32 a80, v176
    v_accvgpr_write_b32 a81, v177
    v_accvgpr_write_b32 a82, v178
    v_accvgpr_write_b32 a83, v179
    v_accvgpr_write_b32 a84, v180
    v_accvgpr_write_b32 a85, v181
    v_accvgpr_write_b32 a86, v182
    v_accvgpr_write_b32 a87, v183
    v_accvgpr_write_b32 a88, v184
    v_accvgpr_write_b32 a89, v185
    v_accvgpr_write_b32 a90, v186
    v_accvgpr_write_b32 a91, v187
    v_accvgpr_write_b32 a92, v188
    v_accvgpr_write_b32 a93, v189
    v_accvgpr_write_b32 a94, v190
    v_accvgpr_write_b32 a95, v191
    s_waitcnt vmcnt(32)
    s_mov_b32 s46, 32768
    buffer_load_dword v64, v241, s[28:31], s46 offen
    s_mov_b32 s46, 40960
    buffer_load_dword v65, v241, s[28:31], s46 offen
    s_mov_b32 s46, 49152
    buffer_load_dword v66, v241, s[28:31], s46 offen
    s_mov_b32 s46, 57344
    buffer_load_dword v67, v241, s[28:31], s46 offen
    s_mov_b32 s46, 98304
    buffer_load_dword v68, v241, s[28:31], s46 offen
    s_mov_b32 s46, 106496
    buffer_load_dword v69, v241, s[28:31], s46 offen
    s_mov_b32 s46, 114688
    buffer_load_dword v70, v241, s[28:31], s46 offen
    s_mov_b32 s46, 122880
    buffer_load_dword v71, v241, s[28:31], s46 offen
    s_mov_b32 s46, 557056
    buffer_load_dword v72, v241, s[28:31], s46 offen
    s_mov_b32 s46, 565248
    buffer_load_dword v73, v241, s[28:31], s46 offen
    s_mov_b32 s46, 573440
    buffer_load_dword v74, v241, s[28:31], s46 offen
    s_mov_b32 s46, 581632
    buffer_load_dword v75, v241, s[28:31], s46 offen
    s_mov_b32 s46, 622592
    buffer_load_dword v76, v241, s[28:31], s46 offen
    s_mov_b32 s46, 630784
    buffer_load_dword v77, v241, s[28:31], s46 offen
    s_mov_b32 s46, 638976
    buffer_load_dword v78, v241, s[28:31], s46 offen
    s_mov_b32 s46, 647168
    buffer_load_dword v79, v241, s[28:31], s46 offen
    v_perm_b32 v176, v81, v80, s47
    v_perm_b32 v177, v83, v82, s47
    v_perm_b32 v178, v85, v84, s47
    v_perm_b32 v179, v87, v86, s47
    v_perm_b32 v180, v89, v88, s47
    v_perm_b32 v181, v91, v90, s47
    v_perm_b32 v182, v93, v92, s47
    v_perm_b32 v183, v95, v94, s47
    v_perm_b32 v184, v81, v80, s48
    v_perm_b32 v185, v83, v82, s48
    v_perm_b32 v186, v85, v84, s48
    v_perm_b32 v187, v87, v86, s48
    v_perm_b32 v188, v89, v88, s48
    v_perm_b32 v189, v91, v90, s48
    v_perm_b32 v190, v93, v92, s48
    v_perm_b32 v191, v95, v94, s48
    v_accvgpr_write_b32 a96, v176
    v_accvgpr_write_b32 a97, v177
    v_accvgpr_write_b32 a98, v178
    v_accvgpr_write_b32 a99, v179
    v_accvgpr_write_b32 a100, v180
    v_accvgpr_write_b32 a101, v181
    v_accvgpr_write_b32 a102, v182
    v_accvgpr_write_b32 a103, v183
    v_accvgpr_write_b32 a104, v184
    v_accvgpr_write_b32 a105, v185
    v_accvgpr_write_b32 a106, v186
    v_accvgpr_write_b32 a107, v187
    v_accvgpr_write_b32 a108, v188
    v_accvgpr_write_b32 a109, v189
    v_accvgpr_write_b32 a110, v190
    v_accvgpr_write_b32 a111, v191
    s_waitcnt vmcnt(32)
    s_mov_b32 s46, 1048576
    buffer_load_dword v80, v241, s[28:31], s46 offen
    s_mov_b32 s46, 1056768
    buffer_load_dword v81, v241, s[28:31], s46 offen
    s_mov_b32 s46, 1064960
    buffer_load_dword v82, v241, s[28:31], s46 offen
    s_mov_b32 s46, 1073152
    buffer_load_dword v83, v241, s[28:31], s46 offen
    s_mov_b32 s46, 1114112
    buffer_load_dword v84, v241, s[28:31], s46 offen
    s_mov_b32 s46, 1122304
    buffer_load_dword v85, v241, s[28:31], s46 offen
    s_mov_b32 s46, 1130496
    buffer_load_dword v86, v241, s[28:31], s46 offen
    s_mov_b32 s46, 1138688
    buffer_load_dword v87, v241, s[28:31], s46 offen
    s_mov_b32 s46, 1572864
    buffer_load_dword v88, v241, s[28:31], s46 offen
    s_mov_b32 s46, 1581056
    buffer_load_dword v89, v241, s[28:31], s46 offen
    s_mov_b32 s46, 1589248
    buffer_load_dword v90, v241, s[28:31], s46 offen
    s_mov_b32 s46, 1597440
    buffer_load_dword v91, v241, s[28:31], s46 offen
    s_mov_b32 s46, 1638400
    buffer_load_dword v92, v241, s[28:31], s46 offen
    s_mov_b32 s46, 1646592
    buffer_load_dword v93, v241, s[28:31], s46 offen
    s_mov_b32 s46, 1654784
    buffer_load_dword v94, v241, s[28:31], s46 offen
    s_mov_b32 s46, 1662976
    buffer_load_dword v95, v241, s[28:31], s46 offen
    v_perm_b32 v176, v97, v96, s47
    v_perm_b32 v177, v99, v98, s47
    v_perm_b32 v178, v101, v100, s47
    v_perm_b32 v179, v103, v102, s47
    v_perm_b32 v180, v105, v104, s47
    v_perm_b32 v181, v107, v106, s47
    v_perm_b32 v182, v109, v108, s47
    v_perm_b32 v183, v111, v110, s47
    v_perm_b32 v184, v97, v96, s48
    v_perm_b32 v185, v99, v98, s48
    v_perm_b32 v186, v101, v100, s48
    v_perm_b32 v187, v103, v102, s48
    v_perm_b32 v188, v105, v104, s48
    v_perm_b32 v189, v107, v106, s48
    v_perm_b32 v190, v109, v108, s48
    v_perm_b32 v191, v111, v110, s48
    v_accvgpr_write_b32 a112, v176
    v_accvgpr_write_b32 a113, v177
    v_accvgpr_write_b32 a114, v178
    v_accvgpr_write_b32 a115, v179
    v_accvgpr_write_b32 a116, v180
    v_accvgpr_write_b32 a117, v181
    v_accvgpr_write_b32 a118, v182
    v_accvgpr_write_b32 a119, v183
    v_accvgpr_write_b32 a120, v184
    v_accvgpr_write_b32 a121, v185
    v_accvgpr_write_b32 a122, v186
    v_accvgpr_write_b32 a123, v187
    v_accvgpr_write_b32 a124, v188
    v_accvgpr_write_b32 a125, v189
    v_accvgpr_write_b32 a126, v190
    v_accvgpr_write_b32 a127, v191
    s_waitcnt vmcnt(32)
    s_mov_b32 s46, 1081344
    buffer_load_dword v96, v241, s[28:31], s46 offen
    s_mov_b32 s46, 1089536
    buffer_load_dword v97, v241, s[28:31], s46 offen
    s_mov_b32 s46, 1097728
    buffer_load_dword v98, v241, s[28:31], s46 offen
    s_mov_b32 s46, 1105920
    buffer_load_dword v99, v241, s[28:31], s46 offen
    s_mov_b32 s46, 1146880
    buffer_load_dword v100, v241, s[28:31], s46 offen
    s_mov_b32 s46, 1155072
    buffer_load_dword v101, v241, s[28:31], s46 offen
    s_mov_b32 s46, 1163264
    buffer_load_dword v102, v241, s[28:31], s46 offen
    s_mov_b32 s46, 1171456
    buffer_load_dword v103, v241, s[28:31], s46 offen
    s_mov_b32 s46, 1605632
    buffer_load_dword v104, v241, s[28:31], s46 offen
    s_mov_b32 s46, 1613824
    buffer_load_dword v105, v241, s[28:31], s46 offen
    s_mov_b32 s46, 1622016
    buffer_load_dword v106, v241, s[28:31], s46 offen
    s_mov_b32 s46, 1630208
    buffer_load_dword v107, v241, s[28:31], s46 offen
    s_mov_b32 s46, 1671168
    buffer_load_dword v108, v241, s[28:31], s46 offen
    s_mov_b32 s46, 1679360
    buffer_load_dword v109, v241, s[28:31], s46 offen
    s_mov_b32 s46, 1687552
    buffer_load_dword v110, v241, s[28:31], s46 offen
    s_mov_b32 s46, 1695744
    buffer_load_dword v111, v241, s[28:31], s46 offen
    v_perm_b32 v176, v49, v48, s47
    v_perm_b32 v177, v51, v50, s47
    v_perm_b32 v178, v53, v52, s47
    v_perm_b32 v179, v55, v54, s47
    v_perm_b32 v180, v57, v56, s47
    v_perm_b32 v181, v59, v58, s47
    v_perm_b32 v182, v61, v60, s47
    v_perm_b32 v183, v63, v62, s47
    v_perm_b32 v184, v49, v48, s48
    v_perm_b32 v185, v51, v50, s48
    v_perm_b32 v186, v53, v52, s48
    v_perm_b32 v187, v55, v54, s48
    v_perm_b32 v188, v57, v56, s48
    v_perm_b32 v189, v59, v58, s48
    v_perm_b32 v190, v61, v60, s48
    v_perm_b32 v191, v63, v62, s48
    v_accvgpr_write_b32 a128, v176
    v_accvgpr_write_b32 a129, v177
    v_accvgpr_write_b32 a130, v178
    v_accvgpr_write_b32 a131, v179
    v_accvgpr_write_b32 a132, v180
    v_accvgpr_write_b32 a133, v181
    v_accvgpr_write_b32 a134, v182
    v_accvgpr_write_b32 a135, v183
    v_accvgpr_write_b32 a136, v184
    v_accvgpr_write_b32 a137, v185
    v_accvgpr_write_b32 a138, v186
    v_accvgpr_write_b32 a139, v187
    v_accvgpr_write_b32 a140, v188
    v_accvgpr_write_b32 a141, v189
    v_accvgpr_write_b32 a142, v190
    v_accvgpr_write_b32 a143, v191
    s_waitcnt vmcnt(32)
    s_mov_b32 s46, 2097152
    buffer_load_dword v48, v241, s[28:31], s46 offen
    s_mov_b32 s46, 2105344
    buffer_load_dword v49, v241, s[28:31], s46 offen
    s_mov_b32 s46, 2113536
    buffer_load_dword v50, v241, s[28:31], s46 offen
    s_mov_b32 s46, 2121728
    buffer_load_dword v51, v241, s[28:31], s46 offen
    s_mov_b32 s46, 2162688
    buffer_load_dword v52, v241, s[28:31], s46 offen
    s_mov_b32 s46, 2170880
    buffer_load_dword v53, v241, s[28:31], s46 offen
    s_mov_b32 s46, 2179072
    buffer_load_dword v54, v241, s[28:31], s46 offen
    s_mov_b32 s46, 2187264
    buffer_load_dword v55, v241, s[28:31], s46 offen
    s_mov_b32 s46, 2621440
    buffer_load_dword v56, v241, s[28:31], s46 offen
    s_mov_b32 s46, 2629632
    buffer_load_dword v57, v241, s[28:31], s46 offen
    s_mov_b32 s46, 2637824
    buffer_load_dword v58, v241, s[28:31], s46 offen
    s_mov_b32 s46, 2646016
    buffer_load_dword v59, v241, s[28:31], s46 offen
    s_mov_b32 s46, 2686976
    buffer_load_dword v60, v241, s[28:31], s46 offen
    s_mov_b32 s46, 2695168
    buffer_load_dword v61, v241, s[28:31], s46 offen
    s_mov_b32 s46, 2703360
    buffer_load_dword v62, v241, s[28:31], s46 offen
    s_mov_b32 s46, 2711552
    buffer_load_dword v63, v241, s[28:31], s46 offen
    v_perm_b32 v176, v65, v64, s47
    v_perm_b32 v177, v67, v66, s47
    v_perm_b32 v178, v69, v68, s47
    v_perm_b32 v179, v71, v70, s47
    v_perm_b32 v180, v73, v72, s47
    v_perm_b32 v181, v75, v74, s47
    v_perm_b32 v182, v77, v76, s47
    v_perm_b32 v183, v79, v78, s47
    v_perm_b32 v184, v65, v64, s48
    v_perm_b32 v185, v67, v66, s48
    v_perm_b32 v186, v69, v68, s48
    v_perm_b32 v187, v71, v70, s48
    v_perm_b32 v188, v73, v72, s48
    v_perm_b32 v189, v75, v74, s48
    v_perm_b32 v190, v77, v76, s48
    v_perm_b32 v191, v79, v78, s48
    v_accvgpr_write_b32 a144, v176
    v_accvgpr_write_b32 a145, v177
    v_accvgpr_write_b32 a146, v178
    v_accvgpr_write_b32 a147, v179
    v_accvgpr_write_b32 a148, v180
    v_accvgpr_write_b32 a149, v181
    v_accvgpr_write_b32 a150, v182
    v_accvgpr_write_b32 a151, v183
    v_accvgpr_write_b32 a152, v184
    v_accvgpr_write_b32 a153, v185
    v_accvgpr_write_b32 a154, v186
    v_accvgpr_write_b32 a155, v187
    v_accvgpr_write_b32 a156, v188
    v_accvgpr_write_b32 a157, v189
    v_accvgpr_write_b32 a158, v190
    v_accvgpr_write_b32 a159, v191
    s_waitcnt vmcnt(32)
    s_mov_b32 s46, 2129920
    buffer_load_dword v64, v241, s[28:31], s46 offen
    s_mov_b32 s46, 2138112
    buffer_load_dword v65, v241, s[28:31], s46 offen
    s_mov_b32 s46, 2146304
    buffer_load_dword v66, v241, s[28:31], s46 offen
    s_mov_b32 s46, 2154496
    buffer_load_dword v67, v241, s[28:31], s46 offen
    s_mov_b32 s46, 2195456
    buffer_load_dword v68, v241, s[28:31], s46 offen
    s_mov_b32 s46, 2203648
    buffer_load_dword v69, v241, s[28:31], s46 offen
    s_mov_b32 s46, 2211840
    buffer_load_dword v70, v241, s[28:31], s46 offen
    s_mov_b32 s46, 2220032
    buffer_load_dword v71, v241, s[28:31], s46 offen
    s_mov_b32 s46, 2654208
    buffer_load_dword v72, v241, s[28:31], s46 offen
    s_mov_b32 s46, 2662400
    buffer_load_dword v73, v241, s[28:31], s46 offen
    s_mov_b32 s46, 2670592
    buffer_load_dword v74, v241, s[28:31], s46 offen
    s_mov_b32 s46, 2678784
    buffer_load_dword v75, v241, s[28:31], s46 offen
    s_mov_b32 s46, 2719744
    buffer_load_dword v76, v241, s[28:31], s46 offen
    s_mov_b32 s46, 2727936
    buffer_load_dword v77, v241, s[28:31], s46 offen
    s_mov_b32 s46, 2736128
    buffer_load_dword v78, v241, s[28:31], s46 offen
    s_mov_b32 s46, 2744320
    buffer_load_dword v79, v241, s[28:31], s46 offen
    v_perm_b32 v176, v81, v80, s47
    v_perm_b32 v177, v83, v82, s47
    v_perm_b32 v178, v85, v84, s47
    v_perm_b32 v179, v87, v86, s47
    v_perm_b32 v180, v89, v88, s47
    v_perm_b32 v181, v91, v90, s47
    v_perm_b32 v182, v93, v92, s47
    v_perm_b32 v183, v95, v94, s47
    v_perm_b32 v184, v81, v80, s48
    v_perm_b32 v185, v83, v82, s48
    v_perm_b32 v186, v85, v84, s48
    v_perm_b32 v187, v87, v86, s48
    v_perm_b32 v188, v89, v88, s48
    v_perm_b32 v189, v91, v90, s48
    v_perm_b32 v190, v93, v92, s48
    v_perm_b32 v191, v95, v94, s48
    v_accvgpr_write_b32 a160, v176
    v_accvgpr_write_b32 a161, v177
    v_accvgpr_write_b32 a162, v178
    v_accvgpr_write_b32 a163, v179
    v_accvgpr_write_b32 a164, v180
    v_accvgpr_write_b32 a165, v181
    v_accvgpr_write_b32 a166, v182
    v_accvgpr_write_b32 a167, v183
    v_accvgpr_write_b32 a168, v184
    v_accvgpr_write_b32 a169, v185
    v_accvgpr_write_b32 a170, v186
    v_accvgpr_write_b32 a171, v187
    v_accvgpr_write_b32 a172, v188
    v_accvgpr_write_b32 a173, v189
    v_accvgpr_write_b32 a174, v190
    v_accvgpr_write_b32 a175, v191
    s_waitcnt vmcnt(32)
    s_mov_b32 s46, 3145728
    buffer_load_dword v80, v241, s[28:31], s46 offen
    s_mov_b32 s46, 3153920
    buffer_load_dword v81, v241, s[28:31], s46 offen
    s_mov_b32 s46, 3162112
    buffer_load_dword v82, v241, s[28:31], s46 offen
    s_mov_b32 s46, 3170304
    buffer_load_dword v83, v241, s[28:31], s46 offen
    s_mov_b32 s46, 3211264
    buffer_load_dword v84, v241, s[28:31], s46 offen
    s_mov_b32 s46, 3219456
    buffer_load_dword v85, v241, s[28:31], s46 offen
    s_mov_b32 s46, 3227648
    buffer_load_dword v86, v241, s[28:31], s46 offen
    s_mov_b32 s46, 3235840
    buffer_load_dword v87, v241, s[28:31], s46 offen
    s_mov_b32 s46, 3670016
    buffer_load_dword v88, v241, s[28:31], s46 offen
    s_mov_b32 s46, 3678208
    buffer_load_dword v89, v241, s[28:31], s46 offen
    s_mov_b32 s46, 3686400
    buffer_load_dword v90, v241, s[28:31], s46 offen
    s_mov_b32 s46, 3694592
    buffer_load_dword v91, v241, s[28:31], s46 offen
    s_mov_b32 s46, 3735552
    buffer_load_dword v92, v241, s[28:31], s46 offen
    s_mov_b32 s46, 3743744
    buffer_load_dword v93, v241, s[28:31], s46 offen
    s_mov_b32 s46, 3751936
    buffer_load_dword v94, v241, s[28:31], s46 offen
    s_mov_b32 s46, 3760128
    buffer_load_dword v95, v241, s[28:31], s46 offen
    v_perm_b32 v176, v97, v96, s47
    v_perm_b32 v177, v99, v98, s47
    v_perm_b32 v178, v101, v100, s47
    v_perm_b32 v179, v103, v102, s47
    v_perm_b32 v180, v105, v104, s47
    v_perm_b32 v181, v107, v106, s47
    v_perm_b32 v182, v109, v108, s47
    v_perm_b32 v183, v111, v110, s47
    v_perm_b32 v184, v97, v96, s48
    v_perm_b32 v185, v99, v98, s48
    v_perm_b32 v186, v101, v100, s48
    v_perm_b32 v187, v103, v102, s48
    v_perm_b32 v188, v105, v104, s48
    v_perm_b32 v189, v107, v106, s48
    v_perm_b32 v190, v109, v108, s48
    v_perm_b32 v191, v111, v110, s48
    v_accvgpr_write_b32 a176, v176
    v_accvgpr_write_b32 a177, v177
    v_accvgpr_write_b32 a178, v178
    v_accvgpr_write_b32 a179, v179
    v_accvgpr_write_b32 a180, v180
    v_accvgpr_write_b32 a181, v181
    v_accvgpr_write_b32 a182, v182
    v_accvgpr_write_b32 a183, v183
    v_accvgpr_write_b32 a184, v184
    v_accvgpr_write_b32 a185, v185
    v_accvgpr_write_b32 a186, v186
    v_accvgpr_write_b32 a187, v187
    v_accvgpr_write_b32 a188, v188
    v_accvgpr_write_b32 a189, v189
    v_accvgpr_write_b32 a190, v190
    v_accvgpr_write_b32 a191, v191
    s_waitcnt vmcnt(32)
    s_mov_b32 s46, 3178496
    buffer_load_dword v96, v241, s[28:31], s46 offen
    s_mov_b32 s46, 3186688
    buffer_load_dword v97, v241, s[28:31], s46 offen
    s_mov_b32 s46, 3194880
    buffer_load_dword v98, v241, s[28:31], s46 offen
    s_mov_b32 s46, 3203072
    buffer_load_dword v99, v241, s[28:31], s46 offen
    s_mov_b32 s46, 3244032
    buffer_load_dword v100, v241, s[28:31], s46 offen
    s_mov_b32 s46, 3252224
    buffer_load_dword v101, v241, s[28:31], s46 offen
    s_mov_b32 s46, 3260416
    buffer_load_dword v102, v241, s[28:31], s46 offen
    s_mov_b32 s46, 3268608
    buffer_load_dword v103, v241, s[28:31], s46 offen
    s_mov_b32 s46, 3702784
    buffer_load_dword v104, v241, s[28:31], s46 offen
    s_mov_b32 s46, 3710976
    buffer_load_dword v105, v241, s[28:31], s46 offen
    s_mov_b32 s46, 3719168
    buffer_load_dword v106, v241, s[28:31], s46 offen
    s_mov_b32 s46, 3727360
    buffer_load_dword v107, v241, s[28:31], s46 offen
    s_mov_b32 s46, 3768320
    buffer_load_dword v108, v241, s[28:31], s46 offen
    s_mov_b32 s46, 3776512
    buffer_load_dword v109, v241, s[28:31], s46 offen
    s_mov_b32 s46, 3784704
    buffer_load_dword v110, v241, s[28:31], s46 offen
    s_mov_b32 s46, 3792896
    buffer_load_dword v111, v241, s[28:31], s46 offen
    v_perm_b32 v176, v49, v48, s47
    v_perm_b32 v177, v51, v50, s47
    v_perm_b32 v178, v53, v52, s47
    v_perm_b32 v179, v55, v54, s47
    v_perm_b32 v180, v57, v56, s47
    v_perm_b32 v181, v59, v58, s47
    v_perm_b32 v182, v61, v60, s47
    v_perm_b32 v183, v63, v62, s47
    v_perm_b32 v184, v49, v48, s48
    v_perm_b32 v185, v51, v50, s48
    v_perm_b32 v186, v53, v52, s48
    v_perm_b32 v187, v55, v54, s48
    v_perm_b32 v188, v57, v56, s48
    v_perm_b32 v189, v59, v58, s48
    v_perm_b32 v190, v61, v60, s48
    v_perm_b32 v191, v63, v62, s48
    v_accvgpr_write_b32 a192, v176
    v_accvgpr_write_b32 a193, v177
    v_accvgpr_write_b32 a194, v178
    v_accvgpr_write_b32 a195, v179
    v_accvgpr_write_b32 a196, v180
    v_accvgpr_write_b32 a197, v181
    v_accvgpr_write_b32 a198, v182
    v_accvgpr_write_b32 a199, v183
    v_accvgpr_write_b32 a200, v184
    v_accvgpr_write_b32 a201, v185
    v_accvgpr_write_b32 a202, v186
    v_accvgpr_write_b32 a203, v187
    v_accvgpr_write_b32 a204, v188
    v_accvgpr_write_b32 a205, v189
    v_accvgpr_write_b32 a206, v190
    v_accvgpr_write_b32 a207, v191
    s_waitcnt vmcnt(32)
    v_perm_b32 v176, v65, v64, s47
    v_perm_b32 v177, v67, v66, s47
    v_perm_b32 v178, v69, v68, s47
    v_perm_b32 v179, v71, v70, s47
    v_perm_b32 v180, v73, v72, s47
    v_perm_b32 v181, v75, v74, s47
    v_perm_b32 v182, v77, v76, s47
    v_perm_b32 v183, v79, v78, s47
    v_perm_b32 v184, v65, v64, s48
    v_perm_b32 v185, v67, v66, s48
    v_perm_b32 v186, v69, v68, s48
    v_perm_b32 v187, v71, v70, s48
    v_perm_b32 v188, v73, v72, s48
    v_perm_b32 v189, v75, v74, s48
    v_perm_b32 v190, v77, v76, s48
    v_perm_b32 v191, v79, v78, s48
    v_accvgpr_write_b32 a208, v176
    v_accvgpr_write_b32 a209, v177
    v_accvgpr_write_b32 a210, v178
    v_accvgpr_write_b32 a211, v179
    v_accvgpr_write_b32 a212, v180
    v_accvgpr_write_b32 a213, v181
    v_accvgpr_write_b32 a214, v182
    v_accvgpr_write_b32 a215, v183
    v_accvgpr_write_b32 a216, v184
    v_accvgpr_write_b32 a217, v185
    v_accvgpr_write_b32 a218, v186
    v_accvgpr_write_b32 a219, v187
    v_accvgpr_write_b32 a220, v188
    v_accvgpr_write_b32 a221, v189
    v_accvgpr_write_b32 a222, v190
    v_accvgpr_write_b32 a223, v191
    s_waitcnt vmcnt(16)
    v_perm_b32 v176, v81, v80, s47
    v_perm_b32 v177, v83, v82, s47
    v_perm_b32 v178, v85, v84, s47
    v_perm_b32 v179, v87, v86, s47
    v_perm_b32 v180, v89, v88, s47
    v_perm_b32 v181, v91, v90, s47
    v_perm_b32 v182, v93, v92, s47
    v_perm_b32 v183, v95, v94, s47
    v_perm_b32 v184, v81, v80, s48
    v_perm_b32 v185, v83, v82, s48
    v_perm_b32 v186, v85, v84, s48
    v_perm_b32 v187, v87, v86, s48
    v_perm_b32 v188, v89, v88, s48
    v_perm_b32 v189, v91, v90, s48
    v_perm_b32 v190, v93, v92, s48
    v_perm_b32 v191, v95, v94, s48
    v_accvgpr_write_b32 a224, v176
    v_accvgpr_write_b32 a225, v177
    v_accvgpr_write_b32 a226, v178
    v_accvgpr_write_b32 a227, v179
    v_accvgpr_write_b32 a228, v180
    v_accvgpr_write_b32 a229, v181
    v_accvgpr_write_b32 a230, v182
    v_accvgpr_write_b32 a231, v183
    v_accvgpr_write_b32 a232, v184
    v_accvgpr_write_b32 a233, v185
    v_accvgpr_write_b32 a234, v186
    v_accvgpr_write_b32 a235, v187
    v_accvgpr_write_b32 a236, v188
    v_accvgpr_write_b32 a237, v189
    v_accvgpr_write_b32 a238, v190
    v_accvgpr_write_b32 a239, v191
    s_waitcnt vmcnt(0)
    v_perm_b32 v176, v97, v96, s47
    v_perm_b32 v177, v99, v98, s47
    v_perm_b32 v178, v101, v100, s47
    v_perm_b32 v179, v103, v102, s47
    v_perm_b32 v180, v105, v104, s47
    v_perm_b32 v181, v107, v106, s47
    v_perm_b32 v182, v109, v108, s47
    v_perm_b32 v183, v111, v110, s47
    v_perm_b32 v184, v97, v96, s48
    v_perm_b32 v185, v99, v98, s48
    v_perm_b32 v186, v101, v100, s48
    v_perm_b32 v187, v103, v102, s48
    v_perm_b32 v188, v105, v104, s48
    v_perm_b32 v189, v107, v106, s48
    v_perm_b32 v190, v109, v108, s48
    v_perm_b32 v191, v111, v110, s48
    v_accvgpr_write_b32 a240, v176
    v_accvgpr_write_b32 a241, v177
    v_accvgpr_write_b32 a242, v178
    v_accvgpr_write_b32 a243, v179
    v_accvgpr_write_b32 a244, v180
    v_accvgpr_write_b32 a245, v181
    v_accvgpr_write_b32 a246, v182
    v_accvgpr_write_b32 a247, v183
    v_accvgpr_write_b32 a248, v184
    v_accvgpr_write_b32 a249, v185
    v_accvgpr_write_b32 a250, v186
    v_accvgpr_write_b32 a251, v187
    v_accvgpr_write_b32 a252, v188
    v_accvgpr_write_b32 a253, v189
    v_accvgpr_write_b32 a254, v190
    v_accvgpr_write_b32 a255, v191
    v_mov_b32 v10, 0
    s_mov_b32 s49, 0
    s_cmp_eq_u32 s18, 0
    s_cbranch_scc0 L_wc_7_x
L_wc_7:
    global_load_dword v11, v10, s[16:17] offset:32 sc1
    s_waitcnt vmcnt(0)
    v_readfirstlane_b32 s48, v11
    s_add_u32 s49, s49, 1
    s_cmp_ge_u32 s49, 200000
    s_cbranch_scc1 L_wc_7_x
    s_cmp_ge_u32 s48, 100
    s_cbranch_scc1 L_wc_7_x
    s_branch L_wc_7
L_wc_7_x:
    s_barrier
    v_mov_b32 v10, 0
    s_mov_b32 s49, 0
    s_cmp_eq_u32 s18, 0
    s_cbranch_scc0 L_wc_8_x
L_wc_8:
    global_load_dword v11, v10, s[16:17] offset:132 sc1
    s_waitcnt vmcnt(0)
    v_readfirstlane_b32 s48, v11
    s_add_u32 s49, s49, 1
    s_cmp_ge_u32 s49, 200000
    s_cbranch_scc1 L_wc_8_x
    s_cmp_ge_u32 s48, 32
    s_cbranch_scc1 L_wc_8_x
    s_branch L_wc_8
L_wc_8_x:
    s_barrier
    v_mov_b32 v10, 0
    s_mov_b32 s49, 0
    s_cmp_eq_u32 s18, 0
    s_cbranch_scc0 L_wc_9_x
L_wc_9:
    global_load_dword v11, v10, s[16:17] offset:148 sc1
    s_waitcnt vmcnt(0)
    v_readfirstlane_b32 s48, v11
    s_add_u32 s49, s49, 1
    s_cmp_ge_u32 s49, 200000
    s_cbranch_scc1 L_wc_9_x
    s_cmp_ge_u32 s48, 128
    s_cbranch_scc1 L_wc_9_x
    s_branch L_wc_9
L_wc_9_x:
    s_barrier
    v_mov_b32 v10, 0
    s_mov_b32 s49, 0
    s_cmp_eq_u32 s18, 0
    s_cbranch_scc0 L_wc_10_x
L_wc_10:
    global_load_dword v11, v10, s[16:17] offset:108 sc1
    s_waitcnt vmcnt(0)
    v_readfirstlane_b32 s48, v11
    s_add_u32 s49, s49, 1
    s_cmp_ge_u32 s49, 200000
    s_cbranch_scc1 L_wc_10_x
    s_cmp_ge_u32 s48, 64
    s_cbranch_scc1 L_wc_10_x
    s_branch L_wc_10
L_wc_10_x:
    s_barrier
    s_sub_u32 s63, s60, 1
    s_mov_b32 s64, 0
    s_lshl_b32 s65, s63, 21
    s_add_u32 s65, s65, 83886080
    s_lshl_b32 s66, s60, 9
    s_add_u32 s66, s66, 573440
    s_lshl_b32 s46, s18, 7
    s_lshl_b32 s47, s62, 2
    s_add_u32 s85, s66, s46
    s_add_u32 s85, s85, s47
    s_lshr_b32 s46, s62, 3
    s_lshl_b32 s46, s46, 7
    s_add_u32 s87, s66, s46
    s_mov_b32 s84, 0
    s_mov_b32 s79, 0
    s_lshl_b32 s78, s18, 11
    v_add_u32 v9, s78, v1
    s_min_u32 s46, s63, 63
    s_cmp_eq_u32 s46, 0
    s_cselect_b32 s47, 64, s46
    s_lshl_b32 s68, s47, 13
    s_add_u32 s68, s68, 1048576
    s_lshl_b32 s46, s46, 18
    s_lshl_b32 s47, s62, 13
    s_add_u32 s46, s46, s47
    s_add_u32 s70, s46, 33554432
    s_and_b32 s47, s18, 1
    s_lshl_b32 s47, s47, 12
    s_add_u32 s69, s46, s47
    s_add_u32 s69, s69, 67108864
    s_lshr_b32 s47, s18, 1
    s_lshl_b32 s47, s47, 12
    s_add_u32 s71, s46, s47
    s_add_u32 s71, s71, 50331648
    s_add_u32 m0, s78, 17472
    s_nop 0
    buffer_load_dwordx4 v9, s[8:11], s70 offen offset:0 sc1 lds
    buffer_load_dwordx4 v9, s[8:11], s70 offen offset:1024 sc1 lds
    buffer_load_dwordx4 v[60:63], v1, s[8:11], s69 offen offset:0 sc1
    buffer_load_dwordx4 v[64:67], v1, s[8:11], s69 offen offset:1024 sc1
    buffer_load_dwordx4 v[68:71], v1, s[8:11], s69 offen offset:2048 sc1
    buffer_load_dwordx4 v[72:75], v1, s[8:11], s69 offen offset:3072 sc1
    buffer_load_dwordx4 v[240:243], v9, s[8:11], s68 offen offset:0 sc1
    buffer_load_dwordx4 v[244:247], v9, s[8:11], s68 offen offset:1024 sc1
    buffer_load_dwordx4 v[108:111], v1, s[8:11], s71 offen offset:0 sc1
    buffer_load_dwordx4 v[112:115], v1, s[8:11], s71 offen offset:1024 sc1
    buffer_load_dwordx4 v[116:119], v1, s[8:11], s71 offen offset:2048 sc1
    buffer_load_dwordx4 v[120:123], v1, s[8:11], s71 offen offset:3072 sc1
    s_mov_b32 s73, s65
    s_waitcnt vmcnt(0)
L_xa_loop:
    s_mov_b32 s74, 0
    v_mov_b64 v[124:125], 0
    v_mov_b64 v[126:127], 0
    v_mov_b64 v[128:129], 0
    v_mov_b64 v[130:131], 0
    v_mov_b64 v[132:133], 0
    v_mov_b64 v[134:135], 0
    v_mov_b64 v[136:137], 0
    v_mov_b64 v[138:139], 0
    s_cmp_eq_u32 s84, 0
    s_cbranch_scc1 L_xa_np_11
    s_waitcnt vmcnt(0)
    v_mov_b32 v10, 0
    v_mov_b32 v11, s64
    s_mov_b64 exec, 1
    buffer_store_dword v11, v10, s[8:11], s85 offen
    s_mov_b64 exec, -1
L_xa_np_11:
    s_cmp_ge_u32 s63, 64
    s_cbranch_scc1 L_xa_late
L_xa_poll:
    s_waitcnt vmcnt(1)
    v_max3_u32 v10, v240, v241, v242
    v_max3_u32 v11, v243, v244, v245
    v_max3_u32 v10, v10, v246, v247
    v_max_u32 v10, v10, v11
    v_cmp_eq_u32 vcc, -1, v10
    s_add_u32 s74, s74, 1
    s_cmp_ge_u32 s74, 200000
    s_cbranch_scc1 L_xa_go
    s_cbranch_vccz L_xa_go
L_xa_late:
    s_cmp_eq_u32 s84, 0
    s_cbranch_scc1 L_xa_np_12
    buffer_load_dword v248, v8, s[8:11], s87 offen sc1
    s_mov_b32 s74, 0
L_xa_fl_13:
    s_waitcnt vmcnt(0)
    v_cmp_gt_u32 vcc, s64, v248
    s_add_u32 s74, s74, 1
    s_cmp_ge_u32 s74, 200000
    s_cbranch_scc1 L_xa_fl_13_x
    s_cbranch_vccz L_xa_fl_13_x
    buffer_load_dword v248, v8, s[8:11], s87 offen sc1
    s_branch L_xa_fl_13
L_xa_fl_13_x:
    buffer_load_dwordx4 v[188:191], v5, s[8:11], s73 offen sc1
    s_add_u32 s73, s73, 4096
    buffer_load_dwordx4 v[192:195], v5, s[8:11], s73 offen sc1
    s_add_u32 s73, s73, 4096
    buffer_load_dwordx4 v[196:199], v5, s[8:11], s73 offen sc1
    s_add_u32 s73, s73, 4096
    buffer_load_dwordx4 v[200:203], v5, s[8:11], s73 offen sc1
    s_add_u32 s73, s73, 4096
    buffer_load_dwordx4 v[204:207], v5, s[8:11], s73 offen sc1
    s_add_u32 s73, s73, 4096
    buffer_load_dwordx4 v[208:211], v5, s[8:11], s73 offen sc1
    s_add_u32 s73, s73, 4096
    buffer_load_dwordx4 v[212:215], v5, s[8:11], s73 offen sc1
    s_add_u32 s73, s73, 4096
    buffer_load_dwordx4 v[216:219], v5, s[8:11], s73 offen sc1
    s_add_u32 s73, s73, 4096
    s_waitcnt vmcnt(7)
    v_mfma_f32_16x16x32_bf16 v[184:187], v[16:19], v[188:191], 0
    s_waitcnt vmcnt(6)
    v_mfma_f32_16x16x32_bf16 v[184:187], v[16:19], v[192:195], v[184:187]
    s_waitcnt vmcnt(5)
    v_mfma_f32_16x16x32_bf16 v[184:187], v[16:19], v[196:199], v[184:187]
    s_waitcnt vmcnt(4)
    v_mfma_f32_16x16x32_bf16 v[184:187], v[16:19], v[200:203], v[184:187]
    s_waitcnt vmcnt(3)
    v_mfma_f32_16x16x32_bf16 v[184:187], v[16:19], v[204:207], v[184:187]
    s_waitcnt vmcnt(2)
    v_mfma_f32_16x16x32_bf16 v[184:187], v[16:19], v[208:211], v[184:187]
    s_waitcnt vmcnt(1)
    v_mfma_f32_16x16x32_bf16 v[184:187], v[16:19], v[212:215], v[184:187]
    s_waitcnt vmcnt(0)
    v_mfma_f32_16x16x32_bf16 v[184:187], v[16:19], v[216:219], v[184:187]
    s_nop 7
    v_cvt_pk_bf16_f32 v186, v184, v185
    buffer_store_dword v186, v6, s[20:23], s75 offen nt
    s_mov_b32 s84, 0
L_xa_np_12:
    s_cmp_lt_u32 s63, 64
    s_cbranch_scc1 L_xa_more
    s_endpgm
L_xa_more:
    buffer_load_dwordx4 v[240:243], v9, s[8:11], s68 offen offset:0 sc1
    buffer_load_dwordx4 v[244:247], v9, s[8:11], s68 offen offset:1024 sc1
    s_waitcnt vmcnt(0)
    s_branch L_xa_poll
L_xa_go:
    ds_write_b128 v9, v[240:243] offset:9280
    ds_write_b128 v9, v[244:247] offset:10304
    s_waitcnt lgkmcnt(0)
    s_barrier
    ds_read_b128 v[28:31], v1 offset:9280
    ds_read_b128 v[32:35], v1 offset:10304
    ds_read_b128 v[36:39], v1 offset:11328
    ds_read_b128 v[40:43], v1 offset:12352
    ds_read_b128 v[44:47], v1 offset:13376
    ds_read_b128 v[48:51], v1 offset:14400
    ds_read_b128 v[52:55], v1 offset:15424
    ds_read_b128 v[56:59], v1 offset:16448
    s_waitcnt lgkmcnt(7)
    v_smfmac_f32_16x16x64_bf16 v[124:127], v[28:31], a[0:7], v4
    ds_read_b128 v[76:79], v1 offset:17472
    v_smfmac_f32_16x16x64_bf16 v[128:131], v[28:31], a[8:15], v4
    s_waitcnt lgkmcnt(7)
    v_smfmac_f32_16x16x64_bf16 v[124:127], v[32:35], a[16:23], v4
    ds_read_b128 v[80:83], v1 offset:18496
    v_smfmac_f32_16x16x64_bf16 v[128:131], v[32:35], a[24:31], v4
    s_waitcnt lgkmcnt(7)
    v_smfmac_f32_16x16x64_bf16 v[124:127], v[36:39], a[32:39], v4
    ds_read_b128 v[84:87], v1 offset:19520
    v_smfmac_f32_16x16x64_bf16 v[128:131], v[36:39], a[40:47], v4
    s_waitcnt lgkmcnt(7)
    v_smfmac_f32_16x16x64_bf16 v[124:127], v[40:43], a[48:55], v4
    ds_read_b128 v[88:91], v1 offset:20544
    v_smfmac_f32_16x16x64_bf16 v[128:131], v[40:43], a[56:63], v4
    s_waitcnt lgkmcnt(7)
    v_smfmac_f32_16x16x64_bf16 v[124:127], v[44:47], a[64:71], v4
    ds_read_b128 v[92:95], v1 offset:21568
    v_smfmac_f32_16x16x64_bf16 v[128:131], v[44:47], a[72:79], v4
    s_waitcnt lgkmcnt(7)
    v_smfmac_f32_16x16x64_bf16 v[124:127], v[48:51], a[80:87], v4
    ds_read_b128 v[96:99], v1 offset:22592
    v_smfmac_f32_16x16x64_bf16 v[128:131], v[48:51], a[88:95], v4
    s_waitcnt lgkmcnt(7)
    v_smfmac_f32_16x16x64_bf16 v[124:127], v[52:55], a[96:103], v4
    ds_read_b128 v[100:103], v1 offset:23616
    v_smfmac_f32_16x16x64_bf16 v[128:131], v[52:55], a[104:111], v4
    s_waitcnt lgkmcnt(7)
    v_smfmac_f32_16x16x64_bf16 v[124:127], v[56:59], a[112:119], v4
    ds_read_b128 v[104:107], v1 offset:24640
    v_smfmac_f32_16x16x64_bf16 v[128:131], v[56:59], a[120:127], v4
    v_smfmac_f32_16x16x64_bf16 v[132:135], v[28:31], a[128:135], v4
    buffer_load_dword v248, v8, s[8:11], s87 offen sc1
    v_smfmac_f32_16x16x64_bf16 v[136:139], v[28:31], a[136:143], v4
    v_smfmac_f32_16x16x64_bf16 v[132:135], v[32:35], a[144:151], v4
    v_smfmac_f32_16x16x64_bf16 v[136:139], v[32:35], a[152:159], v4
    v_smfmac_f32_16x16x64_bf16 v[132:135], v[36:39], a[160:167], v4
    s_nop 1
    v_cvt_pk_bf16_f32 v124, v124, v128
    v_smfmac_f32_16x16x64_bf16 v[136:139], v[36:39], a[168:175], v4
    v_cvt_pk_bf16_f32 v125, v125, v129
    ds_write2_b32 v2, v124, v125 offset0:0 offset1:80
    v_smfmac_f32_16x16x64_bf16 v[132:135], v[40:43], a[176:183], v4
    v_cvt_pk_bf16_f32 v126, v126, v130
    v_smfmac_f32_16x16x64_bf16 v[136:139], v[40:43], a[184:191], v4
    v_cvt_pk_bf16_f32 v127, v127, v131
    ds_write2_b32 v2, v126, v127 offset0:160 offset1:240
    v_smfmac_f32_16x16x64_bf16 v[132:135], v[44:47], a[192:199], v4
    v_smfmac_f32_16x16x64_bf16 v[136:139], v[44:47], a[200:207], v4
    v_smfmac_f32_16x16x64_bf16 v[132:135], v[48:51], a[208:215], v4
    v_smfmac_f32_16x16x64_bf16 v[136:139], v[48:51], a[216:223], v4
    v_smfmac_f32_16x16x64_bf16 v[132:135], v[52:55], a[224:231], v4
    v_smfmac_f32_16x16x64_bf16 v[136:139], v[52:55], a[232:239], v4
    s_waitcnt lgkmcnt(0)
    s_barrier
    ds_read_b128 v[140:143], v3 offset:0
    ds_read_b128 v[144:147], v3 offset:64
    ds_read_b128 v[148:151], v3 offset:128
    ds_read_b128 v[152:155], v3 offset:192
    v_smfmac_f32_16x16x64_bf16 v[132:135], v[56:59], a[240:247], v4
    v_smfmac_f32_16x16x64_bf16 v[136:139], v[56:59], a[248:255], v4
    v_mfma_f32_16x16x32_bf16 v[164:167], v[76:79], v[60:63], v[20:23]
    v_mfma_f32_16x16x32_bf16 v[168:171], v[92:95], v[60:63], v[24:27]
    v_mfma_f32_16x16x32_bf16 v[164:167], v[80:83], v[64:67], v[164:167]
    v_mfma_f32_16x16x32_bf16 v[168:171], v[96:99], v[64:67], v[168:171]
    v_mfma_f32_16x16x32_bf16 v[164:167], v[84:87], v[68:71], v[164:167]
    v_mfma_f32_16x16x32_bf16 v[168:171], v[100:103], v[68:71], v[168:171]
    s_nop 0
    v_cvt_pk_bf16_f32 v128, v132, v133
    v_cvt_pk_bf16_f32 v129, v134, v135
    v_mfma_f32_16x16x32_bf16 v[164:167], v[88:91], v[72:75], v[164:167]
    v_mfma_f32_16x16x32_bf16 v[168:171], v[104:107], v[72:75], v[168:171]
    v_cvt_pk_bf16_f32 v130, v136, v137
    v_cvt_pk_bf16_f32 v131, v138, v139
    s_lshl_b32 s46, s18, 10
    v_add_u32 v10, s46, v1
    ds_write_b128 v10, v[128:131] offset:5184
    s_waitcnt lgkmcnt(4)
    v_mfma_f32_16x16x32_bf16 v[172:175], v[140:143], v[60:63], 0
    s_waitcnt lgkmcnt(3)
    v_mfma_f32_16x16x32_bf16 v[172:175], v[144:147], v[64:67], v[172:175]
    s_waitcnt lgkmcnt(2)
    v_mfma_f32_16x16x32_bf16 v[172:175], v[148:151], v[68:71], v[172:175]
    s_waitcnt lgkmcnt(1)
    v_mfma_f32_16x16x32_bf16 v[172:175], v[152:155], v[72:75], v[172:175]
    s_cmp_eq_u32 s84, 0
    s_cbranch_scc1 L_xa_N
    s_mov_b32 s74, 0
L_xa_fl_14:
    s_waitcnt vmcnt(0)
    v_cmp_gt_u32 vcc, s64, v248
    s_add_u32 s74, s74, 1
    s_cmp_ge_u32 s74, 200000
    s_cbranch_scc1 L_xa_fl_14_x
    s_cbranch_vccz L_xa_fl_14_x
    buffer_load_dword v248, v8, s[8:11], s87 offen sc1
    s_branch L_xa_fl_14
L_xa_fl_14_x:
    s_min_u32 s77, s63, 63
    s_lshl_b32 s77, s77, 16
    s_add_u32 s63, s63, 3
    s_min_u32 s46, s63, 63
    s_cmp_eq_u32 s46, 0
    s_cselect_b32 s47, 64, s46
    s_lshl_b32 s68, s47, 13
    s_add_u32 s68, s68, 1048576
    s_lshl_b32 s46, s46, 18
    s_lshl_b32 s47, s62, 13
    s_add_u32 s46, s46, s47
    s_add_u32 s70, s46, 33554432
    s_and_b32 s47, s18, 1
    s_lshl_b32 s47, s47, 12
    s_add_u32 s69, s46, s47
    s_add_u32 s69, s69, 67108864
    s_lshr_b32 s47, s18, 1
    s_lshl_b32 s47, s47, 12
    s_add_u32 s71, s46, s47
    s_add_u32 s71, s71, 50331648
    s_add_u32 m0, s78, 17472
    v_max3_f32 v10, v164, v165, v166
    v_max3_f32 v10, v10, v167, v168
    v_max3_f32 v10, v10, v169, v170
    v_permlane32_swap_b32 v172, v174
    buffer_load_dwordx4 v[188:191], v5, s[8:11], s73 offen sc1
    s_add_u32 s73, s73, 4096
    v_permlane32_swap_b32 v173, v175
    v_add_f32 v172, v172, v174
    v_add_f32 v173, v173, v175
    v_mul_f32 v172, s67, v172
    buffer_load_dwordx4 v[192:195], v5, s[8:11], s73 offen sc1
    s_add_u32 s73, s73, 4096
    v_mul_f32 v173, s67, v173
    v_max3_f32 v10, v10, v171, v172
    v_max_f32 v10, v10, v173
    s_waitcnt lgkmcnt(0)
    s_barrier
    s_lshr_b32 s46, s18, 1
    s_lshl_b32 s46, s46, 11
    v_add_u32 v11, s46, v1
    ds_read_b128 v[156:159], v11 offset:5184
    ds_read_b128 v[160:163], v11 offset:6208
    v_mov_b32 v11, v10
    buffer_load_dwordx4 v[196:199], v5, s[8:11], s73 offen sc1
    s_add_u32 s73, s73, 4096
    v_permlane16_swap_b32 v10, v11
    v_max_f32 v10, v10, v11
    v_mov_b32 v11, v10
    s_nop 1
    v_permlane32_swap_b32 v10, v11
    buffer_load_dwordx4 v[200:203], v5, s[8:11], s73 offen sc1
    s_add_u32 s73, s73, 4096
    v_max_f32 v10, v10, v11
    v_sub_f32 v164, v164, v10
    v_exp_f32 v164, v164
    v_sub_f32 v165, v165, v10
    buffer_load_dwordx4 v[204:207], v5, s[8:11], s73 offen sc1
    s_add_u32 s73, s73, 4096
    v_exp_f32 v165, v165
    v_sub_f32 v166, v166, v10
    v_exp_f32 v166, v166
    v_sub_f32 v167, v167, v10
    buffer_load_dwordx4 v[208:211], v5, s[8:11], s73 offen sc1
    s_add_u32 s73, s73, 4096
    v_exp_f32 v167, v167
    v_sub_f32 v168, v168, v10
    v_exp_f32 v168, v168
    v_sub_f32 v169, v169, v10
    buffer_load_dwordx4 v[212:215], v5, s[8:11], s73 offen sc1
    s_add_u32 s73, s73, 4096
    v_exp_f32 v169, v169
    v_sub_f32 v170, v170, v10
    v_exp_f32 v170, v170
    v_sub_f32 v171, v171, v10
    buffer_load_dwordx4 v[216:219], v5, s[8:11], s73 offen sc1
    s_add_u32 s73, s73, 4096
    v_exp_f32 v171, v171
    v_sub_f32 v172, v172, v10
    v_exp_f32 v172, v172
    v_sub_f32 v173, v173, v10
    buffer_load_dwordx4 v9, s[8:11], s70 offen offset:0 sc1 lds
    v_exp_f32 v173, v173
    v_cvt_pk_bf16_f32 v176, v164, v165
    v_cvt_pk_bf16_f32 v177, v166, v167
    v_cvt_pk_bf16_f32 v178, v168, v169
    buffer_load_dwordx4 v9, s[8:11], s70 offen offset:1024 sc1 lds
    v_cvt_pk_bf16_f32 v179, v170, v171
    v_cvt_pk_bf16_f32 v172, v172, v173
    v_mov_b32 v173, v172
    v_mfma_f32_16x16x32_bf16 v[180:183], v[12:15], v[176:179], 0
    s_nop 0
    v_permlane32_swap_b32 v172, v173
    v_mfma_f32_16x16x32_bf16 v[140:143], v[108:111], v[176:179], 0
    v_mfma_f32_16x16x32_bf16 v[144:147], v[112:115], v[176:179], 0
    v_mfma_f32_16x16x32_bf16 v[148:151], v[116:119], v[176:179], 0
    v_mfma_f32_16x16x32_bf16 v[152:155], v[120:123], v[176:179], 0
    v_mfma_f32_16x16x16_bf16 v[180:183], v[12:13], v[172:173], v[180:183]
    s_waitcnt lgkmcnt(0)
    s_barrier
    v_mfma_f32_16x16x16_bf16 v[140:143], v[156:157], v[172:173], v[140:143]
    v_mfma_f32_16x16x16_bf16 v[144:147], v[158:159], v[172:173], v[144:147]
    v_mfma_f32_16x16x16_bf16 v[148:151], v[160:161], v[172:173], v[148:151]
    v_mfma_f32_16x16x16_bf16 v[152:155], v[162:163], v[172:173], v[152:155]
    s_and_b32 s47, s18, 1
    s_lshl_b32 s47, s47, 12
    s_add_u32 s46, s46, s47
    v_add_u32 v11, s46, v1
    v_rcp_f32 v10, v180
    s_nop 0
    v_mul_f32 v140, v140, v10
    v_mul_f32 v141, v141, v10
    v_mul_f32 v142, v142, v10
    v_mul_f32 v143, v143, v10
    v_mul_f32 v144, v144, v10
    v_mul_f32 v145, v145, v10
    v_mul_f32 v146, v146, v10
    v_mul_f32 v147, v147, v10
    v_cvt_pk_bf16_f32 v164, v140, v144
    v_cvt_pk_bf16_f32 v165, v141, v145
    v_cvt_pk_bf16_f32 v166, v142, v146
    v_cvt_pk_bf16_f32 v167, v143, v147
    ds_write_b128 v11, v[164:167] offset:0
    v_mul_f32 v148, v148, v10
    v_mul_f32 v149, v149, v10
    v_mul_f32 v150, v150, v10
    v_mul_f32 v151, v151, v10
    v_mul_f32 v152, v152, v10
    v_mul_f32 v153, v153, v10
    v_mul_f32 v154, v154, v10
    v_mul_f32 v155, v155, v10
    v_cvt_pk_bf16_f32 v168, v148, v152
    v_cvt_pk_bf16_f32 v169, v149, v153
    v_cvt_pk_bf16_f32 v170, v150, v154
    v_cvt_pk_bf16_f32 v171, v151, v155
    ds_write_b128 v11, v[168:171] offset:1024
    s_waitcnt vmcnt(9)
    v_mfma_f32_16x16x32_bf16 v[184:187], v[16:19], v[188:191], 0
    s_waitcnt vmcnt(8)
    v_mfma_f32_16x16x32_bf16 v[184:187], v[16:19], v[192:195], v[184:187]
    s_waitcnt vmcnt(7)
    v_mfma_f32_16x16x32_bf16 v[184:187], v[16:19], v[196:199], v[184:187]
    s_waitcnt vmcnt(6)
    v_mfma_f32_16x16x32_bf16 v[184:187], v[16:19], v[200:203], v[184:187]
    s_waitcnt vmcnt(5)
    v_mfma_f32_16x16x32_bf16 v[184:187], v[16:19], v[204:207], v[184:187]
    s_waitcnt vmcnt(4)
    v_mfma_f32_16x16x32_bf16 v[184:187], v[16:19], v[208:211], v[184:187]
    s_waitcnt vmcnt(3)
    v_mfma_f32_16x16x32_bf16 v[184:187], v[16:19], v[212:215], v[184:187]
    s_waitcnt vmcnt(2)
    v_mfma_f32_16x16x32_bf16 v[184:187], v[16:19], v[216:219], v[184:187]
    s_nop 7
    v_cvt_pk_bf16_f32 v186, v184, v185
    buffer_store_dword v186, v6, s[20:23], s75 offen nt
    s_mov_b32 s84, 0
    ds_read_b128 v[220:223], v7 offset:0
    ds_read_b128 v[224:227], v7 offset:8192
    ds_read_b128 v[228:231], v7 offset:16384
    s_waitcnt lgkmcnt(3)
    s_barrier
    ds_read_b128 v[188:191], v1 offset:0
    ds_read_b128 v[204:207], v1 offset:4096
    ds_read_b128 v[192:195], v1 offset:1024
    ds_read_b128 v[208:211], v1 offset:5120
    ds_read_b128 v[196:199], v1 offset:2048
    ds_read_b128 v[212:215], v1 offset:6144
    ds_read_b128 v[200:203], v1 offset:3072
    ds_read_b128 v[216:219], v1 offset:7168
    s_and_b32 s46, s64, 1
    s_lshl_b32 s46, s46, 20
    s_add_u32 s46, s46, s65
    s_lshl_b32 s47, s62, 15
    s_add_u32 s73, s46, s47
    s_lshl_b32 s47, s18, 18
    s_add_u32 s72, s46, s47
    s_lshl_b32 s47, s62, 10
    s_add_u32 s72, s72, s47
    s_add_u32 s76, s72, 131072
    s_waitcnt lgkmcnt(10)
    s_waitcnt lgkmcnt(6)
    v_mfma_f32_16x16x32_bf16 v[124:127], v[220:223], v[188:191], 0
    ds_read_b128 v[232:235], v7 offset:24576
    v_mfma_f32_16x16x32_bf16 v[156:159], v[220:223], v[204:207], 0
    buffer_load_dwordx4 v[60:63], v1, s[8:11], s69 offen offset:0 sc1
    s_waitcnt lgkmcnt(5)
    v_mfma_f32_16x16x32_bf16 v[124:127], v[224:227], v[192:195], v[124:127]
    ds_read_b128 v[236:239], v7 offset:1024
    v_mfma_f32_16x16x32_bf16 v[156:159], v[224:227], v[208:211], v[156:159]
    s_waitcnt lgkmcnt(4)
    v_mfma_f32_16x16x32_bf16 v[124:127], v[228:231], v[196:199], v[124:127]
    ds_read_b128 v[220:223], v7 offset:9216
    v_mfma_f32_16x16x32_bf16 v[156:159], v[228:231], v[212:215], v[156:159]
    s_waitcnt lgkmcnt(2)
    v_mfma_f32_16x16x32_bf16 v[124:127], v[232:235], v[200:203], v[124:127]
    ds_read_b128 v[224:227], v7 offset:17408
    v_mfma_f32_16x16x32_bf16 v[156:159], v[232:235], v[216:219], v[156:159]
    buffer_load_dwordx4 v[64:67], v1, s[8:11], s69 offen offset:1024 sc1
    s_waitcnt lgkmcnt(2)
    v_mfma_f32_16x16x32_bf16 v[128:131], v[236:239], v[188:191], 0
    ds_read_b128 v[228:231], v7 offset:25600
    v_mfma_f32_16x16x32_bf16 v[160:163], v[236:239], v[204:207], 0
    s_waitcnt lgkmcnt(2)
    v_mfma_f32_16x16x32_bf16 v[128:131], v[220:223], v[192:195], v[128:131]
    ds_read_b128 v[232:235], v7 offset:2048
    v_mfma_f32_16x16x32_bf16 v[160:163], v[220:223], v[208:211], v[160:163]
    s_waitcnt lgkmcnt(2)
    v_mfma_f32_16x16x32_bf16 v[128:131], v[224:227], v[196:199], v[128:131]
    ds_read_b128 v[236:239], v7 offset:10240
    v_mfma_f32_16x16x32_bf16 v[160:163], v[224:227], v[212:215], v[160:163]
    buffer_load_dwordx4 v[68:71], v1, s[8:11], s69 offen offset:2048 sc1
    s_waitcnt lgkmcnt(2)
    v_mfma_f32_16x16x32_bf16 v[128:131], v[228:231], v[200:203], v[128:131]
    ds_read_b128 v[220:223], v7 offset:18432
    v_mfma_f32_16x16x32_bf16 v[160:163], v[228:231], v[216:219], v[160:163]
    s_waitcnt lgkmcnt(2)
    v_mfma_f32_16x16x32_bf16 v[132:135], v[232:235], v[188:191], 0
    ds_read_b128 v[224:227], v7 offset:26624
    v_mfma_f32_16x16x32_bf16 v[164:167], v[232:235], v[204:207], 0
    s_waitcnt lgkmcnt(2)
    v_mfma_f32_16x16x32_bf16 v[132:135], v[236:239], v[192:195], v[132:135]
    ds_read_b128 v[228:231], v7 offset:3072
    v_mfma_f32_16x16x32_bf16 v[164:167], v[236:239], v[208:211], v[164:167]
    buffer_load_dwordx4 v[72:75], v1, s[8:11], s69 offen offset:3072 sc1
    s_waitcnt lgkmcnt(2)
    v_mfma_f32_16x16x32_bf16 v[132:135], v[220:223], v[196:199], v[132:135]
    ds_read_b128 v[232:235], v7 offset:11264
    v_cvt_pk_bf16_f32 v28, v124, v128
    v_mfma_f32_16x16x32_bf16 v[164:167], v[220:223], v[212:215], v[164:167]
    v_cvt_pk_bf16_f32 v29, v125, v129
    s_waitcnt lgkmcnt(2)
    v_mfma_f32_16x16x32_bf16 v[132:135], v[224:227], v[200:203], v[132:135]
    ds_read_b128 v[236:239], v7 offset:19456
    v_cvt_pk_bf16_f32 v30, v126, v130
    v_mfma_f32_16x16x32_bf16 v[164:167], v[224:227], v[216:219], v[164:167]
    v_cvt_pk_bf16_f32 v31, v127, v131
    s_waitcnt lgkmcnt(2)
    v_mfma_f32_16x16x32_bf16 v[136:139], v[228:231], v[188:191], 0
    ds_read_b128 v[220:223], v7 offset:27648
    buffer_store_dwordx4 v[28:31], v1, s[8:11], s72 offen nt
    v_mfma_f32_16x16x32_bf16 v[168:171], v[228:231], v[204:207], 0
    s_add_u32 s72, s72, 32768
    buffer_load_dwordx4 v[240:243], v9, s[8:11], s68 offen offset:0 sc1
    s_waitcnt lgkmcnt(2)
    v_mfma_f32_16x16x32_bf16 v[136:139], v[232:235], v[192:195], v[136:139]
    ds_read_b128 v[224:227], v7 offset:4096
    v_cvt_pk_bf16_f32 v32, v156, v160
    v_mfma_f32_16x16x32_bf16 v[168:171], v[232:235], v[208:211], v[168:171]
    v_cvt_pk_bf16_f32 v33, v157, v161
    s_waitcnt lgkmcnt(2)
    v_mfma_f32_16x16x32_bf16 v[136:139], v[236:239], v[196:199], v[136:139]
    ds_read_b128 v[228:231], v7 offset:12288
    v_cvt_pk_bf16_f32 v34, v158, v162
    v_mfma_f32_16x16x32_bf16 v[168:171], v[236:239], v[212:215], v[168:171]
    v_cvt_pk_bf16_f32 v35, v159, v163
    s_waitcnt lgkmcnt(2)
    v_mfma_f32_16x16x32_bf16 v[136:139], v[220:223], v[200:203], v[136:139]
    ds_read_b128 v[232:235], v7 offset:20480
    buffer_store_dwordx4 v[32:35], v1, s[8:11], s76 offen nt
    v_mfma_f32_16x16x32_bf16 v[168:171], v[220:223], v[216:219], v[168:171]
    s_add_u32 s76, s76, 32768
    buffer_load_dwordx4 v[244:247], v9, s[8:11], s68 offen offset:1024 sc1
    s_waitcnt lgkmcnt(2)
    v_mfma_f32_16x16x32_bf16 v[140:143], v[224:227], v[188:191], 0
    ds_read_b128 v[236:239], v7 offset:28672
    v_mfma_f32_16x16x32_bf16 v[172:175], v[224:227], v[204:207], 0
    s_waitcnt lgkmcnt(2)
    v_mfma_f32_16x16x32_bf16 v[140:143], v[228:231], v[192:195], v[140:143]
    ds_read_b128 v[220:223], v7 offset:5120
    v_mfma_f32_16x16x32_bf16 v[172:175], v[228:231], v[208:211], v[172:175]
    s_waitcnt lgkmcnt(2)
    v_mfma_f32_16x16x32_bf16 v[140:143], v[232:235], v[196:199], v[140:143]
    ds_read_b128 v[224:227], v7 offset:13312
    v_cvt_pk_bf16_f32 v36, v132, v136
    v_mfma_f32_16x16x32_bf16 v[172:175], v[232:235], v[212:215], v[172:175]
    v_cvt_pk_bf16_f32 v37, v133, v137
    buffer_load_dwordx4 v[108:111], v1, s[8:11], s71 offen offset:0 sc1
    s_waitcnt lgkmcnt(2)
    v_mfma_f32_16x16x32_bf16 v[140:143], v[236:239], v[200:203], v[140:143]
    ds_read_b128 v[228:231], v7 offset:21504
    v_cvt_pk_bf16_f32 v38, v134, v138
    v_mfma_f32_16x16x32_bf16 v[172:175], v[236:239], v[216:219], v[172:175]
    v_cvt_pk_bf16_f32 v39, v135, v139
    s_waitcnt lgkmcnt(2)
    v_mfma_f32_16x16x32_bf16 v[144:147], v[220:223], v[188:191], 0
    ds_read_b128 v[232:235], v7 offset:29696
    buffer_store_dwordx4 v[36:39], v1, s[8:11], s72 offen nt
    v_mfma_f32_16x16x32_bf16 v[176:179], v[220:223], v[204:207], 0
    s_add_u32 s72, s72, 32768
    s_waitcnt lgkmcnt(2)
    v_mfma_f32_16x16x32_bf16 v[144:147], v[224:227], v[192:195], v[144:147]
    ds_read_b128 v[236:239], v7 offset:6144
    v_cvt_pk_bf16_f32 v40, v164, v168
    v_mfma_f32_16x16x32_bf16 v[176:179], v[224:227], v[208:211], v[176:179]
    v_cvt_pk_bf16_f32 v41, v165, v169
    buffer_load_dwordx4 v[112:115], v1, s[8:11], s71 offen offset:1024 sc1
    s_waitcnt lgkmcnt(2)
    v_mfma_f32_16x16x32_bf16 v[144:147], v[228:231], v[196:199], v[144:147]
    ds_read_b128 v[220:223], v7 offset:14336
    v_cvt_pk_bf16_f32 v42, v166, v170
    v_mfma_f32_16x16x32_bf16 v[176:179], v[228:231], v[212:215], v[176:179]
    v_cvt_pk_bf16_f32 v43, v167, v171
    s_waitcnt lgkmcnt(2)
    v_mfma_f32_16x16x32_bf16 v[144:147], v[232:235], v[200:203], v[144:147]
    ds_read_b128 v[224:227], v7 offset:22528
    buffer_store_dwordx4 v[40:43], v1, s[8:11], s76 offen nt
    v_mfma_f32_16x16x32_bf16 v[176:179], v[232:235], v[216:219], v[176:179]
    s_add_u32 s76, s76, 32768
    s_waitcnt lgkmcnt(2)
    v_mfma_f32_16x16x32_bf16 v[148:151], v[236:239], v[188:191], 0
    ds_read_b128 v[228:231], v7 offset:30720
    v_mfma_f32_16x16x32_bf16 v[180:183], v[236:239], v[204:207], 0
    buffer_load_dwordx4 v[116:119], v1, s[8:11], s71 offen offset:2048 sc1
    s_waitcnt lgkmcnt(2)
    v_mfma_f32_16x16x32_bf16 v[148:151], v[220:223], v[192:195], v[148:151]
    ds_read_b128 v[232:235], v7 offset:7168
    v_mfma_f32_16x16x32_bf16 v[180:183], v[220:223], v[208:211], v[180:183]
    s_waitcnt lgkmcnt(2)
    v_mfma_f32_16x16x32_bf16 v[148:151], v[224:227], v[196:199], v[148:151]
    ds_read_b128 v[236:239], v7 offset:15360
    v_cvt_pk_bf16_f32 v44, v140, v144
    v_mfma_f32_16x16x32_bf16 v[180:183], v[224:227], v[212:215], v[180:183]
    v_cvt_pk_bf16_f32 v45, v141, v145
    s_waitcnt lgkmcnt(2)
    v_mfma_f32_16x16x32_bf16 v[148:151], v[228:231], v[200:203], v[148:151]
    ds_read_b128 v[220:223], v7 offset:23552
    v_cvt_pk_bf16_f32 v46, v142, v146
    v_mfma_f32_16x16x32_bf16 v[180:183], v[228:231], v[216:219], v[180:183]
    v_cvt_pk_bf16_f32 v47, v143, v147
    buffer_load_dwordx4 v[120:123], v1, s[8:11], s71 offen offset:3072 sc1
    s_waitcnt lgkmcnt(2)
    v_mfma_f32_16x16x32_bf16 v[152:155], v[232:235], v[188:191], 0
    ds_read_b128 v[224:227], v7 offset:31744
    buffer_store_dwordx4 v[44:47], v1, s[8:11], s72 offen nt
    v_mfma_f32_16x16x32_bf16 v[184:187], v[232:235], v[204:207], 0
    s_add_u32 s72, s72, 32768
    s_waitcnt lgkmcnt(2)
    v_mfma_f32_16x16x32_bf16 v[152:155], v[236:239], v[192:195], v[152:155]
    v_cvt_pk_bf16_f32 v48, v172, v176
    v_mfma_f32_16x16x32_bf16 v[184:187], v[236:239], v[208:211], v[184:187]
    v_cvt_pk_bf16_f32 v49, v173, v177
    s_waitcnt lgkmcnt(1)
    v_mfma_f32_16x16x32_bf16 v[152:155], v[220:223], v[196:199], v[152:155]
    v_cvt_pk_bf16_f32 v50, v174, v178
    v_mfma_f32_16x16x32_bf16 v[184:187], v[220:223], v[212:215], v[184:187]
    v_cvt_pk_bf16_f32 v51, v175, v179
    s_waitcnt lgkmcnt(0)
    v_mfma_f32_16x16x32_bf16 v[152:155], v[224:227], v[200:203], v[152:155]
    buffer_store_dwordx4 v[48:51], v1, s[8:11], s76 offen nt
    v_mfma_f32_16x16x32_bf16 v[184:187], v[224:227], v[216:219], v[184:187]
    s_add_u32 s76, s76, 32768
    s_nop 4
    v_cvt_pk_bf16_f32 v52, v148, v152
    v_cvt_pk_bf16_f32 v53, v149, v153
    v_cvt_pk_bf16_f32 v54, v150, v154
    v_cvt_pk_bf16_f32 v55, v151, v155
    buffer_store_dwordx4 v[52:55], v1, s[8:11], s72 offen nt
    s_add_u32 s72, s72, 32768
    v_cvt_pk_bf16_f32 v56, v180, v184
    v_cvt_pk_bf16_f32 v57, v181, v185
    v_cvt_pk_bf16_f32 v58, v182, v186
    v_cvt_pk_bf16_f32 v59, v183, v187
    buffer_store_dwordx4 v[56:59], v1, s[8:11], s76 offen nt
    s_add_u32 s76, s76, 32768
    s_branch L_xa_join
L_xa_N:
    s_min_u32 s77, s63, 63
    s_lshl_b32 s77, s77, 16
    s_add_u32 s63, s63, 3
    v_max3_f32 v10, v164, v165, v166
    v_max3_f32 v10, v10, v167, v168
    v_max3_f32 v10, v10, v169, v170
    v_permlane32_swap_b32 v172, v174
    v_permlane32_swap_b32 v173, v175
    v_add_f32 v172, v172, v174
    v_add_f32 v173, v173, v175
    v_mul_f32 v172, s67, v172
    v_mul_f32 v173, s67, v173
    v_max3_f32 v10, v10, v171, v172
    v_max_f32 v10, v10, v173
    s_waitcnt lgkmcnt(0)
    s_barrier
    s_lshr_b32 s46, s18, 1
    s_lshl_b32 s46, s46, 11
    v_add_u32 v11, s46, v1
    ds_read_b128 v[156:159], v11 offset:5184
    ds_read_b128 v[160:163], v11 offset:6208
    v_mov_b32 v11, v10
    s_nop 1
    v_permlane16_swap_b32 v10, v11
    v_max_f32 v10, v10, v11
    v_mov_b32 v11, v10
    s_nop 1
    v_permlane32_swap_b32 v10, v11
    v_max_f32 v10, v10, v11
    v_sub_f32 v164, v164, v10
    v_exp_f32 v164, v164
    v_sub_f32 v165, v165, v10
    v_exp_f32 v165, v165
    v_sub_f32 v166, v166, v10
    v_exp_f32 v166, v166
    v_sub_f32 v167, v167, v10
    v_exp_f32 v167, v167
    v_sub_f32 v168, v168, v10
    v_exp_f32 v168, v168
    v_sub_f32 v169, v169, v10
    v_exp_f32 v169, v169
    v_sub_f32 v170, v170, v10
    v_exp_f32 v170, v170
    v_sub_f32 v171, v171, v10
    v_exp_f32 v171, v171
    v_sub_f32 v172, v172, v10
    v_exp_f32 v172, v172
    v_sub_f32 v173, v173, v10
    v_exp_f32 v173, v173
    v_cvt_pk_bf16_f32 v176, v164, v165
    v_cvt_pk_bf16_f32 v177, v166, v167
    v_cvt_pk_bf16_f32 v178, v168, v169
    v_cvt_pk_bf16_f32 v179, v170, v171
    v_cvt_pk_bf16_f32 v172, v172, v173
    v_mov_b32 v173, v172
    v_mfma_f32_16x16x32_bf16 v[180:183], v[12:15], v[176:179], 0
    s_nop 0
    v_permlane32_swap_b32 v172, v173
    v_mfma_f32_16x16x32_bf16 v[140:143], v[108:111], v[176:179], 0
    v_mfma_f32_16x16x32_bf16 v[144:147], v[112:115], v[176:179], 0
    v_mfma_f32_16x16x32_bf16 v[148:151], v[116:119], v[176:179], 0
    v_mfma_f32_16x16x32_bf16 v[152:155], v[120:123], v[176:179], 0
    v_mfma_f32_16x16x16_bf16 v[180:183], v[12:13], v[172:173], v[180:183]
    s_waitcnt lgkmcnt(0)
    s_barrier
    v_mfma_f32_16x16x16_bf16 v[140:143], v[156:157], v[172:173], v[140:143]
    v_mfma_f32_16x16x16_bf16 v[144:147], v[158:159], v[172:173], v[144:147]
    v_mfma_f32_16x16x16_bf16 v[148:151], v[160:161], v[172:173], v[148:151]
    v_mfma_f32_16x16x16_bf16 v[152:155], v[162:163], v[172:173], v[152:155]
    s_and_b32 s47, s18, 1
    s_lshl_b32 s47, s47, 12
    s_add_u32 s46, s46, s47
    v_add_u32 v11, s46, v1
    v_rcp_f32 v10, v180
    s_nop 0
    v_mul_f32 v140, v140, v10
    v_mul_f32 v141, v141, v10
    v_mul_f32 v142, v142, v10
    v_mul_f32 v143, v143, v10
    v_mul_f32 v144, v144, v10
    v_mul_f32 v145, v145, v10
    v_mul_f32 v146, v146, v10
    v_mul_f32 v147, v147, v10
    v_cvt_pk_bf16_f32 v164, v140, v144
    v_cvt_pk_bf16_f32 v165, v141, v145
    v_cvt_pk_bf16_f32 v166, v142, v146
    v_cvt_pk_bf16_f32 v167, v143, v147
    ds_write_b128 v11, v[164:167] offset:0
    v_mul_f32 v148, v148, v10
    v_mul_f32 v149, v149, v10
    v_mul_f32 v150, v150, v10
    v_mul_f32 v151, v151, v10
    v_mul_f32 v152, v152, v10
    v_mul_f32 v153, v153, v10
    v_mul_f32 v154, v154, v10
    v_mul_f32 v155, v155, v10
    v_cvt_pk_bf16_f32 v168, v148, v152
    v_cvt_pk_bf16_f32 v169, v149, v153
    v_cvt_pk_bf16_f32 v170, v150, v154
    v_cvt_pk_bf16_f32 v171, v151, v155
    ds_write_b128 v11, v[168:171] offset:1024
    ds_read_b128 v[220:223], v7 offset:0
    ds_read_b128 v[224:227], v7 offset:8192
    ds_read_b128 v[228:231], v7 offset:16384
    s_waitcnt lgkmcnt(3)
    s_barrier
    ds_read_b128 v[188:191], v1 offset:0
    ds_read_b128 v[204:207], v1 offset:4096
    ds_read_b128 v[192:195], v1 offset:1024
    ds_read_b128 v[208:211], v1 offset:5120
    ds_read_b128 v[196:199], v1 offset:2048
    ds_read_b128 v[212:215], v1 offset:6144
    ds_read_b128 v[200:203], v1 offset:3072
    ds_read_b128 v[216:219], v1 offset:7168
    s_and_b32 s46, s64, 1
    s_lshl_b32 s46, s46, 20
    s_add_u32 s46, s46, s65
    s_lshl_b32 s47, s62, 15
    s_add_u32 s73, s46, s47
    s_lshl_b32 s47, s18, 18
    s_add_u32 s72, s46, s47
    s_lshl_b32 s47, s62, 10
    s_add_u32 s72, s72, s47
    s_add_u32 s72, s72, s79
    s_add_u32 s76, s72, 131072
    s_waitcnt lgkmcnt(10)
    s_waitcnt lgkmcnt(6)
    v_mfma_f32_16x16x32_bf16 v[124:127], v[220:223], v[188:191], 0
    ds_read_b128 v[232:235], v7 offset:24576
    v_mfma_f32_16x16x32_bf16 v[156:159], v[220:223], v[204:207], 0
    s_waitcnt lgkmcnt(5)
    v_mfma_f32_16x16x32_bf16 v[124:127], v[224:227], v[192:195], v[124:127]
    ds_read_b128 v[236:239], v7 offset:1024
    v_mfma_f32_16x16x32_bf16 v[156:159], v[224:227], v[208:211], v[156:159]
    s_waitcnt lgkmcnt(4)
    v_mfma_f32_16x16x32_bf16 v[124:127], v[228:231], v[196:199], v[124:127]
    ds_read_b128 v[220:223], v7 offset:9216
    v_mfma_f32_16x16x32_bf16 v[156:159], v[228:231], v[212:215], v[156:159]
    s_waitcnt lgkmcnt(2)
    v_mfma_f32_16x16x32_bf16 v[124:127], v[232:235], v[200:203], v[124:127]
    ds_read_b128 v[224:227], v7 offset:17408
    v_mfma_f32_16x16x32_bf16 v[156:159], v[232:235], v[216:219], v[156:159]
    s_waitcnt lgkmcnt(2)
    v_mfma_f32_16x16x32_bf16 v[128:131], v[236:239], v[188:191], 0
    ds_read_b128 v[228:231], v7 offset:25600
    v_mfma_f32_16x16x32_bf16 v[160:163], v[236:239], v[204:207], 0
    s_waitcnt lgkmcnt(2)
    v_mfma_f32_16x16x32_bf16 v[128:131], v[220:223], v[192:195], v[128:131]
    ds_read_b128 v[232:235], v7 offset:2048
    v_mfma_f32_16x16x32_bf16 v[160:163], v[220:223], v[208:211], v[160:163]
    s_waitcnt lgkmcnt(2)
    v_mfma_f32_16x16x32_bf16 v[128:131], v[224:227], v[196:199], v[128:131]
    ds_read_b128 v[236:239], v7 offset:10240
    v_mfma_f32_16x16x32_bf16 v[160:163], v[224:227], v[212:215], v[160:163]
    s_waitcnt lgkmcnt(2)
    v_mfma_f32_16x16x32_bf16 v[128:131], v[228:231], v[200:203], v[128:131]
    ds_read_b128 v[220:223], v7 offset:18432
    v_mfma_f32_16x16x32_bf16 v[160:163], v[228:231], v[216:219], v[160:163]
    s_waitcnt lgkmcnt(2)
    v_mfma_f32_16x16x32_bf16 v[132:135], v[232:235], v[188:191], 0
    ds_read_b128 v[224:227], v7 offset:26624
    v_mfma_f32_16x16x32_bf16 v[164:167], v[232:235], v[204:207], 0
    s_waitcnt lgkmcnt(2)
    v_mfma_f32_16x16x32_bf16 v[132:135], v[236:239], v[192:195], v[132:135]
    ds_read_b128 v[228:231], v7 offset:3072
    v_mfma_f32_16x16x32_bf16 v[164:167], v[236:239], v[208:211], v[164:167]
    s_waitcnt lgkmcnt(2)
    v_mfma_f32_16x16x32_bf16 v[132:135], v[220:223], v[196:199], v[132:135]
    ds_read_b128 v[232:235], v7 offset:11264
    v_cvt_pk_bf16_f32 v28, v124, v128
    v_mfma_f32_16x16x32_bf16 v[164:167], v[220:223], v[212:215], v[164:167]
    v_cvt_pk_bf16_f32 v29, v125, v129
    s_waitcnt lgkmcnt(2)
    v_mfma_f32_16x16x32_bf16 v[132:135], v[224:227], v[200:203], v[132:135]
    ds_read_b128 v[236:239], v7 offset:19456
    v_cvt_pk_bf16_f32 v30, v126, v130
    v_mfma_f32_16x16x32_bf16 v[164:167], v[224:227], v[216:219], v[164:167]
    v_cvt_pk_bf16_f32 v31, v127, v131
    s_waitcnt lgkmcnt(2)
    v_mfma_f32_16x16x32_bf16 v[136:139], v[228:231], v[188:191], 0
    ds_read_b128 v[220:223], v7 offset:27648
    buffer_store_dwordx4 v[28:31], v1, s[8:11], s72 offen nt
    v_mfma_f32_16x16x32_bf16 v[168:171], v[228:231], v[204:207], 0
    s_add_u32 s72, s72, 32768
    s_waitcnt lgkmcnt(2)
    v_mfma_f32_16x16x32_bf16 v[136:139], v[232:235], v[192:195], v[136:139]
    ds_read_b128 v[224:227], v7 offset:4096
    v_cvt_pk_bf16_f32 v32, v156, v160
    v_mfma_f32_16x16x32_bf16 v[168:171], v[232:235], v[208:211], v[168:171]
    v_cvt_pk_bf16_f32 v33, v157, v161
    s_waitcnt lgkmcnt(2)
    v_mfma_f32_16x16x32_bf16 v[136:139], v[236:239], v[196:199], v[136:139]
    ds_read_b128 v[228:231], v7 offset:12288
    v_cvt_pk_bf16_f32 v34, v158, v162
    v_mfma_f32_16x16x32_bf16 v[168:171], v[236:239], v[212:215], v[168:171]
    v_cvt_pk_bf16_f32 v35, v159, v163
    s_waitcnt lgkmcnt(2)
    v_mfma_f32_16x16x32_bf16 v[136:139], v[220:223], v[200:203], v[136:139]
    ds_read_b128 v[232:235], v7 offset:20480
    buffer_store_dwordx4 v[32:35], v1, s[8:11], s76 offen nt
    v_mfma_f32_16x16x32_bf16 v[168:171], v[220:223], v[216:219], v[168:171]
    s_add_u32 s76, s76, 32768
    s_waitcnt lgkmcnt(2)
    v_mfma_f32_16x16x32_bf16 v[140:143], v[224:227], v[188:191], 0
    ds_read_b128 v[236:239], v7 offset:28672
    v_mfma_f32_16x16x32_bf16 v[172:175], v[224:227], v[204:207], 0
    s_waitcnt lgkmcnt(2)
    v_mfma_f32_16x16x32_bf16 v[140:143], v[228:231], v[192:195], v[140:143]
    ds_read_b128 v[220:223], v7 offset:5120
    v_mfma_f32_16x16x32_bf16 v[172:175], v[228:231], v[208:211], v[172:175]
    s_waitcnt lgkmcnt(2)
    v_mfma_f32_16x16x32_bf16 v[140:143], v[232:235], v[196:199], v[140:143]
    ds_read_b128 v[224:227], v7 offset:13312
    v_cvt_pk_bf16_f32 v36, v132, v136
    v_mfma_f32_16x16x32_bf16 v[172:175], v[232:235], v[212:215], v[172:175]
    v_cvt_pk_bf16_f32 v37, v133, v137
    s_waitcnt lgkmcnt(2)
    v_mfma_f32_16x16x32_bf16 v[140:143], v[236:239], v[200:203], v[140:143]
    ds_read_b128 v[228:231], v7 offset:21504
    v_cvt_pk_bf16_f32 v38, v134, v138
    v_mfma_f32_16x16x32_bf16 v[172:175], v[236:239], v[216:219], v[172:175]
    v_cvt_pk_bf16_f32 v39, v135, v139
    s_waitcnt lgkmcnt(2)
    v_mfma_f32_16x16x32_bf16 v[144:147], v[220:223], v[188:191], 0
    ds_read_b128 v[232:235], v7 offset:29696
    buffer_store_dwordx4 v[36:39], v1, s[8:11], s72 offen nt
    v_mfma_f32_16x16x32_bf16 v[176:179], v[220:223], v[204:207], 0
    s_add_u32 s72, s72, 32768
    s_waitcnt lgkmcnt(2)
    v_mfma_f32_16x16x32_bf16 v[144:147], v[224:227], v[192:195], v[144:147]
    ds_read_b128 v[236:239], v7 offset:6144
    v_cvt_pk_bf16_f32 v40, v164, v168
    v_mfma_f32_16x16x32_bf16 v[176:179], v[224:227], v[208:211], v[176:179]
    v_cvt_pk_bf16_f32 v41, v165, v169
    s_waitcnt lgkmcnt(2)
    v_mfma_f32_16x16x32_bf16 v[144:147], v[228:231], v[196:199], v[144:147]
    ds_read_b128 v[220:223], v7 offset:14336
    v_cvt_pk_bf16_f32 v42, v166, v170
    v_mfma_f32_16x16x32_bf16 v[176:179], v[228:231], v[212:215], v[176:179]
    v_cvt_pk_bf16_f32 v43, v167, v171
    s_waitcnt lgkmcnt(2)
    v_mfma_f32_16x16x32_bf16 v[144:147], v[232:235], v[200:203], v[144:147]
    ds_read_b128 v[224:227], v7 offset:22528
    buffer_store_dwordx4 v[40:43], v1, s[8:11], s76 offen nt
    v_mfma_f32_16x16x32_bf16 v[176:179], v[232:235], v[216:219], v[176:179]
    s_add_u32 s76, s76, 32768
    s_waitcnt lgkmcnt(2)
    v_mfma_f32_16x16x32_bf16 v[148:151], v[236:239], v[188:191], 0
    ds_read_b128 v[228:231], v7 offset:30720
    v_mfma_f32_16x16x32_bf16 v[180:183], v[236:239], v[204:207], 0
    s_waitcnt lgkmcnt(2)
    v_mfma_f32_16x16x32_bf16 v[148:151], v[220:223], v[192:195], v[148:151]
    ds_read_b128 v[232:235], v7 offset:7168
    v_mfma_f32_16x16x32_bf16 v[180:183], v[220:223], v[208:211], v[180:183]
    s_waitcnt lgkmcnt(2)
    v_mfma_f32_16x16x32_bf16 v[148:151], v[224:227], v[196:199], v[148:151]
    ds_read_b128 v[236:239], v7 offset:15360
    v_cvt_pk_bf16_f32 v44, v140, v144
    v_mfma_f32_16x16x32_bf16 v[180:183], v[224:227], v[212:215], v[180:183]
    v_cvt_pk_bf16_f32 v45, v141, v145
    s_waitcnt lgkmcnt(2)
    v_mfma_f32_16x16x32_bf16 v[148:151], v[228:231], v[200:203], v[148:151]
    ds_read_b128 v[220:223], v7 offset:23552
    v_cvt_pk_bf16_f32 v46, v142, v146
    v_mfma_f32_16x16x32_bf16 v[180:183], v[228:231], v[216:219], v[180:183]
    v_cvt_pk_bf16_f32 v47, v143, v147
    s_waitcnt lgkmcnt(2)
    v_mfma_f32_16x16x32_bf16 v[152:155], v[232:235], v[188:191], 0
    ds_read_b128 v[224:227], v7 offset:31744
    buffer_store_dwordx4 v[44:47], v1, s[8:11], s72 offen nt
    v_mfma_f32_16x16x32_bf16 v[184:187], v[232:235], v[204:207], 0
    s_add_u32 s72, s72, 32768
    s_waitcnt lgkmcnt(2)
    v_mfma_f32_16x16x32_bf16 v[152:155], v[236:239], v[192:195], v[152:155]
    v_cvt_pk_bf16_f32 v48, v172, v176
    v_mfma_f32_16x16x32_bf16 v[184:187], v[236:239], v[208:211], v[184:187]
    v_cvt_pk_bf16_f32 v49, v173, v177
    s_waitcnt lgkmcnt(1)
    v_mfma_f32_16x16x32_bf16 v[152:155], v[220:223], v[196:199], v[152:155]
    v_cvt_pk_bf16_f32 v50, v174, v178
    v_mfma_f32_16x16x32_bf16 v[184:187], v[220:223], v[212:215], v[184:187]
    v_cvt_pk_bf16_f32 v51, v175, v179
    s_waitcnt lgkmcnt(0)
    v_mfma_f32_16x16x32_bf16 v[152:155], v[224:227], v[200:203], v[152:155]
    buffer_store_dwordx4 v[48:51], v1, s[8:11], s76 offen nt
    v_mfma_f32_16x16x32_bf16 v[184:187], v[224:227], v[216:219], v[184:187]
    s_add_u32 s76, s76, 32768
    s_nop 4
    v_cvt_pk_bf16_f32 v52, v148, v152
    v_cvt_pk_bf16_f32 v53, v149, v153
    v_cvt_pk_bf16_f32 v54, v150, v154
    v_cvt_pk_bf16_f32 v55, v151, v155
    buffer_store_dwordx4 v[52:55], v1, s[8:11], s72 offen nt
    s_add_u32 s72, s72, 32768
    v_cvt_pk_bf16_f32 v56, v180, v184
    v_cvt_pk_bf16_f32 v57, v181, v185
    v_cvt_pk_bf16_f32 v58, v182, v186
    v_cvt_pk_bf16_f32 v59, v183, v187
    buffer_store_dwordx4 v[56:59], v1, s[8:11], s76 offen nt
    s_add_u32 s76, s76, 32768
    s_cmp_ge_u32 s63, 64
    s_cbranch_scc1 L_xa_join
    s_min_u32 s46, s63, 63
    s_cmp_eq_u32 s46, 0
    s_cselect_b32 s47, 64, s46
    s_lshl_b32 s68, s47, 13
    s_add_u32 s68, s68, 1048576
    s_lshl_b32 s46, s46, 18
    s_lshl_b32 s47, s62, 13
    s_add_u32 s46, s46, s47
    s_add_u32 s70, s46, 33554432
    s_and_b32 s47, s18, 1
    s_lshl_b32 s47, s47, 12
    s_add_u32 s69, s46, s47
    s_add_u32 s69, s69, 67108864
    s_lshr_b32 s47, s18, 1
    s_lshl_b32 s47, s47, 12
    s_add_u32 s71, s46, s47
    s_add_u32 s71, s71, 50331648
    s_add_u32 m0, s78, 17472
    s_nop 0
    buffer_load_dwordx4 v9, s[8:11], s70 offen offset:0 sc1 lds
    buffer_load_dwordx4 v9, s[8:11], s70 offen offset:1024 sc1 lds
    buffer_load_dwordx4 v[60:63], v1, s[8:11], s69 offen offset:0 sc1
    buffer_load_dwordx4 v[64:67], v1, s[8:11], s69 offen offset:1024 sc1
    buffer_load_dwordx4 v[68:71], v1, s[8:11], s69 offen offset:2048 sc1
    buffer_load_dwordx4 v[72:75], v1, s[8:11], s69 offen offset:3072 sc1
    buffer_load_dwordx4 v[240:243], v9, s[8:11], s68 offen offset:0 sc1
    buffer_load_dwordx4 v[244:247], v9, s[8:11], s68 offen offset:1024 sc1
    buffer_load_dwordx4 v[108:111], v1, s[8:11], s71 offen offset:0 sc1
    buffer_load_dwordx4 v[112:115], v1, s[8:11], s71 offen offset:1024 sc1
    buffer_load_dwordx4 v[116:119], v1, s[8:11], s71 offen offset:2048 sc1
    buffer_load_dwordx4 v[120:123], v1, s[8:11], s71 offen offset:3072 sc1
L_xa_join:
    s_mov_b32 s75, s77
    s_add_u32 s64, s64, 1
    s_mov_b32 s84, 1
    s_branch L_xa_loop
L_xa_out:
    s_branch L_wend
L_bpart:
    s_cmp_eq_u32 s60, 7
    s_cbranch_scc1 L_wend
    s_load_dwordx4 s[72:75], s[0:1], 72
    s_mov_b32 s50, 1024
    s_and_b32 s48, s61, 1
    s_lshl_b32 s51, s48, 9
    s_lshl_b32 s46, s18, 7
    s_add_u32 s51, s51, s46
    s_waitcnt lgkmcnt(0)
    s_mov_b32 s24, s72
    s_and_b32 s25, s73, 0xffff
    s_mov_b32 s26, 524288
    s_mov_b32 s27, 0x00020000
    s_mov_b32 s28, s74
    s_and_b32 s29, s75, 0xffff
    s_mov_b32 s30, 4194304
    s_mov_b32 s31, 0x00020000
    s_call_b64 s[52:53], L_gemm_b
    s_mov_b32 s62, s61
    s_sub_u32 s70, s60, 4
    s_mul_i32 s63, s70, 24
    s_cmp_eq_u32 s70, 2
    s_cselect_b32 s64, 2, 3
    v_mov_b32 v6, 0
    s_mov_b32 s49, 0
    s_cmp_eq_u32 s18, 0
    s_cbranch_scc0 L_wc_15_x
L_wc_15:
    global_load_dword v7, v6, s[16:17] offset:36 sc1
    s_waitcnt vmcnt(0)
    v_readfirstlane_b32 s48, v7
    s_add_u32 s49, s49, 1
    s_cmp_ge_u32 s49, 200000
    s_cbranch_scc1 L_wc_15_x
    s_cmp_ge_u32 s48, 120
    s_cbranch_scc1 L_wc_15_x
    s_branch L_wc_15
L_wc_15_x:
    s_barrier
    v_and_b32 v24, 63, v0
    v_and_b32 v25, 7, v24
    v_bfe_u32 v26, v24, 4, 1
    v_lshl_add_u32 v27, v26, 3, v25
    v_lshlrev_b32 v1, 4, v27
    v_lshrrev_b32 v28, 5, v24
    v_lshl_add_u32 v1, v28, 8, v1
    v_bfe_u32 v29, v24, 3, 1
    v_lshl_add_u32 v1, v29, 12, v1
    s_and_b32 s46, s62, 7
    s_lshl_b32 s46, s46, 9
    v_add_u32 v1, s46, v1
    v_and_b32 v30, 3, v24
    v_lshl_add_u32 v30, v29, 2, v30
    v_bfe_u32 v31, v24, 2, 1
    v_lshl_add_u32 v30, v31, 3, v30
    v_lshl_add_u32 v30, v26, 4, v30
    v_lshlrev_b32 v5, 4, v30
    v_lshl_add_u32 v5, v28, 9, v5
    v_and_b32 v30, 3, v24
    v_lshlrev_b32 v2, 4, v30
    v_bfe_u32 v31, v24, 2, 2
    v_lshl_add_u32 v2, v31, 10, v2
    v_lshrrev_b32 v31, 4, v24
    v_lshl_add_u32 v2, v31, 8, v2
    s_and_b32 s46, s62, 3
    s_lshl_b32 s46, s46, 6
    s_and_b32 s47, s62, 4
    s_lshl_b32 s47, s47, 10
    s_add_u32 s46, s46, s47
    v_add_u32 v2, s46, v2
    s_lshr_b32 s46, s62, 3
    s_lshl_b32 s46, s46, 13
    s_add_u32 s46, s46, 100663296
    s_mul_i32 s47, s18, 1572864
    s_add_u32 s47, s47, s46
    s_add_u32 s47, s47, 32768
    s_lshl_b32 s48, s18, 14
    s_add_u32 m0, s48, 0
    s_add_u32 s49, s47, 32768
    buffer_load_dwordx4 v1, s[8:11], s47 offen sc1 lds
    s_add_u32 m0, s48, 65536
    s_add_u32 s47, s47, 98304
    buffer_load_dwordx4 v2, s[8:11], s49 offen sc1 lds
    s_add_u32 m0, s48, 1024
    s_add_u32 s49, s47, 32768
    buffer_load_dwordx4 v1, s[8:11], s47 offen sc1 lds
    s_add_u32 m0, s48, 66560
    s_add_u32 s47, s47, 98304
    buffer_load_dwordx4 v2, s[8:11], s49 offen sc1 lds
    s_add_u32 m0, s48, 2048
    s_add_u32 s49, s47, 32768
    buffer_load_dwordx4 v1, s[8:11], s47 offen sc1 lds
    s_add_u32 m0, s48, 67584
    s_add_u32 s47, s47, 98304
    buffer_load_dwordx4 v2, s[8:11], s49 offen sc1 lds
    s_add_u32 m0, s48, 3072
    s_add_u32 s49, s47, 32768
    buffer_load_dwordx4 v1, s[8:11], s47 offen sc1 lds
    s_add_u32 m0, s48, 68608
    s_add_u32 s47, s47, 98304
    buffer_load_dwordx4 v2, s[8:11], s49 offen sc1 lds
    s_add_u32 m0, s48, 4096
    s_add_u32 s49, s47, 32768
    buffer_load_dwordx4 v1, s[8:11], s47 offen sc1 lds
    s_add_u32 m0, s48, 69632
    s_add_u32 s47, s47, 98304
    buffer_load_dwordx4 v2, s[8:11], s49 offen sc1 lds
    s_add_u32 m0, s48, 5120
    s_add_u32 s49, s47, 32768
    buffer_load_dwordx4 v1, s[8:11], s47 offen sc1 lds
    s_add_u32 m0, s48, 70656
    s_add_u32 s47, s47, 98304
    buffer_load_dwordx4 v2, s[8:11], s49 offen sc1 lds
    s_add_u32 m0, s48, 6144
    s_add_u32 s49, s47, 32768
    buffer_load_dwordx4 v1, s[8:11], s47 offen sc1 lds
    s_add_u32 m0, s48, 71680
    s_add_u32 s47, s47, 98304
    buffer_load_dwordx4 v2, s[8:11], s49 offen sc1 lds
    s_add_u32 m0, s48, 7168
    s_add_u32 s49, s47, 32768
    buffer_load_dwordx4 v1, s[8:11], s47 offen sc1 lds
    s_add_u32 m0, s48, 72704
    s_add_u32 s47, s47, 98304
    buffer_load_dwordx4 v2, s[8:11], s49 offen sc1 lds
    s_add_u32 m0, s48, 8192
    s_add_u32 s49, s47, 32768
    buffer_load_dwordx4 v1, s[8:11], s47 offen sc1 lds
    s_add_u32 m0, s48, 73728
    s_add_u32 s47, s47, 98304
    buffer_load_dwordx4 v2, s[8:11], s49 offen sc1 lds
    s_add_u32 m0, s48, 9216
    s_add_u32 s49, s47, 32768
    buffer_load_dwordx4 v1, s[8:11], s47 offen sc1 lds
    s_add_u32 m0, s48, 74752
    s_add_u32 s47, s47, 98304
    buffer_load_dwordx4 v2, s[8:11], s49 offen sc1 lds
    s_add_u32 m0, s48, 10240
    s_add_u32 s49, s47, 32768
    buffer_load_dwordx4 v1, s[8:11], s47 offen sc1 lds
    s_add_u32 m0, s48, 75776
    s_add_u32 s47, s47, 98304
    buffer_load_dwordx4 v2, s[8:11], s49 offen sc1 lds
    s_add_u32 m0, s48, 11264
    s_add_u32 s49, s47, 32768
    buffer_load_dwordx4 v1, s[8:11], s47 offen sc1 lds
    s_add_u32 m0, s48, 76800
    s_add_u32 s47, s47, 98304
    buffer_load_dwordx4 v2, s[8:11], s49 offen sc1 lds
    s_add_u32 m0, s48, 12288
    s_add_u32 s49, s47, 32768
    buffer_load_dwordx4 v1, s[8:11], s47 offen sc1 lds
    s_add_u32 m0, s48, 77824
    s_add_u32 s47, s47, 98304
    buffer_load_dwordx4 v2, s[8:11], s49 offen sc1 lds
    s_add_u32 m0, s48, 13312
    s_add_u32 s49, s47, 32768
    buffer_load_dwordx4 v1, s[8:11], s47 offen sc1 lds
    s_add_u32 m0, s48, 78848
    s_add_u32 s47, s47, 98304
    buffer_load_dwordx4 v2, s[8:11], s49 offen sc1 lds
    s_add_u32 m0, s48, 14336
    s_add_u32 s49, s47, 32768
    buffer_load_dwordx4 v1, s[8:11], s47 offen sc1 lds
    s_add_u32 m0, s48, 79872
    s_add_u32 s47, s47, 98304
    buffer_load_dwordx4 v2, s[8:11], s49 offen sc1 lds
    s_add_u32 m0, s48, 15360
    s_add_u32 s49, s47, 32768
    buffer_load_dwordx4 v1, s[8:11], s47 offen sc1 lds
    s_add_u32 m0, s48, 80896
    s_add_u32 s47, s47, 98304
    buffer_load_dwordx4 v2, s[8:11], s49 offen sc1 lds
    s_mov_b32 s66, 0xffff
    s_mov_b32 s67, 0xffff
    s_lshl_b32 s47, s18, 1
    s_add_u32 s63, s63, s47
    s_mov_b32 s69, s46
    v_and_b32 v160, 27, v0
    v_cmp_eq_u32 vcc, 16, v160
    v_mov_b32 v161, 0x3f803f80
    s_nop 0
    v_cndmask_b32 v160, 0, v161, vcc
    v_mov_b32 v24, v160
    v_mov_b32 v25, v160
    v_mov_b32 v26, v160
    v_mov_b32 v27, v160
    v_mov_b32 v28, v160
    v_mov_b32 v29, v160
    v_mov_b32 v30, v160
    v_mov_b32 v31, v160
    v_mov_b32 v32, v160
    v_mov_b32 v33, v160
    v_mov_b32 v34, v160
    v_mov_b32 v35, v160
    v_mov_b32 v36, v160
    v_mov_b32 v37, v160
    v_mov_b32 v38, v160
    v_mov_b32 v39, v160
    s_waitcnt vmcnt(0)
    s_barrier
L_ba_pass:
    s_mul_i32 s47, s63, 98304
    s_add_u32 s47, s47, s69
    s_add_u32 s48, s47, 98304
    buffer_load_dwordx4 v[8:11], v1, s[8:11], s47 offen sc1
    buffer_load_dwordx4 v[12:15], v1, s[8:11], s48 offen sc1
    v_and_b32 v160, 63, v0
    v_lshlrev_b32 v3, 4, v160
    v_and_b32 v161, 3, v160
    v_lshlrev_b32 v161, 2, v161
    v_bfe_u32 v162, v160, 2, 1
    v_lshl_add_u32 v161, v162, 1, v161
    v_bfe_u32 v162, v160, 3, 1
    v_add_u32 v161, v161, v162
    v_lshlrev_b32 v161, 4, v161
    v_lshrrev_b32 v162, 5, v160
    v_lshl_add_u32 v161, v162, 8, v161
    v_add_u32 v4, 0x10000, v161
    v_mov_b64 v[96:97], 0
    v_mov_b64 v[128:129], 0
    v_mov_b64 v[98:99], 0
    v_mov_b64 v[130:131], 0
    v_mov_b64 v[100:101], 0
    v_mov_b64 v[132:133], 0
    v_mov_b64 v[102:103], 0
    v_mov_b64 v[134:135], 0
    v_mov_b64 v[104:105], 0
    v_mov_b64 v[136:137], 0
    v_mov_b64 v[106:107], 0
    v_mov_b64 v[138:139], 0
    v_mov_b64 v[108:109], 0
    v_mov_b64 v[140:141], 0
    v_mov_b64 v[110:111], 0
    v_mov_b64 v[142:143], 0
    v_mov_b64 v[112:113], 0
    v_mov_b64 v[144:145], 0
    v_mov_b64 v[114:115], 0
    v_mov_b64 v[146:147], 0
    v_mov_b64 v[116:117], 0
    v_mov_b64 v[148:149], 0
    v_mov_b64 v[118:119], 0
    v_mov_b64 v[150:151], 0
    v_mov_b64 v[120:121], 0
    v_mov_b64 v[152:153], 0
    v_mov_b64 v[122:123], 0
    v_mov_b64 v[154:155], 0
    v_mov_b64 v[124:125], 0
    v_mov_b64 v[156:157], 0
    v_mov_b64 v[126:127], 0
    v_mov_b64 v[158:159], 0
    v_mov_b64 v[48:49], 0
    v_mov_b64 v[50:51], 0
    v_mov_b64 v[52:53], 0
    v_mov_b64 v[54:55], 0
    ds_read_b128 v[16:19], v3 offset:0
    s_mov_b64 exec, s[66:67]
    ds_read_b128 v[32:35], v4 offset:0
    ds_read_b128 v[36:39], v4 offset:512
    s_mov_b64 exec, -1
    s_mov_b32 s65, 0
    s_mov_b32 s68, 0xff800000
    s_waitcnt vmcnt(0) lgkmcnt(0)
    v_mfma_f32_32x32x16_bf16 v[64:79], v[16:19], v[8:11], 0
    s_nop 7
L_ba_loop_f:
    v_mfma_f32_32x32x16_bf16 v[80:95], v[16:19], v[12:15], 0
    ds_read_b128 v[20:23], v3 offset:1024
    s_mov_b64 exec, s[66:67]
    ds_read_b128 v[24:27], v4 offset:0
    ds_read_b128 v[28:31], v4 offset:512
    s_mov_b64 exec, -1
    v_exp_f32 v64, v64
    v_exp_f32 v65, v65
    v_exp_f32 v66, v66
    v_exp_f32 v67, v67
    v_mfma_f32_32x32x16_bf16 v[144:159], v[32:35], v[48:51], v[144:159]
    v_cvt_pk_bf16_f32 v40, v64, v65
    v_exp_f32 v68, v68
    v_exp_f32 v69, v69
    v_cvt_pk_bf16_f32 v41, v66, v67
    v_exp_f32 v70, v70
    v_exp_f32 v71, v71
    v_cvt_pk_bf16_f32 v42, v68, v69
    v_exp_f32 v72, v72
    v_exp_f32 v73, v73
    v_mfma_f32_32x32x16_bf16 v[144:159], v[36:39], v[52:55], v[144:159]
    v_cvt_pk_bf16_f32 v43, v70, v71
    v_exp_f32 v74, v74
    v_exp_f32 v75, v75
    v_cvt_pk_bf16_f32 v44, v72, v73
    v_exp_f32 v76, v76
    v_exp_f32 v77, v77
    v_cvt_pk_bf16_f32 v45, v74, v75
    v_exp_f32 v78, v78
    v_exp_f32 v79, v79
    v_cvt_pk_bf16_f32 v46, v76, v77
    v_cvt_pk_bf16_f32 v47, v78, v79
    s_waitcnt lgkmcnt(2)
    v_mfma_f32_32x32x16_bf16 v[64:79], v[20:23], v[8:11], 0
    s_waitcnt lgkmcnt(0)
    v_exp_f32 v80, v80
    v_exp_f32 v81, v81
    v_exp_f32 v82, v82
    v_exp_f32 v83, v83
    v_mfma_f32_32x32x16_bf16 v[128:143], v[24:27], v[40:43], v[128:143]
    v_cvt_pk_bf16_f32 v48, v80, v81
    v_exp_f32 v84, v84
    v_exp_f32 v85, v85
    v_cvt_pk_bf16_f32 v49, v82, v83
    v_exp_f32 v86, v86
    v_exp_f32 v87, v87
    v_cvt_pk_bf16_f32 v50, v84, v85
    v_exp_f32 v88, v88
    v_exp_f32 v89, v89
    v_mfma_f32_32x32x16_bf16 v[128:143], v[28:31], v[44:47], v[128:143]
    v_cvt_pk_bf16_f32 v51, v86, v87
    v_exp_f32 v90, v90
    v_exp_f32 v91, v91
    v_cvt_pk_bf16_f32 v52, v88, v89
    v_exp_f32 v92, v92
    v_exp_f32 v93, v93
    v_cvt_pk_bf16_f32 v53, v90, v91
    v_exp_f32 v94, v94
    v_exp_f32 v95, v95
    v_cvt_pk_bf16_f32 v54, v92, v93
    v_cvt_pk_bf16_f32 v55, v94, v95
    v_mfma_f32_32x32x16_bf16 v[80:95], v[20:23], v[12:15], 0
    ds_read_b128 v[16:19], v3 offset:2048
    s_mov_b64 exec, s[66:67]
    ds_read_b128 v[32:35], v4 offset:1024
    ds_read_b128 v[36:39], v4 offset:1536
    s_mov_b64 exec, -1
    v_exp_f32 v64, v64
    v_exp_f32 v65, v65
    v_exp_f32 v66, v66
    v_exp_f32 v67, v67
    v_mfma_f32_32x32x16_bf16 v[144:159], v[24:27], v[48:51], v[144:159]
    v_cvt_pk_bf16_f32 v40, v64, v65
    v_exp_f32 v68, v68
    v_exp_f32 v69, v69
    v_cvt_pk_bf16_f32 v41, v66, v67
    v_exp_f32 v70, v70
    v_exp_f32 v71, v71
    v_cvt_pk_bf16_f32 v42, v68, v69
    v_exp_f32 v72, v72
    v_exp_f32 v73, v73
    v_mfma_f32_32x32x16_bf16 v[144:159], v[28:31], v[52:55], v[144:159]
    v_cvt_pk_bf16_f32 v43, v70, v71
    v_exp_f32 v74, v74
    v_exp_f32 v75, v75
    v_cvt_pk_bf16_f32 v44, v72, v73
    v_exp_f32 v76, v76
    v_exp_f32 v77, v77
    v_cvt_pk_bf16_f32 v45, v74, v75
    v_exp_f32 v78, v78
    v_exp_f32 v79, v79
    v_cvt_pk_bf16_f32 v46, v76, v77
    v_cvt_pk_bf16_f32 v47, v78, v79
    s_waitcnt lgkmcnt(2)
    v_mfma_f32_32x32x16_bf16 v[64:79], v[16:19], v[8:11], 0
    s_waitcnt lgkmcnt(0)
    v_exp_f32 v80, v80
    v_exp_f32 v81, v81
    v_exp_f32 v82, v82
    v_exp_f32 v83, v83
    v_mfma_f32_32x32x16_bf16 v[128:143], v[32:35], v[40:43], v[128:143]
    v_cvt_pk_bf16_f32 v48, v80, v81
    v_exp_f32 v84, v84
    v_exp_f32 v85, v85
    v_cvt_pk_bf16_f32 v49, v82, v83
    v_exp_f32 v86, v86
    v_exp_f32 v87, v87
    v_cvt_pk_bf16_f32 v50, v84, v85
    v_exp_f32 v88, v88
    v_exp_f32 v89, v89
    v_mfma_f32_32x32x16_bf16 v[128:143], v[36:39], v[44:47], v[128:143]
    v_cvt_pk_bf16_f32 v51, v86, v87
    v_exp_f32 v90, v90
    v_exp_f32 v91, v91
    v_cvt_pk_bf16_f32 v52, v88, v89
    v_exp_f32 v92, v92
    v_exp_f32 v93, v93
    v_cvt_pk_bf16_f32 v53, v90, v91
    v_exp_f32 v94, v94
    v_exp_f32 v95, v95
    v_cvt_pk_bf16_f32 v54, v92, v93
    v_cvt_pk_bf16_f32 v55, v94, v95
    v_add_u32 v3, 2048, v3
    v_add_u32 v4, 2048, v4
    s_add_u32 s65, s65, 1
    s_cmp_lt_u32 s65, 32
    s_cbranch_scc1 L_ba_loop_f
    v_mfma_f32_32x32x16_bf16 v[144:159], v[32:35], v[48:51], v[144:159]
    v_mfma_f32_32x32x16_bf16 v[144:159], v[36:39], v[52:55], v[144:159]
    s_mov_b32 s47, 671088640
    v_add_u32 v6, 3565158400, v136
    s_nop 9
    v_add_u32 v7, 3565158400, v152
    v_max_u32 v6, v6, v7
    v_cmp_lt_u32 vcc, s47, v6
    s_waitcnt lgkmcnt(0)
    s_cbranch_vccz L_ba_norm
    v_and_b32 v160, 63, v0
    v_lshlrev_b32 v3, 4, v160
    v_and_b32 v161, 3, v160
    v_lshlrev_b32 v161, 2, v161
    v_bfe_u32 v162, v160, 2, 1
    v_lshl_add_u32 v161, v162, 1, v161
    v_bfe_u32 v162, v160, 3, 1
    v_add_u32 v161, v161, v162
    v_lshlrev_b32 v161, 4, v161
    v_lshrrev_b32 v162, 5, v160
    v_lshl_add_u32 v161, v162, 8, v161
    v_add_u32 v4, 0x10000, v161
    v_mov_b64 v[96:97], 0
    v_mov_b64 v[128:129], 0
    v_mov_b64 v[98:99], 0
    v_mov_b64 v[130:131], 0
    v_mov_b64 v[100:101], 0
    v_mov_b64 v[132:133], 0
    v_mov_b64 v[102:103], 0
    v_mov_b64 v[134:135], 0
    v_mov_b64 v[104:105], 0
    v_mov_b64 v[136:137], 0
    v_mov_b64 v[106:107], 0
    v_mov_b64 v[138:139], 0
    v_mov_b64 v[108:109], 0
    v_mov_b64 v[140:141], 0
    v_mov_b64 v[110:111], 0
    v_mov_b64 v[142:143], 0
    v_mov_b64 v[112:113], 0
    v_mov_b64 v[144:145], 0
    v_mov_b64 v[114:115], 0
    v_mov_b64 v[146:147], 0
    v_mov_b64 v[116:117], 0
    v_mov_b64 v[148:149], 0
    v_mov_b64 v[118:119], 0
    v_mov_b64 v[150:151], 0
    v_mov_b64 v[120:121], 0
    v_mov_b64 v[152:153], 0
    v_mov_b64 v[122:123], 0
    v_mov_b64 v[154:155], 0
    v_mov_b64 v[124:125], 0
    v_mov_b64 v[156:157], 0
    v_mov_b64 v[126:127], 0
    v_mov_b64 v[158:159], 0
    v_mov_b64 v[48:49], 0
    v_mov_b64 v[50:51], 0
    v_mov_b64 v[52:53], 0
    v_mov_b64 v[54:55], 0
    ds_read_b128 v[16:19], v3 offset:0
    s_mov_b64 exec, s[66:67]
    ds_read_b128 v[32:35], v4 offset:0
    ds_read_b128 v[36:39], v4 offset:512
    s_mov_b64 exec, -1
    s_mov_b32 s65, 0
    s_mov_b32 s68, 0xff800000
    s_waitcnt vmcnt(0) lgkmcnt(0)
    v_mfma_f32_32x32x16_bf16 v[64:79], v[16:19], v[8:11], v[96:111]
    s_nop 7
L_ba_loop:
    v_mfma_f32_32x32x16_bf16 v[80:95], v[16:19], v[12:15], v[112:127]
    ds_read_b128 v[20:23], v3 offset:1024
    s_mov_b64 exec, s[66:67]
    ds_read_b128 v[24:27], v4 offset:0
    ds_read_b128 v[28:31], v4 offset:512
    s_mov_b64 exec, -1
    v_max3_f32 v6, v64, v65, v66
    v_max3_f32 v7, v67, v68, v69
    v_max3_f32 v6, v6, v70, v71
    v_max3_f32 v7, v7, v72, v73
    v_max3_f32 v6, v6, v74, v75
    v_max3_f32 v7, v7, v76, v77
    v_max3_f32 v6, v6, v78, v79
    v_max_f32 v6, v6, v7
    v_cmp_lt_f32 vcc, s68, v6
    v_mfma_f32_32x32x16_bf16 v[144:159], v[32:35], v[48:51], v[144:159]
    s_cbranch_vccnz L_ba_rs_16
L_ba_rs_16_r:
    v_exp_f32 v64, v64
    v_exp_f32 v65, v65
    v_exp_f32 v66, v66
    v_exp_f32 v67, v67
    v_mfma_f32_32x32x16_bf16 v[144:159], v[36:39], v[52:55], v[144:159]
    v_cvt_pk_bf16_f32 v40, v64, v65
    v_exp_f32 v68, v68
    v_exp_f32 v69, v69
    v_cvt_pk_bf16_f32 v41, v66, v67
    v_exp_f32 v70, v70
    v_exp_f32 v71, v71
    v_cvt_pk_bf16_f32 v42, v68, v69
    v_exp_f32 v72, v72
    v_exp_f32 v73, v73
    v_cvt_pk_bf16_f32 v43, v70, v71
    v_exp_f32 v74, v74
    v_exp_f32 v75, v75
    v_cvt_pk_bf16_f32 v44, v72, v73
    v_exp_f32 v76, v76
    v_exp_f32 v77, v77
    v_cvt_pk_bf16_f32 v45, v74, v75
    v_exp_f32 v78, v78
    v_exp_f32 v79, v79
    v_cvt_pk_bf16_f32 v46, v76, v77
    v_cvt_pk_bf16_f32 v47, v78, v79
    s_waitcnt lgkmcnt(2)
    v_mfma_f32_32x32x16_bf16 v[64:79], v[20:23], v[8:11], v[96:111]
    v_max3_f32 v6, v80, v81, v82
    v_max3_f32 v7, v83, v84, v85
    v_max3_f32 v6, v6, v86, v87
    v_max3_f32 v7, v7, v88, v89
    v_max3_f32 v6, v6, v90, v91
    v_max3_f32 v7, v7, v92, v93
    v_max3_f32 v6, v6, v94, v95
    v_max_f32 v6, v6, v7
    v_cmp_lt_f32 vcc, s68, v6
    s_waitcnt lgkmcnt(0)
    v_mfma_f32_32x32x16_bf16 v[128:143], v[24:27], v[40:43], v[128:143]
    s_cbranch_vccnz L_ba_rs_17
L_ba_rs_17_r:
    v_exp_f32 v80, v80
    v_exp_f32 v81, v81
    v_exp_f32 v82, v82
    v_exp_f32 v83, v83
    v_mfma_f32_32x32x16_bf16 v[128:143], v[28:31], v[44:47], v[128:143]
    v_cvt_pk_bf16_f32 v48, v80, v81
    v_exp_f32 v84, v84
    v_exp_f32 v85, v85
    v_cvt_pk_bf16_f32 v49, v82, v83
    v_exp_f32 v86, v86
    v_exp_f32 v87, v87
    v_cvt_pk_bf16_f32 v50, v84, v85
    v_exp_f32 v88, v88
    v_exp_f32 v89, v89
    v_cvt_pk_bf16_f32 v51, v86, v87
    v_exp_f32 v90, v90
    v_exp_f32 v91, v91
    v_cvt_pk_bf16_f32 v52, v88, v89
    v_exp_f32 v92, v92
    v_exp_f32 v93, v93
    v_cvt_pk_bf16_f32 v53, v90, v91
    v_exp_f32 v94, v94
    v_exp_f32 v95, v95
    v_cvt_pk_bf16_f32 v54, v92, v93
    v_cvt_pk_bf16_f32 v55, v94, v95
    s_mov_b32 s68, 0x41000000
    v_mfma_f32_32x32x16_bf16 v[80:95], v[20:23], v[12:15], v[112:127]
    ds_read_b128 v[16:19], v3 offset:2048
    s_mov_b64 exec, s[66:67]
    ds_read_b128 v[32:35], v4 offset:1024
    ds_read_b128 v[36:39], v4 offset:1536
    s_mov_b64 exec, -1
    v_max3_f32 v6, v64, v65, v66
    v_max3_f32 v7, v67, v68, v69
    v_max3_f32 v6, v6, v70, v71
    v_max3_f32 v7, v7, v72, v73
    v_max3_f32 v6, v6, v74, v75
    v_max3_f32 v7, v7, v76, v77
    v_max3_f32 v6, v6, v78, v79
    v_max_f32 v6, v6, v7
    v_cmp_lt_f32 vcc, s68, v6
    v_mfma_f32_32x32x16_bf16 v[144:159], v[24:27], v[48:51], v[144:159]
    s_cbranch_vccnz L_ba_rs_18
L_ba_rs_18_r:
    v_exp_f32 v64, v64
    v_exp_f32 v65, v65
    v_exp_f32 v66, v66
    v_exp_f32 v67, v67
    v_mfma_f32_32x32x16_bf16 v[144:159], v[28:31], v[52:55], v[144:159]
    v_cvt_pk_bf16_f32 v40, v64, v65
    v_exp_f32 v68, v68
    v_exp_f32 v69, v69
    v_cvt_pk_bf16_f32 v41, v66, v67
    v_exp_f32 v70, v70
    v_exp_f32 v71, v71
    v_cvt_pk_bf16_f32 v42, v68, v69
    v_exp_f32 v72, v72
    v_exp_f32 v73, v73
    v_cvt_pk_bf16_f32 v43, v70, v71
    v_exp_f32 v74, v74
    v_exp_f32 v75, v75
    v_cvt_pk_bf16_f32 v44, v72, v73
    v_exp_f32 v76, v76
    v_exp_f32 v77, v77
    v_cvt_pk_bf16_f32 v45, v74, v75
    v_exp_f32 v78, v78
    v_exp_f32 v79, v79
    v_cvt_pk_bf16_f32 v46, v76, v77
    v_cvt_pk_bf16_f32 v47, v78, v79
    s_waitcnt lgkmcnt(2)
    v_mfma_f32_32x32x16_bf16 v[64:79], v[16:19], v[8:11], v[96:111]
    v_max3_f32 v6, v80, v81, v82
    v_max3_f32 v7, v83, v84, v85
    v_max3_f32 v6, v6, v86, v87
    v_max3_f32 v7, v7, v88, v89
    v_max3_f32 v6, v6, v90, v91
    v_max3_f32 v7, v7, v92, v93
    v_max3_f32 v6, v6, v94, v95
    v_max_f32 v6, v6, v7
    v_cmp_lt_f32 vcc, s68, v6
    s_waitcnt lgkmcnt(0)
    v_mfma_f32_32x32x16_bf16 v[128:143], v[32:35], v[40:43], v[128:143]
    s_cbranch_vccnz L_ba_rs_19
L_ba_rs_19_r:
    v_exp_f32 v80, v80
    v_exp_f32 v81, v81
    v_exp_f32 v82, v82
    v_exp_f32 v83, v83
    v_mfma_f32_32x32x16_bf16 v[128:143], v[36:39], v[44:47], v[128:143]
    v_cvt_pk_bf16_f32 v48, v80, v81
    v_exp_f32 v84, v84
    v_exp_f32 v85, v85
    v_cvt_pk_bf16_f32 v49, v82, v83
    v_exp_f32 v86, v86
    v_exp_f32 v87, v87
    v_cvt_pk_bf16_f32 v50, v84, v85
    v_exp_f32 v88, v88
    v_exp_f32 v89, v89
    v_cvt_pk_bf16_f32 v51, v86, v87
    v_exp_f32 v90, v90
    v_exp_f32 v91, v91
    v_cvt_pk_bf16_f32 v52, v88, v89
    v_exp_f32 v92, v92
    v_exp_f32 v93, v93
    v_cvt_pk_bf16_f32 v53, v90, v91
    v_exp_f32 v94, v94
    v_exp_f32 v95, v95
    v_cvt_pk_bf16_f32 v54, v92, v93
    v_cvt_pk_bf16_f32 v55, v94, v95
    v_add_u32 v3, 2048, v3
    v_add_u32 v4, 2048, v4
    s_add_u32 s65, s65, 1
    s_cmp_lt_u32 s65, 32
    s_cbranch_scc1 L_ba_loop
    v_mfma_f32_32x32x16_bf16 v[144:159], v[32:35], v[48:51], v[144:159]
    v_mfma_f32_32x32x16_bf16 v[144:159], v[36:39], v[52:55], v[144:159]
L_ba_norm:
    s_lshl_b32 s47, s63, 15
    s_lshl_b32 s48, s62, 10
    s_add_u32 s47, s47, s48
    s_add_u32 s47, s47, 109051904
    s_add_u32 s48, s47, 32768
    v_rcp_f32 v6, v136
    s_nop 0
    v_mul_f32 v128, v128, v6
    v_mul_f32 v129, v129, v6
    v_mul_f32 v130, v130, v6
    v_mul_f32 v131, v131, v6
    v_mul_f32 v132, v132, v6
    v_mul_f32 v133, v133, v6
    v_mul_f32 v134, v134, v6
    v_mul_f32 v135, v135, v6
    v_cvt_pk_bf16_f32 v40, v128, v129
    v_cvt_pk_bf16_f32 v41, v130, v131
    v_cvt_pk_bf16_f32 v42, v132, v133
    v_cvt_pk_bf16_f32 v43, v134, v135
    buffer_store_dwordx4 v[40:43], v5, s[8:11], s47 offen sc1
    v_rcp_f32 v6, v152
    s_nop 0
    v_mul_f32 v144, v144, v6
    v_mul_f32 v145, v145, v6
    v_mul_f32 v146, v146, v6
    v_mul_f32 v147, v147, v6
    v_mul_f32 v148, v148, v6
    v_mul_f32 v149, v149, v6
    v_mul_f32 v150, v150, v6
    v_mul_f32 v151, v151, v6
    v_cvt_pk_bf16_f32 v48, v144, v145
    v_cvt_pk_bf16_f32 v49, v146, v147
    v_cvt_pk_bf16_f32 v50, v148, v149
    v_cvt_pk_bf16_f32 v51, v150, v151
    buffer_store_dwordx4 v[48:51], v5, s[8:11], s48 offen sc1
    s_add_u32 s63, s63, 8
    s_sub_u32 s64, s64, 1
    s_cmp_lg_u32 s64, 0
    s_waitcnt lgkmcnt(0)
    s_cbranch_scc1 L_ba_pass
    s_waitcnt vmcnt(0)
    s_barrier
    s_cmp_eq_u32 s18, 0
    s_cbranch_scc0 L_ba_done
    s_lshl_b32 s46, s70, 2
    s_add_u32 s46, s46, 64
    v_mov_b32 v6, s46
    v_mov_b32 v7, 1
    s_mov_b64 exec, 1
    global_atomic_add v6, v7, s[16:17]
    s_mov_b64 exec, -1
    s_branch L_ba_done
L_ba_rs_16:
    v_mov_b32 v7, v6
    s_nop 1
    v_permlane32_swap_b32 v6, v7
    v_max_f32 v6, v6, v7
    s_cmp_eq_u32 s68, 0x41000000
    s_cbranch_scc0 L_ba_rs_16_f
    v_max_f32 v6, 0, v6
L_ba_rs_16_f:
    v_sub_f32 v64, v64, v6
    v_sub_f32 v96, v96, v6
    v_sub_f32 v65, v65, v6
    v_sub_f32 v97, v97, v6
    v_sub_f32 v66, v66, v6
    v_sub_f32 v98, v98, v6
    v_sub_f32 v67, v67, v6
    v_sub_f32 v99, v99, v6
    v_sub_f32 v68, v68, v6
    v_sub_f32 v100, v100, v6
    v_sub_f32 v69, v69, v6
    v_sub_f32 v101, v101, v6
    v_sub_f32 v70, v70, v6
    v_sub_f32 v102, v102, v6
    v_sub_f32 v71, v71, v6
    v_sub_f32 v103, v103, v6
    v_sub_f32 v72, v72, v6
    v_sub_f32 v104, v104, v6
    v_sub_f32 v73, v73, v6
    v_sub_f32 v105, v105, v6
    v_sub_f32 v74, v74, v6
    v_sub_f32 v106, v106, v6
    v_sub_f32 v75, v75, v6
    v_sub_f32 v107, v107, v6
    v_sub_f32 v76, v76, v6
    v_sub_f32 v108, v108, v6
    v_sub_f32 v77, v77, v6
    v_sub_f32 v109, v109, v6
    v_sub_f32 v78, v78, v6
    v_sub_f32 v110, v110, v6
    v_sub_f32 v79, v79, v6
    v_sub_f32 v111, v111, v6
    v_max_f32 v6, 0, v6
    v_sub_f32 v6, 0, v6
    v_exp_f32 v6, v6
    s_nop 0
    v_mul_f32 v128, v128, v6
    v_mul_f32 v129, v129, v6
    v_mul_f32 v130, v130, v6
    v_mul_f32 v131, v131, v6
    v_mul_f32 v132, v132, v6
    v_mul_f32 v133, v133, v6
    v_mul_f32 v134, v134, v6
    v_mul_f32 v135, v135, v6
    v_mul_f32 v136, v136, v6
    v_mul_f32 v137, v137, v6
    v_mul_f32 v138, v138, v6
    v_mul_f32 v139, v139, v6
    v_mul_f32 v140, v140, v6
    v_mul_f32 v141, v141, v6
    v_mul_f32 v142, v142, v6
    v_mul_f32 v143, v143, v6
    s_branch L_ba_rs_16_r
L_ba_rs_17:
    v_mov_b32 v7, v6
    s_nop 1
    v_permlane32_swap_b32 v6, v7
    v_max_f32 v6, v6, v7
    s_cmp_eq_u32 s68, 0x41000000
    s_cbranch_scc0 L_ba_rs_17_f
    v_max_f32 v6, 0, v6
L_ba_rs_17_f:
    v_sub_f32 v80, v80, v6
    v_sub_f32 v112, v112, v6
    v_sub_f32 v81, v81, v6
    v_sub_f32 v113, v113, v6
    v_sub_f32 v82, v82, v6
    v_sub_f32 v114, v114, v6
    v_sub_f32 v83, v83, v6
    v_sub_f32 v115, v115, v6
    v_sub_f32 v84, v84, v6
    v_sub_f32 v116, v116, v6
    v_sub_f32 v85, v85, v6
    v_sub_f32 v117, v117, v6
    v_sub_f32 v86, v86, v6
    v_sub_f32 v118, v118, v6
    v_sub_f32 v87, v87, v6
    v_sub_f32 v119, v119, v6
    v_sub_f32 v88, v88, v6
    v_sub_f32 v120, v120, v6
    v_sub_f32 v89, v89, v6
    v_sub_f32 v121, v121, v6
    v_sub_f32 v90, v90, v6
    v_sub_f32 v122, v122, v6
    v_sub_f32 v91, v91, v6
    v_sub_f32 v123, v123, v6
    v_sub_f32 v92, v92, v6
    v_sub_f32 v124, v124, v6
    v_sub_f32 v93, v93, v6
    v_sub_f32 v125, v125, v6
    v_sub_f32 v94, v94, v6
    v_sub_f32 v126, v126, v6
    v_sub_f32 v95, v95, v6
    v_sub_f32 v127, v127, v6
    v_max_f32 v6, 0, v6
    v_sub_f32 v6, 0, v6
    v_exp_f32 v6, v6
    s_nop 0
    v_mul_f32 v144, v144, v6
    v_mul_f32 v145, v145, v6
    v_mul_f32 v146, v146, v6
    v_mul_f32 v147, v147, v6
    v_mul_f32 v148, v148, v6
    v_mul_f32 v149, v149, v6
    v_mul_f32 v150, v150, v6
    v_mul_f32 v151, v151, v6
    v_mul_f32 v152, v152, v6
    v_mul_f32 v153, v153, v6
    v_mul_f32 v154, v154, v6
    v_mul_f32 v155, v155, v6
    v_mul_f32 v156, v156, v6
    v_mul_f32 v157, v157, v6
    v_mul_f32 v158, v158, v6
    v_mul_f32 v159, v159, v6
    s_branch L_ba_rs_17_r
L_ba_rs_18:
    v_mov_b32 v7, v6
    s_nop 1
    v_permlane32_swap_b32 v6, v7
    v_max_f32 v6, v6, v7
    s_cmp_eq_u32 s68, 0x41000000
    s_cbranch_scc0 L_ba_rs_18_f
    v_max_f32 v6, 0, v6
L_ba_rs_18_f:
    v_sub_f32 v64, v64, v6
    v_sub_f32 v96, v96, v6
    v_sub_f32 v65, v65, v6
    v_sub_f32 v97, v97, v6
    v_sub_f32 v66, v66, v6
    v_sub_f32 v98, v98, v6
    v_sub_f32 v67, v67, v6
    v_sub_f32 v99, v99, v6
    v_sub_f32 v68, v68, v6
    v_sub_f32 v100, v100, v6
    v_sub_f32 v69, v69, v6
    v_sub_f32 v101, v101, v6
    v_sub_f32 v70, v70, v6
    v_sub_f32 v102, v102, v6
    v_sub_f32 v71, v71, v6
    v_sub_f32 v103, v103, v6
    v_sub_f32 v72, v72, v6
    v_sub_f32 v104, v104, v6
    v_sub_f32 v73, v73, v6
    v_sub_f32 v105, v105, v6
    v_sub_f32 v74, v74, v6
    v_sub_f32 v106, v106, v6
    v_sub_f32 v75, v75, v6
    v_sub_f32 v107, v107, v6
    v_sub_f32 v76, v76, v6
    v_sub_f32 v108, v108, v6
    v_sub_f32 v77, v77, v6
    v_sub_f32 v109, v109, v6
    v_sub_f32 v78, v78, v6
    v_sub_f32 v110, v110, v6
    v_sub_f32 v79, v79, v6
    v_sub_f32 v111, v111, v6
    v_max_f32 v6, 0, v6
    v_sub_f32 v6, 0, v6
    v_exp_f32 v6, v6
    s_nop 0
    v_mul_f32 v128, v128, v6
    v_mul_f32 v129, v129, v6
    v_mul_f32 v130, v130, v6
    v_mul_f32 v131, v131, v6
    v_mul_f32 v132, v132, v6
    v_mul_f32 v133, v133, v6
    v_mul_f32 v134, v134, v6
    v_mul_f32 v135, v135, v6
    v_mul_f32 v136, v136, v6
    v_mul_f32 v137, v137, v6
    v_mul_f32 v138, v138, v6
    v_mul_f32 v139, v139, v6
    v_mul_f32 v140, v140, v6
    v_mul_f32 v141, v141, v6
    v_mul_f32 v142, v142, v6
    v_mul_f32 v143, v143, v6
    s_branch L_ba_rs_18_r
L_ba_rs_19:
    v_mov_b32 v7, v6
    s_nop 1
    v_permlane32_swap_b32 v6, v7
    v_max_f32 v6, v6, v7
    s_cmp_eq_u32 s68, 0x41000000
    s_cbranch_scc0 L_ba_rs_19_f
    v_max_f32 v6, 0, v6
L_ba_rs_19_f:
    v_sub_f32 v80, v80, v6
    v_sub_f32 v112, v112, v6
    v_sub_f32 v81, v81, v6
    v_sub_f32 v113, v113, v6
    v_sub_f32 v82, v82, v6
    v_sub_f32 v114, v114, v6
    v_sub_f32 v83, v83, v6
    v_sub_f32 v115, v115, v6
    v_sub_f32 v84, v84, v6
    v_sub_f32 v116, v116, v6
    v_sub_f32 v85, v85, v6
    v_sub_f32 v117, v117, v6
    v_sub_f32 v86, v86, v6
    v_sub_f32 v118, v118, v6
    v_sub_f32 v87, v87, v6
    v_sub_f32 v119, v119, v6
    v_sub_f32 v88, v88, v6
    v_sub_f32 v120, v120, v6
    v_sub_f32 v89, v89, v6
    v_sub_f32 v121, v121, v6
    v_sub_f32 v90, v90, v6
    v_sub_f32 v122, v122, v6
    v_sub_f32 v91, v91, v6
    v_sub_f32 v123, v123, v6
    v_sub_f32 v92, v92, v6
    v_sub_f32 v124, v124, v6
    v_sub_f32 v93, v93, v6
    v_sub_f32 v125, v125, v6
    v_sub_f32 v94, v94, v6
    v_sub_f32 v126, v126, v6
    v_sub_f32 v95, v95, v6
    v_sub_f32 v127, v127, v6
    v_max_f32 v6, 0, v6
    v_sub_f32 v6, 0, v6
    v_exp_f32 v6, v6
    s_nop 0
    v_mul_f32 v144, v144, v6
    v_mul_f32 v145, v145, v6
    v_mul_f32 v146, v146, v6
    v_mul_f32 v147, v147, v6
    v_mul_f32 v148, v148, v6
    v_mul_f32 v149, v149, v6
    v_mul_f32 v150, v150, v6
    v_mul_f32 v151, v151, v6
    v_mul_f32 v152, v152, v6
    v_mul_f32 v153, v153, v6
    v_mul_f32 v154, v154, v6
    v_mul_f32 v155, v155, v6
    v_mul_f32 v156, v156, v6
    v_mul_f32 v157, v157, v6
    v_mul_f32 v158, v158, v6
    v_mul_f32 v159, v159, v6
    s_branch L_ba_rs_19_r
L_ba_done:
    s_cmp_eq_u32 s70, 0
    s_cbranch_scc0 L_bw0
    v_mov_b32 v6, 0
    s_mov_b32 s49, 0
    s_cmp_eq_u32 s18, 0
    s_cbranch_scc0 L_wc_20_x
L_wc_20:
    global_load_dword v7, v6, s[16:17] offset:64 sc1
    s_waitcnt vmcnt(0)
    v_readfirstlane_b32 s48, v7
    s_add_u32 s49, s49, 1
    s_cmp_ge_u32 s49, 200000
    s_cbranch_scc1 L_wc_20_x
    s_cmp_ge_u32 s48, 32
    s_cbranch_scc1 L_wc_20_x
    s_branch L_wc_20
L_wc_20_x:
    s_barrier
L_bw0:
    s_cmp_eq_u32 s70, 1
    s_cbranch_scc0 L_bw1
    v_mov_b32 v6, 0
    s_mov_b32 s49, 0
    s_cmp_eq_u32 s18, 0
    s_cbranch_scc0 L_wc_21_x
L_wc_21:
    global_load_dword v7, v6, s[16:17] offset:68 sc1
    s_waitcnt vmcnt(0)
    v_readfirstlane_b32 s48, v7
    s_add_u32 s49, s49, 1
    s_cmp_ge_u32 s49, 200000
    s_cbranch_scc1 L_wc_21_x
    s_cmp_ge_u32 s48, 32
    s_cbranch_scc1 L_wc_21_x
    s_branch L_wc_21
L_wc_21_x:
    s_barrier
L_bw1:
    s_cmp_eq_u32 s70, 2
    s_cbranch_scc0 L_bw2
    v_mov_b32 v6, 0
    s_mov_b32 s49, 0
    s_cmp_eq_u32 s18, 0
    s_cbranch_scc0 L_wc_22_x
L_wc_22:
    global_load_dword v7, v6, s[16:17] offset:72 sc1
    s_waitcnt vmcnt(0)
    v_readfirstlane_b32 s48, v7
    s_add_u32 s49, s49, 1
    s_cmp_ge_u32 s49, 200000
    s_cbranch_scc1 L_wc_22_x
    s_cmp_ge_u32 s48, 32
    s_cbranch_scc1 L_wc_22_x
    s_branch L_wc_22
L_wc_22_x:
    s_barrier
L_bw2:
    s_waitcnt lgkmcnt(0)
    s_mov_b32 s20, s8
    s_mov_b32 s21, s9
    s_mov_b32 s22, s10
    s_mov_b32 s23, 0x00020000
    s_lshr_b32 s47, s61, 1
    s_mul_i32 s46, s70, 24
    s_add_u32 s47, s47, s46
    s_lshl_b32 s32, s47, 15
    s_add_u32 s32, s32, 109051904
    s_mov_b32 s34, 16
    s_mov_b32 s33, 524288
    s_mov_b32 s43, 2
    s_mov_b32 s50, 1024
    s_cmp_lt_u32 s61, 16
    s_cselect_b32 s42, 2, 1
    s_cmp_eq_u32 s70, 2
    s_cselect_b32 s42, 1, s42
    s_lshl_b32 s36, s47, 16
    s_add_u32 s36, s36, s51
    s_add_u32 s36, s36, 1024
    s_mov_b32 s37, 1048576
    s_mov_b32 s40, 1.0
    s_mov_b32 s41, 1.0
    s_mov_b32 s44, 40
    s_mov_b32 s45, 0
    v_and_b32 v24, 63, v0
    v_lshlrev_b32 v1, 9, v24
    v_bfe_u32 v25, v24, 2, 2
    v_and_b32 v26, 3, v24
    v_lshl_add_u32 v25, v25, 3, v26
    v_lshlrev_b32 v25, 11, v25
    v_lshrrev_b32 v26, 4, v24
    v_lshl_add_u32 v4, v26, 5, v25
    s_call_b64 s[52:53], L_gemm_a
    s_call_b64 s[52:53], L_gemm_c
L_wend:
    s_endpgm
L_gemm_a:
    v_and_b32 v24, 63, v0
    v_and_b32 v25, 15, v24
    v_lshrrev_b32 v26, 4, v24
    v_mul_u32_u24 v3, 1056, v25
    v_lshl_add_u32 v3, v26, 4, v3
    s_and_b32 s46, s18, 1
    s_lshl_b32 s46, s46, 4
    s_lshr_b32 s47, s18, 1
    s_lshl_b32 s47, s47, 2
    s_add_u32 s46, s46, s47
    s_mul_i32 s46, s46, s34
    s_add_u32 s32, s32, s46
    s_mul_i32 s57, s18, 8448
    s_mov_b32 s56, 0
    s_mov_b32 s55, s42
    s_barrier
    s_mul_i32 s48, s34, 0
    s_add_u32 s48, s48, s32
    s_add_u32 m0, s57, 0
    s_nop 0
    buffer_load_dwordx4 v1, s[20:23], s48 offen sc1 lds
    s_mul_i32 s48, s34, 1
    s_add_u32 s48, s48, s32
    s_add_u32 m0, s57, 1056
    s_nop 0
    buffer_load_dwordx4 v1, s[20:23], s48 offen sc1 lds
    s_mul_i32 s48, s34, 2
    s_add_u32 s48, s48, s32
    s_add_u32 m0, s57, 2112
    s_nop 0
    buffer_load_dwordx4 v1, s[20:23], s48 offen sc1 lds
    s_mul_i32 s48, s34, 3
    s_add_u32 s48, s48, s32
    s_add_u32 m0, s57, 3168
    s_nop 0
    buffer_load_dwordx4 v1, s[20:23], s48 offen sc1 lds
    s_mul_i32 s48, s34, 8
    s_add_u32 s48, s48, s32
    s_add_u32 m0, s57, 4224
    s_nop 0
    buffer_load_dwordx4 v1, s[20:23], s48 offen sc1 lds
    s_mul_i32 s48, s34, 9
    s_add_u32 s48, s48, s32
    s_add_u32 m0, s57, 5280
    s_nop 0
    buffer_load_dwordx4 v1, s[20:23], s48 offen sc1 lds
    s_mul_i32 s48, s34, 10
    s_add_u32 s48, s48, s32
    s_add_u32 m0, s57, 6336
    s_nop 0
    buffer_load_dwordx4 v1, s[20:23], s48 offen sc1 lds
    s_mul_i32 s48, s34, 11
    s_add_u32 s48, s48, s32
    s_add_u32 m0, s57, 7392
    s_nop 0
    buffer_load_dwordx4 v1, s[20:23], s48 offen sc1 lds
    s_sub_u32 s55, s55, 1
    s_cmp_gt_i32 s55, 0
    s_cselect_b32 s48, s33, 0
    s_add_u32 s32, s32, s48
    s_add_u32 s57, s57, 33792
    s_cmp_ge_u32 s57, 135168
    s_cselect_b32 s48, 135168, 0
    s_sub_u32 s57, s57, s48
    s_cmp_eq_u32 s42, 1
    s_cbranch_scc1 L_gemm_a_end
    s_mul_i32 s48, s34, 0
    s_add_u32 s48, s48, s32
    s_add_u32 m0, s57, 0
    s_nop 0
    buffer_load_dwordx4 v1, s[20:23], s48 offen sc1 lds
    s_mul_i32 s48, s34, 1
    s_add_u32 s48, s48, s32
    s_add_u32 m0, s57, 1056
    s_nop 0
    buffer_load_dwordx4 v1, s[20:23], s48 offen sc1 lds
    s_mul_i32 s48, s34, 2
    s_add_u32 s48, s48, s32
    s_add_u32 m0, s57, 2112
    s_nop 0
    buffer_load_dwordx4 v1, s[20:23], s48 offen sc1 lds
    s_mul_i32 s48, s34, 3
    s_add_u32 s48, s48, s32
    s_add_u32 m0, s57, 3168
    s_nop 0
    buffer_load_dwordx4 v1, s[20:23], s48 offen sc1 lds
    s_mul_i32 s48, s34, 8
    s_add_u32 s48, s48, s32
    s_add_u32 m0, s57, 4224
    s_nop 0
    buffer_load_dwordx4 v1, s[20:23], s48 offen sc1 lds
    s_mul_i32 s48, s34, 9
    s_add_u32 s48, s48, s32
    s_add_u32 m0, s57, 5280
    s_nop 0
    buffer_load_dwordx4 v1, s[20:23], s48 offen sc1 lds
    s_mul_i32 s48, s34, 10
    s_add_u32 s48, s48, s32
    s_add_u32 m0, s57, 6336
    s_nop 0
    buffer_load_dwordx4 v1, s[20:23], s48 offen sc1 lds
    s_mul_i32 s48, s34, 11
    s_add_u32 s48, s48, s32
    s_add_u32 m0, s57, 7392
    s_nop 0
    buffer_load_dwordx4 v1, s[20:23], s48 offen sc1 lds
    s_sub_u32 s55, s55, 1
    s_cmp_gt_i32 s55, 0
    s_cselect_b32 s48, s33, 0
    s_add_u32 s32, s32, s48
    s_add_u32 s57, s57, 33792
    s_cmp_ge_u32 s57, 135168
    s_cselect_b32 s48, 135168, 0
    s_sub_u32 s57, s57, s48
    s_mul_i32 s48, s34, 0
    s_add_u32 s48, s48, s32
    s_add_u32 m0, s57, 0
    s_nop 0
    buffer_load_dwordx4 v1, s[20:23], s48 offen sc1 lds
    s_mul_i32 s48, s34, 1
    s_add_u32 s48, s48, s32
    s_add_u32 m0, s57, 1056
    s_nop 0
    buffer_load_dwordx4 v1, s[20:23], s48 offen sc1 lds
    s_mul_i32 s48, s34, 2
    s_add_u32 s48, s48, s32
    s_add_u32 m0, s57, 2112
    s_nop 0
    buffer_load_dwordx4 v1, s[20:23], s48 offen sc1 lds
    s_mul_i32 s48, s34, 3
    s_add_u32 s48, s48, s32
    s_add_u32 m0, s57, 3168
    s_nop 0
    buffer_load_dwordx4 v1, s[20:23], s48 offen sc1 lds
    s_mul_i32 s48, s34, 8
    s_add_u32 s48, s48, s32
    s_add_u32 m0, s57, 4224
    s_nop 0
    buffer_load_dwordx4 v1, s[20:23], s48 offen sc1 lds
    s_mul_i32 s48, s34, 9
    s_add_u32 s48, s48, s32
    s_add_u32 m0, s57, 5280
    s_nop 0
    buffer_load_dwordx4 v1, s[20:23], s48 offen sc1 lds
    s_mul_i32 s48, s34, 10
    s_add_u32 s48, s48, s32
    s_add_u32 m0, s57, 6336
    s_nop 0
    buffer_load_dwordx4 v1, s[20:23], s48 offen sc1 lds
    s_mul_i32 s48, s34, 11
    s_add_u32 s48, s48, s32
    s_add_u32 m0, s57, 7392
    s_nop 0
    buffer_load_dwordx4 v1, s[20:23], s48 offen sc1 lds
    s_sub_u32 s55, s55, 1
    s_cmp_gt_i32 s55, 0
    s_cselect_b32 s48, s33, 0
    s_add_u32 s32, s32, s48
    s_add_u32 s57, s57, 33792
    s_cmp_ge_u32 s57, 135168
    s_cselect_b32 s48, 135168, 0
    s_sub_u32 s57, s57, s48
L_gemm_a_end:
    s_setpc_b64 s[52:53]
L_gemm_b:
    v_and_b32 v24, 63, v0
    v_and_b32 v25, 15, v24
    v_lshrrev_b32 v26, 4, v24
    v_lshlrev_b32 v27, 3, v26
    v_mul_lo_u32 v27, v27, s50
    v_lshl_add_u32 v27, v25, 3, v27
    s_mov_b32 s47, s51
    s_mul_i32 s46, s50, 24
    s_mov_b32 s48, 0x05040100
    s_mov_b32 s49, 0x07060302
    buffer_load_dwordx2 v[96:97], v27, s[24:27], s47 offen
    s_add_u32 s47, s47, s50
    buffer_load_dwordx2 v[98:99], v27, s[24:27], s47 offen
    s_add_u32 s47, s47, s50
    buffer_load_dwordx2 v[100:101], v27, s[24:27], s47 offen
    s_add_u32 s47, s47, s50
    buffer_load_dwordx2 v[102:103], v27, s[24:27], s47 offen
    s_add_u32 s47, s47, s50
    buffer_load_dwordx2 v[104:105], v27, s[24:27], s47 offen
    s_add_u32 s47, s47, s50
    buffer_load_dwordx2 v[106:107], v27, s[24:27], s47 offen
    s_add_u32 s47, s47, s50
    buffer_load_dwordx2 v[108:109], v27, s[24:27], s47 offen
    s_add_u32 s47, s47, s50
    buffer_load_dwordx2 v[110:111], v27, s[24:27], s47 offen
    s_add_u32 s47, s47, s50
    s_add_u32 s47, s47, s46
    buffer_load_dwordx2 v[112:113], v27, s[24:27], s47 offen
    s_add_u32 s47, s47, s50
    buffer_load_dwordx2 v[114:115], v27, s[24:27], s47 offen
    s_add_u32 s47, s47, s50
    buffer_load_dwordx2 v[116:117], v27, s[24:27], s47 offen
    s_add_u32 s47, s47, s50
    buffer_load_dwordx2 v[118:119], v27, s[24:27], s47 offen
    s_add_u32 s47, s47, s50
    buffer_load_dwordx2 v[120:121], v27, s[24:27], s47 offen
    s_add_u32 s47, s47, s50
    buffer_load_dwordx2 v[122:123], v27, s[24:27], s47 offen
    s_add_u32 s47, s47, s50
    buffer_load_dwordx2 v[124:125], v27, s[24:27], s47 offen
    s_add_u32 s47, s47, s50
    buffer_load_dwordx2 v[126:127], v27, s[24:27], s47 offen
    s_add_u32 s47, s47, s50
    s_add_u32 s47, s47, s46
    buffer_load_dwordx2 v[128:129], v27, s[24:27], s47 offen
    s_add_u32 s47, s47, s50
    buffer_load_dwordx2 v[130:131], v27, s[24:27], s47 offen
    s_add_u32 s47, s47, s50
    buffer_load_dwordx2 v[132:133], v27, s[24:27], s47 offen
    s_add_u32 s47, s47, s50
    buffer_load_dwordx2 v[134:135], v27, s[24:27], s47 offen
    s_add_u32 s47, s47, s50
    buffer_load_dwordx2 v[136:137], v27, s[24:27], s47 offen
    s_add_u32 s47, s47, s50
    buffer_load_dwordx2 v[138:139], v27, s[24:27], s47 offen
    s_add_u32 s47, s47, s50
    buffer_load_dwordx2 v[140:141], v27, s[24:27], s47 offen
    s_add_u32 s47, s47, s50
    buffer_load_dwordx2 v[142:143], v27, s[24:27], s47 offen
    s_add_u32 s47, s47, s50
    s_add_u32 s47, s47, s46
    buffer_load_dwordx2 v[144:145], v27, s[24:27], s47 offen
    s_add_u32 s47, s47, s50
    buffer_load_dwordx2 v[146:147], v27, s[24:27], s47 offen
    s_add_u32 s47, s47, s50
    buffer_load_dwordx2 v[148:149], v27, s[24:27], s47 offen
    s_add_u32 s47, s47, s50
    buffer_load_dwordx2 v[150:151], v27, s[24:27], s47 offen
    s_add_u32 s47, s47, s50
    buffer_load_dwordx2 v[152:153], v27, s[24:27], s47 offen
    s_add_u32 s47, s47, s50
    buffer_load_dwordx2 v[154:155], v27, s[24:27], s47 offen
    s_add_u32 s47, s47, s50
    buffer_load_dwordx2 v[156:157], v27, s[24:27], s47 offen
    s_add_u32 s47, s47, s50
    buffer_load_dwordx2 v[158:159], v27, s[24:27], s47 offen
    s_add_u32 s47, s47, s50
    s_add_u32 s47, s47, s46
    s_waitcnt vmcnt(24)
    buffer_load_dwordx2 v[160:161], v27, s[24:27], s47 offen
    s_add_u32 s47, s47, s50
    buffer_load_dwordx2 v[162:163], v27, s[24:27], s47 offen
    s_add_u32 s47, s47, s50
    buffer_load_dwordx2 v[164:165], v27, s[24:27], s47 offen
    s_add_u32 s47, s47, s50
    buffer_load_dwordx2 v[166:167], v27, s[24:27], s47 offen
    s_add_u32 s47, s47, s50
    buffer_load_dwordx2 v[168:169], v27, s[24:27], s47 offen
    s_add_u32 s47, s47, s50
    buffer_load_dwordx2 v[170:171], v27, s[24:27], s47 offen
    s_add_u32 s47, s47, s50
    buffer_load_dwordx2 v[172:173], v27, s[24:27], s47 offen
    s_add_u32 s47, s47, s50
    buffer_load_dwordx2 v[174:175], v27, s[24:27], s47 offen
    s_add_u32 s47, s47, s50
    s_add_u32 s47, s47, s46
    buffer_load_dwordx2 v[176:177], v27, s[24:27], s47 offen
    s_add_u32 s47, s47, s50
    buffer_load_dwordx2 v[178:179], v27, s[24:27], s47 offen
    s_add_u32 s47, s47, s50
    buffer_load_dwordx2 v[180:181], v27, s[24:27], s47 offen
    s_add_u32 s47, s47, s50
    buffer_load_dwordx2 v[182:183], v27, s[24:27], s47 offen
    s_add_u32 s47, s47, s50
    buffer_load_dwordx2 v[184:185], v27, s[24:27], s47 offen
    s_add_u32 s47, s47, s50
    buffer_load_dwordx2 v[186:187], v27, s[24:27], s47 offen
    s_add_u32 s47, s47, s50
    buffer_load_dwordx2 v[188:189], v27, s[24:27], s47 offen
    s_add_u32 s47, s47, s50
    buffer_load_dwordx2 v[190:191], v27, s[24:27], s47 offen
    s_add_u32 s47, s47, s50
    s_add_u32 s47, s47, s46
    buffer_load_dwordx2 v[192:193], v27, s[24:27], s47 offen
    s_add_u32 s47, s47, s50
    buffer_load_dwordx2 v[194:195], v27, s[24:27], s47 offen
    s_add_u32 s47, s47, s50
    buffer_load_dwordx2 v[196:197], v27, s[24:27], s47 offen
    s_add_u32 s47, s47, s50
    buffer_load_dwordx2 v[198:199], v27, s[24:27], s47 offen
    s_add_u32 s47, s47, s50
    buffer_load_dwordx2 v[200:201], v27, s[24:27], s47 offen
    s_add_u32 s47, s47, s50
    buffer_load_dwordx2 v[202:203], v27, s[24:27], s47 offen
    s_add_u32 s47, s47, s50
    buffer_load_dwordx2 v[204:205], v27, s[24:27], s47 offen
    s_add_u32 s47, s47, s50
    buffer_load_dwordx2 v[206:207], v27, s[24:27], s47 offen
    s_add_u32 s47, s47, s50
    s_add_u32 s47, s47, s46
    v_perm_b32 v224, v98, v96, s48
    v_perm_b32 v225, v102, v100, s48
    v_perm_b32 v226, v106, v104, s48
    v_perm_b32 v227, v110, v108, s48
    v_perm_b32 v228, v98, v96, s49
    v_perm_b32 v229, v102, v100, s49
    v_perm_b32 v230, v106, v104, s49
    v_perm_b32 v231, v110, v108, s49
    v_perm_b32 v232, v99, v97, s48
    v_perm_b32 v233, v103, v101, s48
    v_perm_b32 v234, v107, v105, s48
    v_perm_b32 v235, v111, v109, s48
    v_perm_b32 v236, v99, v97, s49
    v_perm_b32 v237, v103, v101, s49
    v_perm_b32 v238, v107, v105, s49
    v_perm_b32 v239, v111, v109, s49
    v_accvgpr_write_b32 a0, v224
    v_accvgpr_write_b32 a1, v225
    v_accvgpr_write_b32 a2, v226
    v_accvgpr_write_b32 a3, v227
    v_accvgpr_write_b32 a4, v228
    v_accvgpr_write_b32 a5, v229
    v_accvgpr_write_b32 a6, v230
    v_accvgpr_write_b32 a7, v231
    v_accvgpr_write_b32 a8, v232
    v_accvgpr_write_b32 a9, v233
    v_accvgpr_write_b32 a10, v234
    v_accvgpr_write_b32 a11, v235
    v_accvgpr_write_b32 a12, v236
    v_accvgpr_write_b32 a13, v237
    v_accvgpr_write_b32 a14, v238
    v_accvgpr_write_b32 a15, v239
    s_waitcnt vmcnt(40)
    buffer_load_dwordx2 v[208:209], v27, s[24:27], s47 offen
    s_add_u32 s47, s47, s50
    buffer_load_dwordx2 v[210:211], v27, s[24:27], s47 offen
    s_add_u32 s47, s47, s50
    buffer_load_dwordx2 v[212:213], v27, s[24:27], s47 offen
    s_add_u32 s47, s47, s50
    buffer_load_dwordx2 v[214:215], v27, s[24:27], s47 offen
    s_add_u32 s47, s47, s50
    buffer_load_dwordx2 v[216:217], v27, s[24:27], s47 offen
    s_add_u32 s47, s47, s50
    buffer_load_dwordx2 v[218:219], v27, s[24:27], s47 offen
    s_add_u32 s47, s47, s50
    buffer_load_dwordx2 v[220:221], v27, s[24:27], s47 offen
    s_add_u32 s47, s47, s50
    buffer_load_dwordx2 v[222:223], v27, s[24:27], s47 offen
    s_add_u32 s47, s47, s50
    s_add_u32 s47, s47, s46
    v_perm_b32 v224, v114, v112, s48
    v_perm_b32 v225, v118, v116, s48
    v_perm_b32 v226, v122, v120, s48
    v_perm_b32 v227, v126, v124, s48
    v_perm_b32 v228, v114, v112, s49
    v_perm_b32 v229, v118, v116, s49
    v_perm_b32 v230, v122, v120, s49
    v_perm_b32 v231, v126, v124, s49
    v_perm_b32 v232, v115, v113, s48
    v_perm_b32 v233, v119, v117, s48
    v_perm_b32 v234, v123, v121, s48
    v_perm_b32 v235, v127, v125, s48
    v_perm_b32 v236, v115, v113, s49
    v_perm_b32 v237, v119, v117, s49
    v_perm_b32 v238, v123, v121, s49
    v_perm_b32 v239, v127, v125, s49
    v_accvgpr_write_b32 a16, v224
    v_accvgpr_write_b32 a17, v225
    v_accvgpr_write_b32 a18, v226
    v_accvgpr_write_b32 a19, v227
    v_accvgpr_write_b32 a20, v228
    v_accvgpr_write_b32 a21, v229
    v_accvgpr_write_b32 a22, v230
    v_accvgpr_write_b32 a23, v231
    v_accvgpr_write_b32 a24, v232
    v_accvgpr_write_b32 a25, v233
    v_accvgpr_write_b32 a26, v234
    v_accvgpr_write_b32 a27, v235
    v_accvgpr_write_b32 a28, v236
    v_accvgpr_write_b32 a29, v237
    v_accvgpr_write_b32 a30, v238
    v_accvgpr_write_b32 a31, v239
    s_waitcnt vmcnt(40)
    buffer_load_dwordx2 v[96:97], v27, s[24:27], s47 offen
    s_add_u32 s47, s47, s50
    buffer_load_dwordx2 v[98:99], v27, s[24:27], s47 offen
    s_add_u32 s47, s47, s50
    buffer_load_dwordx2 v[100:101], v27, s[24:27], s47 offen
    s_add_u32 s47, s47, s50
    buffer_load_dwordx2 v[102:103], v27, s[24:27], s47 offen
    s_add_u32 s47, s47, s50
    buffer_load_dwordx2 v[104:105], v27, s[24:27], s47 offen
    s_add_u32 s47, s47, s50
    buffer_load_dwordx2 v[106:107], v27, s[24:27], s47 offen
    s_add_u32 s47, s47, s50
    buffer_load_dwordx2 v[108:109], v27, s[24:27], s47 offen
    s_add_u32 s47, s47, s50
    buffer_load_dwordx2 v[110:111], v27, s[24:27], s47 offen
    s_add_u32 s47, s47, s50
    s_add_u32 s47, s47, s46
    v_perm_b32 v224, v130, v128, s48
    v_perm_b32 v225, v134, v132, s48
    v_perm_b32 v226, v138, v136, s48
    v_perm_b32 v227, v142, v140, s48
    v_perm_b32 v228, v130, v128, s49
    v_perm_b32 v229, v134, v132, s49
    v_perm_b32 v230, v138, v136, s49
    v_perm_b32 v231, v142, v140, s49
    v_perm_b32 v232, v131, v129, s48
    v_perm_b32 v233, v135, v133, s48
    v_perm_b32 v234, v139, v137, s48
    v_perm_b32 v235, v143, v141, s48
    v_perm_b32 v236, v131, v129, s49
    v_perm_b32 v237, v135, v133, s49
    v_perm_b32 v238, v139, v137, s49
    v_perm_b32 v239, v143, v141, s49
    v_accvgpr_write_b32 a32, v224
    v_accvgpr_write_b32 a33, v225
    v_accvgpr_write_b32 a34, v226
    v_accvgpr_write_b32 a35, v227
    v_accvgpr_write_b32 a36, v228
    v_accvgpr_write_b32 a37, v229
    v_accvgpr_write_b32 a38, v230
    v_accvgpr_write_b32 a39, v231
    v_accvgpr_write_b32 a40, v232
    v_accvgpr_write_b32 a41, v233
    v_accvgpr_write_b32 a42, v234
    v_accvgpr_write_b32 a43, v235
    v_accvgpr_write_b32 a44, v236
    v_accvgpr_write_b32 a45, v237
    v_accvgpr_write_b32 a46, v238
    v_accvgpr_write_b32 a47, v239
    s_waitcnt vmcnt(40)
    buffer_load_dwordx2 v[112:113], v27, s[24:27], s47 offen
    s_add_u32 s47, s47, s50
    buffer_load_dwordx2 v[114:115], v27, s[24:27], s47 offen
    s_add_u32 s47, s47, s50
    buffer_load_dwordx2 v[116:117], v27, s[24:27], s47 offen
    s_add_u32 s47, s47, s50
    buffer_load_dwordx2 v[118:119], v27, s[24:27], s47 offen
    s_add_u32 s47, s47, s50
    buffer_load_dwordx2 v[120:121], v27, s[24:27], s47 offen
    s_add_u32 s47, s47, s50
    buffer_load_dwordx2 v[122:123], v27, s[24:27], s47 offen
    s_add_u32 s47, s47, s50
    buffer_load_dwordx2 v[124:125], v27, s[24:27], s47 offen
    s_add_u32 s47, s47, s50
    buffer_load_dwordx2 v[126:127], v27, s[24:27], s47 offen
    s_add_u32 s47, s47, s50
    s_add_u32 s47, s47, s46
    v_perm_b32 v224, v146, v144, s48
    v_perm_b32 v225, v150, v148, s48
    v_perm_b32 v226, v154, v152, s48
    v_perm_b32 v227, v158, v156, s48
    v_perm_b32 v228, v146, v144, s49
    v_perm_b32 v229, v150, v148, s49
    v_perm_b32 v230, v154, v152, s49
    v_perm_b32 v231, v158, v156, s49
    v_perm_b32 v232, v147, v145, s48
    v_perm_b32 v233, v151, v149, s48
    v_perm_b32 v234, v155, v153, s48
    v_perm_b32 v235, v159, v157, s48
    v_perm_b32 v236, v147, v145, s49
    v_perm_b32 v237, v151, v149, s49
    v_perm_b32 v238, v155, v153, s49
    v_perm_b32 v239, v159, v157, s49
    v_accvgpr_write_b32 a48, v224
    v_accvgpr_write_b32 a49, v225
    v_accvgpr_write_b32 a50, v226
    v_accvgpr_write_b32 a51, v227
    v_accvgpr_write_b32 a52, v228
    v_accvgpr_write_b32 a53, v229
    v_accvgpr_write_b32 a54, v230
    v_accvgpr_write_b32 a55, v231
    v_accvgpr_write_b32 a56, v232
    v_accvgpr_write_b32 a57, v233
    v_accvgpr_write_b32 a58, v234
    v_accvgpr_write_b32 a59, v235
    v_accvgpr_write_b32 a60, v236
    v_accvgpr_write_b32 a61, v237
    v_accvgpr_write_b32 a62, v238
    v_accvgpr_write_b32 a63, v239
    s_waitcnt vmcnt(40)
    buffer_load_dwordx2 v[128:129], v27, s[24:27], s47 offen
    s_add_u32 s47, s47, s50
    buffer_load_dwordx2 v[130:131], v27, s[24:27], s47 offen
    s_add_u32 s47, s47, s50
    buffer_load_dwordx2 v[132:133], v27, s[24:27], s47 offen
    s_add_u32 s47, s47, s50
    buffer_load_dwordx2 v[134:135], v27, s[24:27], s47 offen
    s_add_u32 s47, s47, s50
    buffer_load_dwordx2 v[136:137], v27, s[24:27], s47 offen
    s_add_u32 s47, s47, s50
    buffer_load_dwordx2 v[138:139], v27, s[24:27], s47 offen
    s_add_u32 s47, s47, s50
    buffer_load_dwordx2 v[140:141], v27, s[24:27], s47 offen
    s_add_u32 s47, s47, s50
    buffer_load_dwordx2 v[142:143], v27, s[24:27], s47 offen
    s_add_u32 s47, s47, s50
    s_add_u32 s47, s47, s46
    v_perm_b32 v224, v162, v160, s48
    v_perm_b32 v225, v166, v164, s48
    v_perm_b32 v226, v170, v168, s48
    v_perm_b32 v227, v174, v172, s48
    v_perm_b32 v228, v162, v160, s49
    v_perm_b32 v229, v166, v164, s49
    v_perm_b32 v230, v170, v168, s49
    v_perm_b32 v231, v174, v172, s49
    v_perm_b32 v232, v163, v161, s48
    v_perm_b32 v233, v167, v165, s48
    v_perm_b32 v234, v171, v169, s48
    v_perm_b32 v235, v175, v173, s48
    v_perm_b32 v236, v163, v161, s49
    v_perm_b32 v237, v167, v165, s49
    v_perm_b32 v238, v171, v169, s49
    v_perm_b32 v239, v175, v173, s49
    v_accvgpr_write_b32 a64, v224
    v_accvgpr_write_b32 a65, v225
    v_accvgpr_write_b32 a66, v226
    v_accvgpr_write_b32 a67, v227
    v_accvgpr_write_b32 a68, v228
    v_accvgpr_write_b32 a69, v229
    v_accvgpr_write_b32 a70, v230
    v_accvgpr_write_b32 a71, v231
    v_accvgpr_write_b32 a72, v232
    v_accvgpr_write_b32 a73, v233
    v_accvgpr_write_b32 a74, v234
    v_accvgpr_write_b32 a75, v235
    v_accvgpr_write_b32 a76, v236
    v_accvgpr_write_b32 a77, v237
    v_accvgpr_write_b32 a78, v238
    v_accvgpr_write_b32 a79, v239
    s_waitcnt vmcnt(40)
    buffer_load_dwordx2 v[144:145], v27, s[24:27], s47 offen
    s_add_u32 s47, s47, s50
    buffer_load_dwordx2 v[146:147], v27, s[24:27], s47 offen
    s_add_u32 s47, s47, s50
    buffer_load_dwordx2 v[148:149], v27, s[24:27], s47 offen
    s_add_u32 s47, s47, s50
    buffer_load_dwordx2 v[150:151], v27, s[24:27], s47 offen
    s_add_u32 s47, s47, s50
    buffer_load_dwordx2 v[152:153], v27, s[24:27], s47 offen
    s_add_u32 s47, s47, s50
    buffer_load_dwordx2 v[154:155], v27, s[24:27], s47 offen
    s_add_u32 s47, s47, s50
    buffer_load_dwordx2 v[156:157], v27, s[24:27], s47 offen
    s_add_u32 s47, s47, s50
    buffer_load_dwordx2 v[158:159], v27, s[24:27], s47 offen
    s_add_u32 s47, s47, s50
    s_add_u32 s47, s47, s46
    v_perm_b32 v224, v178, v176, s48
    v_perm_b32 v225, v182, v180, s48
    v_perm_b32 v226, v186, v184, s48
    v_perm_b32 v227, v190, v188, s48
    v_perm_b32 v228, v178, v176, s49
    v_perm_b32 v229, v182, v180, s49
    v_perm_b32 v230, v186, v184, s49
    v_perm_b32 v231, v190, v188, s49
    v_perm_b32 v232, v179, v177, s48
    v_perm_b32 v233, v183, v181, s48
    v_perm_b32 v234, v187, v185, s48
    v_perm_b32 v235, v191, v189, s48
    v_perm_b32 v236, v179, v177, s49
    v_perm_b32 v237, v183, v181, s49
    v_perm_b32 v238, v187, v185, s49
    v_perm_b32 v239, v191, v189, s49
    v_accvgpr_write_b32 a80, v224
    v_accvgpr_write_b32 a81, v225
    v_accvgpr_write_b32 a82, v226
    v_accvgpr_write_b32 a83, v227
    v_accvgpr_write_b32 a84, v228
    v_accvgpr_write_b32 a85, v229
    v_accvgpr_write_b32 a86, v230
    v_accvgpr_write_b32 a87, v231
    v_accvgpr_write_b32 a88, v232
    v_accvgpr_write_b32 a89, v233
    v_accvgpr_write_b32 a90, v234
    v_accvgpr_write_b32 a91, v235
    v_accvgpr_write_b32 a92, v236
    v_accvgpr_write_b32 a93, v237
    v_accvgpr_write_b32 a94, v238
    v_accvgpr_write_b32 a95, v239
    s_waitcnt vmcnt(40)
    buffer_load_dwordx2 v[160:161], v27, s[24:27], s47 offen
    s_add_u32 s47, s47, s50
    buffer_load_dwordx2 v[162:163], v27, s[24:27], s47 offen
    s_add_u32 s47, s47, s50
    buffer_load_dwordx2 v[164:165], v27, s[24:27], s47 offen
    s_add_u32 s47, s47, s50
    buffer_load_dwordx2 v[166:167], v27, s[24:27], s47 offen
    s_add_u32 s47, s47, s50
    buffer_load_dwordx2 v[168:169], v27, s[24:27], s47 offen
    s_add_u32 s47, s47, s50
    buffer_load_dwordx2 v[170:171], v27, s[24:27], s47 offen
    s_add_u32 s47, s47, s50
    buffer_load_dwordx2 v[172:173], v27, s[24:27], s47 offen
    s_add_u32 s47, s47, s50
    buffer_load_dwordx2 v[174:175], v27, s[24:27], s47 offen
    s_add_u32 s47, s47, s50
    s_add_u32 s47, s47, s46
    v_perm_b32 v224, v194, v192, s48
    v_perm_b32 v225, v198, v196, s48
    v_perm_b32 v226, v202, v200, s48
    v_perm_b32 v227, v206, v204, s48
    v_perm_b32 v228, v194, v192, s49
    v_perm_b32 v229, v198, v196, s49
    v_perm_b32 v230, v202, v200, s49
    v_perm_b32 v231, v206, v204, s49
    v_perm_b32 v232, v195, v193, s48
    v_perm_b32 v233, v199, v197, s48
    v_perm_b32 v234, v203, v201, s48
    v_perm_b32 v235, v207, v205, s48
    v_perm_b32 v236, v195, v193, s49
    v_perm_b32 v237, v199, v197, s49
    v_perm_b32 v238, v203, v201, s49
    v_perm_b32 v239, v207, v205, s49
    v_accvgpr_write_b32 a96, v224
    v_accvgpr_write_b32 a97, v225
    v_accvgpr_write_b32 a98, v226
    v_accvgpr_write_b32 a99, v227
    v_accvgpr_write_b32 a100, v228
    v_accvgpr_write_b32 a101, v229
    v_accvgpr_write_b32 a102, v230
    v_accvgpr_write_b32 a103, v231
    v_accvgpr_write_b32 a104, v232
    v_accvgpr_write_b32 a105, v233
    v_accvgpr_write_b32 a106, v234
    v_accvgpr_write_b32 a107, v235
    v_accvgpr_write_b32 a108, v236
    v_accvgpr_write_b32 a109, v237
    v_accvgpr_write_b32 a110, v238
    v_accvgpr_write_b32 a111, v239
    s_waitcnt vmcnt(40)
    buffer_load_dwordx2 v[176:177], v27, s[24:27], s47 offen
    s_add_u32 s47, s47, s50
    buffer_load_dwordx2 v[178:179], v27, s[24:27], s47 offen
    s_add_u32 s47, s47, s50
    buffer_load_dwordx2 v[180:181], v27, s[24:27], s47 offen
    s_add_u32 s47, s47, s50
    buffer_load_dwordx2 v[182:183], v27, s[24:27], s47 offen
    s_add_u32 s47, s47, s50
    buffer_load_dwordx2 v[184:185], v27, s[24:27], s47 offen
    s_add_u32 s47, s47, s50
    buffer_load_dwordx2 v[186:187], v27, s[24:27], s47 offen
    s_add_u32 s47, s47, s50
    buffer_load_dwordx2 v[188:189], v27, s[24:27], s47 offen
    s_add_u32 s47, s47, s50
    buffer_load_dwordx2 v[190:191], v27, s[24:27], s47 offen
    s_add_u32 s47, s47, s50
    s_add_u32 s47, s47, s46
    v_perm_b32 v224, v210, v208, s48
    v_perm_b32 v225, v214, v212, s48
    v_perm_b32 v226, v218, v216, s48
    v_perm_b32 v227, v222, v220, s48
    v_perm_b32 v228, v210, v208, s49
    v_perm_b32 v229, v214, v212, s49
    v_perm_b32 v230, v218, v216, s49
    v_perm_b32 v231, v222, v220, s49
    v_perm_b32 v232, v211, v209, s48
    v_perm_b32 v233, v215, v213, s48
    v_perm_b32 v234, v219, v217, s48
    v_perm_b32 v235, v223, v221, s48
    v_perm_b32 v236, v211, v209, s49
    v_perm_b32 v237, v215, v213, s49
    v_perm_b32 v238, v219, v217, s49
    v_perm_b32 v239, v223, v221, s49
    v_accvgpr_write_b32 a112, v224
    v_accvgpr_write_b32 a113, v225
    v_accvgpr_write_b32 a114, v226
    v_accvgpr_write_b32 a115, v227
    v_accvgpr_write_b32 a116, v228
    v_accvgpr_write_b32 a117, v229
    v_accvgpr_write_b32 a118, v230
    v_accvgpr_write_b32 a119, v231
    v_accvgpr_write_b32 a120, v232
    v_accvgpr_write_b32 a121, v233
    v_accvgpr_write_b32 a122, v234
    v_accvgpr_write_b32 a123, v235
    v_accvgpr_write_b32 a124, v236
    v_accvgpr_write_b32 a125, v237
    v_accvgpr_write_b32 a126, v238
    v_accvgpr_write_b32 a127, v239
    s_waitcnt vmcnt(40)
    buffer_load_dwordx2 v[192:193], v27, s[24:27], s47 offen
    s_add_u32 s47, s47, s50
    buffer_load_dwordx2 v[194:195], v27, s[24:27], s47 offen
    s_add_u32 s47, s47, s50
    buffer_load_dwordx2 v[196:197], v27, s[24:27], s47 offen
    s_add_u32 s47, s47, s50
    buffer_load_dwordx2 v[198:199], v27, s[24:27], s47 offen
    s_add_u32 s47, s47, s50
    buffer_load_dwordx2 v[200:201], v27, s[24:27], s47 offen
    s_add_u32 s47, s47, s50
    buffer_load_dwordx2 v[202:203], v27, s[24:27], s47 offen
    s_add_u32 s47, s47, s50
    buffer_load_dwordx2 v[204:205], v27, s[24:27], s47 offen
    s_add_u32 s47, s47, s50
    buffer_load_dwordx2 v[206:207], v27, s[24:27], s47 offen
    s_add_u32 s47, s47, s50
    s_add_u32 s47, s47, s46
    v_perm_b32 v224, v98, v96, s48
    v_perm_b32 v225, v102, v100, s48
    v_perm_b32 v226, v106, v104, s48
    v_perm_b32 v227, v110, v108, s48
    v_perm_b32 v228, v98, v96, s49
    v_perm_b32 v229, v102, v100, s49
    v_perm_b32 v230, v106, v104, s49
    v_perm_b32 v231, v110, v108, s49
    v_perm_b32 v232, v99, v97, s48
    v_perm_b32 v233, v103, v101, s48
    v_perm_b32 v234, v107, v105, s48
    v_perm_b32 v235, v111, v109, s48
    v_perm_b32 v236, v99, v97, s49
    v_perm_b32 v237, v103, v101, s49
    v_perm_b32 v238, v107, v105, s49
    v_perm_b32 v239, v111, v109, s49
    v_accvgpr_write_b32 a128, v224
    v_accvgpr_write_b32 a129, v225
    v_accvgpr_write_b32 a130, v226
    v_accvgpr_write_b32 a131, v227
    v_accvgpr_write_b32 a132, v228
    v_accvgpr_write_b32 a133, v229
    v_accvgpr_write_b32 a134, v230
    v_accvgpr_write_b32 a135, v231
    v_accvgpr_write_b32 a136, v232
    v_accvgpr_write_b32 a137, v233
    v_accvgpr_write_b32 a138, v234
    v_accvgpr_write_b32 a139, v235
    v_accvgpr_write_b32 a140, v236
    v_accvgpr_write_b32 a141, v237
    v_accvgpr_write_b32 a142, v238
    v_accvgpr_write_b32 a143, v239
    s_waitcnt vmcnt(40)
    buffer_load_dwordx2 v[208:209], v27, s[24:27], s47 offen
    s_add_u32 s47, s47, s50
    buffer_load_dwordx2 v[210:211], v27, s[24:27], s47 offen
    s_add_u32 s47, s47, s50
    buffer_load_dwordx2 v[212:213], v27, s[24:27], s47 offen
    s_add_u32 s47, s47, s50
    buffer_load_dwordx2 v[214:215], v27, s[24:27], s47 offen
    s_add_u32 s47, s47, s50
    buffer_load_dwordx2 v[216:217], v27, s[24:27], s47 offen
    s_add_u32 s47, s47, s50
    buffer_load_dwordx2 v[218:219], v27, s[24:27], s47 offen
    s_add_u32 s47, s47, s50
    buffer_load_dwordx2 v[220:221], v27, s[24:27], s47 offen
    s_add_u32 s47, s47, s50
    buffer_load_dwordx2 v[222:223], v27, s[24:27], s47 offen
    s_add_u32 s47, s47, s50
    s_add_u32 s47, s47, s46
    v_perm_b32 v224, v114, v112, s48
    v_perm_b32 v225, v118, v116, s48
    v_perm_b32 v226, v122, v120, s48
    v_perm_b32 v227, v126, v124, s48
    v_perm_b32 v228, v114, v112, s49
    v_perm_b32 v229, v118, v116, s49
    v_perm_b32 v230, v122, v120, s49
    v_perm_b32 v231, v126, v124, s49
    v_perm_b32 v232, v115, v113, s48
    v_perm_b32 v233, v119, v117, s48
    v_perm_b32 v234, v123, v121, s48
    v_perm_b32 v235, v127, v125, s48
    v_perm_b32 v236, v115, v113, s49
    v_perm_b32 v237, v119, v117, s49
    v_perm_b32 v238, v123, v121, s49
    v_perm_b32 v239, v127, v125, s49
    v_accvgpr_write_b32 a144, v224
    v_accvgpr_write_b32 a145, v225
    v_accvgpr_write_b32 a146, v226
    v_accvgpr_write_b32 a147, v227
    v_accvgpr_write_b32 a148, v228
    v_accvgpr_write_b32 a149, v229
    v_accvgpr_write_b32 a150, v230
    v_accvgpr_write_b32 a151, v231
    v_accvgpr_write_b32 a152, v232
    v_accvgpr_write_b32 a153, v233
    v_accvgpr_write_b32 a154, v234
    v_accvgpr_write_b32 a155, v235
    v_accvgpr_write_b32 a156, v236
    v_accvgpr_write_b32 a157, v237
    v_accvgpr_write_b32 a158, v238
    v_accvgpr_write_b32 a159, v239
    s_waitcnt vmcnt(40)
    v_perm_b32 v224, v130, v128, s48
    v_perm_b32 v225, v134, v132, s48
    v_perm_b32 v226, v138, v136, s48
    v_perm_b32 v227, v142, v140, s48
    v_perm_b32 v228, v130, v128, s49
    v_perm_b32 v229, v134, v132, s49
    v_perm_b32 v230, v138, v136, s49
    v_perm_b32 v231, v142, v140, s49
    v_perm_b32 v232, v131, v129, s48
    v_perm_b32 v233, v135, v133, s48
    v_perm_b32 v234, v139, v137, s48
    v_perm_b32 v235, v143, v141, s48
    v_perm_b32 v236, v131, v129, s49
    v_perm_b32 v237, v135, v133, s49
    v_perm_b32 v238, v139, v137, s49
    v_perm_b32 v239, v143, v141, s49
    v_accvgpr_write_b32 a160, v224
    v_accvgpr_write_b32 a161, v225
    v_accvgpr_write_b32 a162, v226
    v_accvgpr_write_b32 a163, v227
    v_accvgpr_write_b32 a164, v228
    v_accvgpr_write_b32 a165, v229
    v_accvgpr_write_b32 a166, v230
    v_accvgpr_write_b32 a167, v231
    v_accvgpr_write_b32 a168, v232
    v_accvgpr_write_b32 a169, v233
    v_accvgpr_write_b32 a170, v234
    v_accvgpr_write_b32 a171, v235
    v_accvgpr_write_b32 a172, v236
    v_accvgpr_write_b32 a173, v237
    v_accvgpr_write_b32 a174, v238
    v_accvgpr_write_b32 a175, v239
    s_waitcnt vmcnt(32)
    v_perm_b32 v224, v146, v144, s48
    v_perm_b32 v225, v150, v148, s48
    v_perm_b32 v226, v154, v152, s48
    v_perm_b32 v227, v158, v156, s48
    v_perm_b32 v228, v146, v144, s49
    v_perm_b32 v229, v150, v148, s49
    v_perm_b32 v230, v154, v152, s49
    v_perm_b32 v231, v158, v156, s49
    v_perm_b32 v232, v147, v145, s48
    v_perm_b32 v233, v151, v149, s48
    v_perm_b32 v234, v155, v153, s48
    v_perm_b32 v235, v159, v157, s48
    v_perm_b32 v236, v147, v145, s49
    v_perm_b32 v237, v151, v149, s49
    v_perm_b32 v238, v155, v153, s49
    v_perm_b32 v239, v159, v157, s49
    v_accvgpr_write_b32 a176, v224
    v_accvgpr_write_b32 a177, v225
    v_accvgpr_write_b32 a178, v226
    v_accvgpr_write_b32 a179, v227
    v_accvgpr_write_b32 a180, v228
    v_accvgpr_write_b32 a181, v229
    v_accvgpr_write_b32 a182, v230
    v_accvgpr_write_b32 a183, v231
    v_accvgpr_write_b32 a184, v232
    v_accvgpr_write_b32 a185, v233
    v_accvgpr_write_b32 a186, v234
    v_accvgpr_write_b32 a187, v235
    v_accvgpr_write_b32 a188, v236
    v_accvgpr_write_b32 a189, v237
    v_accvgpr_write_b32 a190, v238
    v_accvgpr_write_b32 a191, v239
    s_waitcnt vmcnt(24)
    v_perm_b32 v224, v162, v160, s48
    v_perm_b32 v225, v166, v164, s48
    v_perm_b32 v226, v170, v168, s48
    v_perm_b32 v227, v174, v172, s48
    v_perm_b32 v228, v162, v160, s49
    v_perm_b32 v229, v166, v164, s49
    v_perm_b32 v230, v170, v168, s49
    v_perm_b32 v231, v174, v172, s49
    v_perm_b32 v232, v163, v161, s48
    v_perm_b32 v233, v167, v165, s48
    v_perm_b32 v234, v171, v169, s48
    v_perm_b32 v235, v175, v173, s48
    v_perm_b32 v236, v163, v161, s49
    v_perm_b32 v237, v167, v165, s49
    v_perm_b32 v238, v171, v169, s49
    v_perm_b32 v239, v175, v173, s49
    v_accvgpr_write_b32 a192, v224
    v_accvgpr_write_b32 a193, v225
    v_accvgpr_write_b32 a194, v226
    v_accvgpr_write_b32 a195, v227
    v_accvgpr_write_b32 a196, v228
    v_accvgpr_write_b32 a197, v229
    v_accvgpr_write_b32 a198, v230
    v_accvgpr_write_b32 a199, v231
    v_accvgpr_write_b32 a200, v232
    v_accvgpr_write_b32 a201, v233
    v_accvgpr_write_b32 a202, v234
    v_accvgpr_write_b32 a203, v235
    v_accvgpr_write_b32 a204, v236
    v_accvgpr_write_b32 a205, v237
    v_accvgpr_write_b32 a206, v238
    v_accvgpr_write_b32 a207, v239
    s_waitcnt vmcnt(16)
    v_perm_b32 v224, v178, v176, s48
    v_perm_b32 v225, v182, v180, s48
    v_perm_b32 v226, v186, v184, s48
    v_perm_b32 v227, v190, v188, s48
    v_perm_b32 v228, v178, v176, s49
    v_perm_b32 v229, v182, v180, s49
    v_perm_b32 v230, v186, v184, s49
    v_perm_b32 v231, v190, v188, s49
    v_perm_b32 v232, v179, v177, s48
    v_perm_b32 v233, v183, v181, s48
    v_perm_b32 v234, v187, v185, s48
    v_perm_b32 v235, v191, v189, s48
    v_perm_b32 v236, v179, v177, s49
    v_perm_b32 v237, v183, v181, s49
    v_perm_b32 v238, v187, v185, s49
    v_perm_b32 v239, v191, v189, s49
    v_accvgpr_write_b32 a208, v224
    v_accvgpr_write_b32 a209, v225
    v_accvgpr_write_b32 a210, v226
    v_accvgpr_write_b32 a211, v227
    v_accvgpr_write_b32 a212, v228
    v_accvgpr_write_b32 a213, v229
    v_accvgpr_write_b32 a214, v230
    v_accvgpr_write_b32 a215, v231
    v_accvgpr_write_b32 a216, v232
    v_accvgpr_write_b32 a217, v233
    v_accvgpr_write_b32 a218, v234
    v_accvgpr_write_b32 a219, v235
    v_accvgpr_write_b32 a220, v236
    v_accvgpr_write_b32 a221, v237
    v_accvgpr_write_b32 a222, v238
    v_accvgpr_write_b32 a223, v239
    s_waitcnt vmcnt(8)
    v_perm_b32 v224, v194, v192, s48
    v_perm_b32 v225, v198, v196, s48
    v_perm_b32 v226, v202, v200, s48
    v_perm_b32 v227, v206, v204, s48
    v_perm_b32 v228, v194, v192, s49
    v_perm_b32 v229, v198, v196, s49
    v_perm_b32 v230, v202, v200, s49
    v_perm_b32 v231, v206, v204, s49
    v_perm_b32 v232, v195, v193, s48
    v_perm_b32 v233, v199, v197, s48
    v_perm_b32 v234, v203, v201, s48
    v_perm_b32 v235, v207, v205, s48
    v_perm_b32 v236, v195, v193, s49
    v_perm_b32 v237, v199, v197, s49
    v_perm_b32 v238, v203, v201, s49
    v_perm_b32 v239, v207, v205, s49
    v_accvgpr_write_b32 a224, v224
    v_accvgpr_write_b32 a225, v225
    v_accvgpr_write_b32 a226, v226
    v_accvgpr_write_b32 a227, v227
    v_accvgpr_write_b32 a228, v228
    v_accvgpr_write_b32 a229, v229
    v_accvgpr_write_b32 a230, v230
    v_accvgpr_write_b32 a231, v231
    v_accvgpr_write_b32 a232, v232
    v_accvgpr_write_b32 a233, v233
    v_accvgpr_write_b32 a234, v234
    v_accvgpr_write_b32 a235, v235
    v_accvgpr_write_b32 a236, v236
    v_accvgpr_write_b32 a237, v237
    v_accvgpr_write_b32 a238, v238
    v_accvgpr_write_b32 a239, v239
    s_waitcnt vmcnt(0)
    v_perm_b32 v224, v210, v208, s48
    v_perm_b32 v225, v214, v212, s48
    v_perm_b32 v226, v218, v216, s48
    v_perm_b32 v227, v222, v220, s48
    v_perm_b32 v228, v210, v208, s49
    v_perm_b32 v229, v214, v212, s49
    v_perm_b32 v230, v218, v216, s49
    v_perm_b32 v231, v222, v220, s49
    v_perm_b32 v232, v211, v209, s48
    v_perm_b32 v233, v215, v213, s48
    v_perm_b32 v234, v219, v217, s48
    v_perm_b32 v235, v223, v221, s48
    v_perm_b32 v236, v211, v209, s49
    v_perm_b32 v237, v215, v213, s49
    v_perm_b32 v238, v219, v217, s49
    v_perm_b32 v239, v223, v221, s49
    v_accvgpr_write_b32 a240, v224
    v_accvgpr_write_b32 a241, v225
    v_accvgpr_write_b32 a242, v226
    v_accvgpr_write_b32 a243, v227
    v_accvgpr_write_b32 a244, v228
    v_accvgpr_write_b32 a245, v229
    v_accvgpr_write_b32 a246, v230
    v_accvgpr_write_b32 a247, v231
    v_accvgpr_write_b32 a248, v232
    v_accvgpr_write_b32 a249, v233
    v_accvgpr_write_b32 a250, v234
    v_accvgpr_write_b32 a251, v235
    v_accvgpr_write_b32 a252, v236
    v_accvgpr_write_b32 a253, v237
    v_accvgpr_write_b32 a254, v238
    v_accvgpr_write_b32 a255, v239
    s_setpc_b64 s[52:53]
L_gemm_c:
    s_waitcnt vmcnt(0)
    s_mov_b32 s54, 0
    s_cmp_eq_u32 s43, 1
    s_cbranch_scc1 L_gemm_v
L_gemm_qk:
    v_add_u32 v2, s56, v3
    s_waitcnt vmcnt(12)
    s_barrier
    ds_read_b128 v[32:35], v2 offset:0
    ds_read_b128 v[36:39], v2 offset:16896
    ds_read_b128 v[40:43], v2 offset:64
    ds_read_b128 v[44:47], v2 offset:16960
    ds_read_b128 v[48:51], v2 offset:128
    ds_read_b128 v[52:55], v2 offset:17024
    s_waitcnt lgkmcnt(5)
    v_mfma_f32_16x16x32_bf16 v[64:67], a[0:3], v[32:35], 0
    ds_read_b128 v[56:59], v2 offset:192
    v_mfma_f32_16x16x32_bf16 v[68:71], a[4:7], v[32:35], 0
    v_mfma_f32_16x16x32_bf16 v[72:75], a[8:11], v[32:35], 0
    v_mfma_f32_16x16x32_bf16 v[76:79], a[12:15], v[32:35], 0
    s_waitcnt lgkmcnt(5)
    v_mfma_f32_16x16x32_bf16 v[80:83], a[0:3], v[36:39], 0
    ds_read_b128 v[60:63], v2 offset:17088
    v_mfma_f32_16x16x32_bf16 v[84:87], a[4:7], v[36:39], 0
    v_mfma_f32_16x16x32_bf16 v[88:91], a[8:11], v[36:39], 0
    v_mfma_f32_16x16x32_bf16 v[92:95], a[12:15], v[36:39], 0
    s_waitcnt lgkmcnt(5)
    v_mfma_f32_16x16x32_bf16 v[64:67], a[16:19], v[40:43], v[64:67]
    ds_read_b128 v[32:35], v2 offset:256
    v_mfma_f32_16x16x32_bf16 v[68:71], a[20:23], v[40:43], v[68:71]
    s_mul_i32 s48, s34, 0
    v_mfma_f32_16x16x32_bf16 v[72:75], a[24:27], v[40:43], v[72:75]
    s_add_u32 s48, s48, s32
    v_mfma_f32_16x16x32_bf16 v[76:79], a[28:31], v[40:43], v[76:79]
    s_waitcnt lgkmcnt(5)
    v_mfma_f32_16x16x32_bf16 v[80:83], a[16:19], v[44:47], v[80:83]
    ds_read_b128 v[36:39], v2 offset:17152
    v_mfma_f32_16x16x32_bf16 v[84:87], a[20:23], v[44:47], v[84:87]
    s_add_u32 m0, s57, 0
    v_mfma_f32_16x16x32_bf16 v[88:91], a[24:27], v[44:47], v[88:91]
    buffer_load_dwordx4 v1, s[20:23], s48 offen sc1 lds
    v_mfma_f32_16x16x32_bf16 v[92:95], a[28:31], v[44:47], v[92:95]
    s_waitcnt lgkmcnt(5)
    v_mfma_f32_16x16x32_bf16 v[64:67], a[32:35], v[48:51], v[64:67]
    ds_read_b128 v[40:43], v2 offset:320
    v_mfma_f32_16x16x32_bf16 v[68:71], a[36:39], v[48:51], v[68:71]
    s_mul_i32 s48, s34, 1
    v_mfma_f32_16x16x32_bf16 v[72:75], a[40:43], v[48:51], v[72:75]
    s_add_u32 s48, s48, s32
    v_mfma_f32_16x16x32_bf16 v[76:79], a[44:47], v[48:51], v[76:79]
    s_waitcnt lgkmcnt(5)
    v_mfma_f32_16x16x32_bf16 v[80:83], a[32:35], v[52:55], v[80:83]
    ds_read_b128 v[44:47], v2 offset:17216
    v_mfma_f32_16x16x32_bf16 v[84:87], a[36:39], v[52:55], v[84:87]
    s_add_u32 m0, s57, 1056
    v_mfma_f32_16x16x32_bf16 v[88:91], a[40:43], v[52:55], v[88:91]
    buffer_load_dwordx4 v1, s[20:23], s48 offen sc1 lds
    v_mfma_f32_16x16x32_bf16 v[92:95], a[44:47], v[52:55], v[92:95]
    s_waitcnt lgkmcnt(5)
    v_mfma_f32_16x16x32_bf16 v[64:67], a[48:51], v[56:59], v[64:67]
    ds_read_b128 v[48:51], v2 offset:384
    v_mfma_f32_16x16x32_bf16 v[68:71], a[52:55], v[56:59], v[68:71]
    s_mul_i32 s48, s34, 2
    v_mfma_f32_16x16x32_bf16 v[72:75], a[56:59], v[56:59], v[72:75]
    s_add_u32 s48, s48, s32
    v_mfma_f32_16x16x32_bf16 v[76:79], a[60:63], v[56:59], v[76:79]
    s_waitcnt lgkmcnt(5)
    v_mfma_f32_16x16x32_bf16 v[80:83], a[48:51], v[60:63], v[80:83]
    ds_read_b128 v[52:55], v2 offset:17280
    v_mfma_f32_16x16x32_bf16 v[84:87], a[52:55], v[60:63], v[84:87]
    s_add_u32 m0, s57, 2112
    v_mfma_f32_16x16x32_bf16 v[88:91], a[56:59], v[60:63], v[88:91]
    buffer_load_dwordx4 v1, s[20:23], s48 offen sc1 lds
    v_mfma_f32_16x16x32_bf16 v[92:95], a[60:63], v[60:63], v[92:95]
    s_waitcnt lgkmcnt(5)
    v_mfma_f32_16x16x32_bf16 v[64:67], a[64:67], v[32:35], v[64:67]
    ds_read_b128 v[56:59], v2 offset:448
    v_mfma_f32_16x16x32_bf16 v[68:71], a[68:71], v[32:35], v[68:71]
    s_mul_i32 s48, s34, 3
    v_mfma_f32_16x16x32_bf16 v[72:75], a[72:75], v[32:35], v[72:75]
    s_add_u32 s48, s48, s32
    v_mfma_f32_16x16x32_bf16 v[76:79], a[76:79], v[32:35], v[76:79]
    s_waitcnt lgkmcnt(5)
    v_mfma_f32_16x16x32_bf16 v[80:83], a[64:67], v[36:39], v[80:83]
    ds_read_b128 v[60:63], v2 offset:17344
    v_mfma_f32_16x16x32_bf16 v[84:87], a[68:71], v[36:39], v[84:87]
    s_add_u32 m0, s57, 3168
    v_mfma_f32_16x16x32_bf16 v[88:91], a[72:75], v[36:39], v[88:91]
    buffer_load_dwordx4 v1, s[20:23], s48 offen sc1 lds
    v_mfma_f32_16x16x32_bf16 v[92:95], a[76:79], v[36:39], v[92:95]
    s_waitcnt lgkmcnt(5)
    v_mfma_f32_16x16x32_bf16 v[64:67], a[80:83], v[40:43], v[64:67]
    ds_read_b128 v[32:35], v2 offset:512
    v_mfma_f32_16x16x32_bf16 v[68:71], a[84:87], v[40:43], v[68:71]
    s_mul_i32 s48, s34, 8
    v_mfma_f32_16x16x32_bf16 v[72:75], a[88:91], v[40:43], v[72:75]
    s_add_u32 s48, s48, s32
    v_mfma_f32_16x16x32_bf16 v[76:79], a[92:95], v[40:43], v[76:79]
    s_waitcnt lgkmcnt(5)
    v_mfma_f32_16x16x32_bf16 v[80:83], a[80:83], v[44:47], v[80:83]
    ds_read_b128 v[36:39], v2 offset:17408
    v_mfma_f32_16x16x32_bf16 v[84:87], a[84:87], v[44:47], v[84:87]
    s_add_u32 m0, s57, 4224
    v_mfma_f32_16x16x32_bf16 v[88:91], a[88:91], v[44:47], v[88:91]
    buffer_load_dwordx4 v1, s[20:23], s48 offen sc1 lds
    v_mfma_f32_16x16x32_bf16 v[92:95], a[92:95], v[44:47], v[92:95]
    s_waitcnt lgkmcnt(5)
    v_mfma_f32_16x16x32_bf16 v[64:67], a[96:99], v[48:51], v[64:67]
    ds_read_b128 v[40:43], v2 offset:576
    v_mfma_f32_16x16x32_bf16 v[68:71], a[100:103], v[48:51], v[68:71]
    s_mul_i32 s48, s34, 9
    v_mfma_f32_16x16x32_bf16 v[72:75], a[104:107], v[48:51], v[72:75]
    s_add_u32 s48, s48, s32
    v_mfma_f32_16x16x32_bf16 v[76:79], a[108:111], v[48:51], v[76:79]
    s_waitcnt lgkmcnt(5)
    v_mfma_f32_16x16x32_bf16 v[80:83], a[96:99], v[52:55], v[80:83]
    ds_read_b128 v[44:47], v2 offset:17472
    v_mfma_f32_16x16x32_bf16 v[84:87], a[100:103], v[52:55], v[84:87]
    s_add_u32 m0, s57, 5280
    v_mfma_f32_16x16x32_bf16 v[88:91], a[104:107], v[52:55], v[88:91]
    buffer_load_dwordx4 v1, s[20:23], s48 offen sc1 lds
    v_mfma_f32_16x16x32_bf16 v[92:95], a[108:111], v[52:55], v[92:95]
    s_waitcnt lgkmcnt(5)
    v_mfma_f32_16x16x32_bf16 v[64:67], a[112:115], v[56:59], v[64:67]
    ds_read_b128 v[48:51], v2 offset:640
    v_mfma_f32_16x16x32_bf16 v[68:71], a[116:119], v[56:59], v[68:71]
    s_mul_i32 s48, s34, 10
    v_mfma_f32_16x16x32_bf16 v[72:75], a[120:123], v[56:59], v[72:75]
    s_add_u32 s48, s48, s32
    v_mfma_f32_16x16x32_bf16 v[76:79], a[124:127], v[56:59], v[76:79]
    s_waitcnt lgkmcnt(5)
    v_mfma_f32_16x16x32_bf16 v[80:83], a[112:115], v[60:63], v[80:83]
    ds_read_b128 v[52:55], v2 offset:17536
    v_mfma_f32_16x16x32_bf16 v[84:87], a[116:119], v[60:63], v[84:87]
    s_add_u32 m0, s57, 6336
    v_mfma_f32_16x16x32_bf16 v[88:91], a[120:123], v[60:63], v[88:91]
    buffer_load_dwordx4 v1, s[20:23], s48 offen sc1 lds
    v_mfma_f32_16x16x32_bf16 v[92:95], a[124:127], v[60:63], v[92:95]
    s_waitcnt lgkmcnt(5)
    v_mfma_f32_16x16x32_bf16 v[64:67], a[128:131], v[32:35], v[64:67]
    ds_read_b128 v[56:59], v2 offset:704
    v_mfma_f32_16x16x32_bf16 v[68:71], a[132:135], v[32:35], v[68:71]
    s_mul_i32 s48, s34, 11
    v_mfma_f32_16x16x32_bf16 v[72:75], a[136:139], v[32:35], v[72:75]
    s_add_u32 s48, s48, s32
    v_mfma_f32_16x16x32_bf16 v[76:79], a[140:143], v[32:35], v[76:79]
    s_waitcnt lgkmcnt(5)
    v_mfma_f32_16x16x32_bf16 v[80:83], a[128:131], v[36:39], v[80:83]
    ds_read_b128 v[60:63], v2 offset:17600
    v_mfma_f32_16x16x32_bf16 v[84:87], a[132:135], v[36:39], v[84:87]
    s_add_u32 m0, s57, 7392
    v_mfma_f32_16x16x32_bf16 v[88:91], a[136:139], v[36:39], v[88:91]
    buffer_load_dwordx4 v1, s[20:23], s48 offen sc1 lds
    v_mfma_f32_16x16x32_bf16 v[92:95], a[140:143], v[36:39], v[92:95]
    s_waitcnt lgkmcnt(5)
    v_mfma_f32_16x16x32_bf16 v[64:67], a[144:147], v[40:43], v[64:67]
    ds_read_b128 v[32:35], v2 offset:768
    v_mfma_f32_16x16x32_bf16 v[68:71], a[148:151], v[40:43], v[68:71]
    s_sub_u32 s55, s55, 1
    v_mfma_f32_16x16x32_bf16 v[72:75], a[152:155], v[40:43], v[72:75]
    s_cmp_gt_i32 s55, 0
    v_mfma_f32_16x16x32_bf16 v[76:79], a[156:159], v[40:43], v[76:79]
    s_waitcnt lgkmcnt(5)
    v_mfma_f32_16x16x32_bf16 v[80:83], a[144:147], v[44:47], v[80:83]
    ds_read_b128 v[36:39], v2 offset:17664
    v_mfma_f32_16x16x32_bf16 v[84:87], a[148:151], v[44:47], v[84:87]
    s_cselect_b32 s48, s33, 0
    v_mfma_f32_16x16x32_bf16 v[88:91], a[152:155], v[44:47], v[88:91]
    s_add_u32 s32, s32, s48
    v_mfma_f32_16x16x32_bf16 v[92:95], a[156:159], v[44:47], v[92:95]
    s_waitcnt lgkmcnt(5)
    v_mfma_f32_16x16x32_bf16 v[64:67], a[160:163], v[48:51], v[64:67]
    ds_read_b128 v[40:43], v2 offset:832
    v_mfma_f32_16x16x32_bf16 v[68:71], a[164:167], v[48:51], v[68:71]
    s_add_u32 s57, s57, 33792
    v_mfma_f32_16x16x32_bf16 v[72:75], a[168:171], v[48:51], v[72:75]
    s_cmp_ge_u32 s57, 135168
    v_mfma_f32_16x16x32_bf16 v[76:79], a[172:175], v[48:51], v[76:79]
    s_waitcnt lgkmcnt(5)
    v_mfma_f32_16x16x32_bf16 v[80:83], a[160:163], v[52:55], v[80:83]
    ds_read_b128 v[44:47], v2 offset:17728
    v_mfma_f32_16x16x32_bf16 v[84:87], a[164:167], v[52:55], v[84:87]
    s_cselect_b32 s48, 135168, 0
    v_mfma_f32_16x16x32_bf16 v[88:91], a[168:171], v[52:55], v[88:91]
    s_sub_u32 s57, s57, s48
    v_mfma_f32_16x16x32_bf16 v[92:95], a[172:175], v[52:55], v[92:95]
    s_waitcnt lgkmcnt(5)
    v_mfma_f32_16x16x32_bf16 v[64:67], a[176:179], v[56:59], v[64:67]
    ds_read_b128 v[48:51], v2 offset:896
    v_mfma_f32_16x16x32_bf16 v[68:71], a[180:183], v[56:59], v[68:71]
    v_mfma_f32_16x16x32_bf16 v[72:75], a[184:187], v[56:59], v[72:75]
    v_mfma_f32_16x16x32_bf16 v[76:79], a[188:191], v[56:59], v[76:79]
    s_waitcnt lgkmcnt(5)
    v_mfma_f32_16x16x32_bf16 v[80:83], a[176:179], v[60:63], v[80:83]
    ds_read_b128 v[52:55], v2 offset:17792
    v_mfma_f32_16x16x32_bf16 v[84:87], a[180:183], v[60:63], v[84:87]
    v_mfma_f32_16x16x32_bf16 v[88:91], a[184:187], v[60:63], v[88:91]
    v_mfma_f32_16x16x32_bf16 v[92:95], a[188:191], v[60:63], v[92:95]
    s_lshr_b32 s46, 1042, s54
    s_bitcmp1_b32 s46, 0
    s_cbranch_scc0 L_ns_23
    s_waitcnt vmcnt(8)
    s_barrier
    s_cmp_eq_u32 s18, 0
    s_cbranch_scc0 L_sig_24
    v_mov_b32 v24, s44
    v_mov_b32 v25, 1
    s_mov_b64 exec, 1
    global_atomic_add v24, v25, s[16:17]
    s_mov_b64 exec, -1
L_sig_24:
    s_add_u32 s44, s44, s45
L_ns_23:
    s_waitcnt lgkmcnt(5)
    v_mfma_f32_16x16x32_bf16 v[64:67], a[192:195], v[32:35], v[64:67]
    ds_read_b128 v[56:59], v2 offset:960
    v_mfma_f32_16x16x32_bf16 v[68:71], a[196:199], v[32:35], v[68:71]
    v_mfma_f32_16x16x32_bf16 v[72:75], a[200:203], v[32:35], v[72:75]
    v_mfma_f32_16x16x32_bf16 v[76:79], a[204:207], v[32:35], v[76:79]
    s_waitcnt lgkmcnt(5)
    v_mfma_f32_16x16x32_bf16 v[80:83], a[192:195], v[36:39], v[80:83]
    ds_read_b128 v[60:63], v2 offset:17856
    v_mfma_f32_16x16x32_bf16 v[84:87], a[196:199], v[36:39], v[84:87]
    v_mfma_f32_16x16x32_bf16 v[88:91], a[200:203], v[36:39], v[88:91]
    v_mfma_f32_16x16x32_bf16 v[92:95], a[204:207], v[36:39], v[92:95]
    s_waitcnt lgkmcnt(5)
    v_mfma_f32_16x16x32_bf16 v[64:67], a[208:211], v[40:43], v[64:67]
    v_mfma_f32_16x16x32_bf16 v[68:71], a[212:215], v[40:43], v[68:71]
    v_mfma_f32_16x16x32_bf16 v[72:75], a[216:219], v[40:43], v[72:75]
    v_mfma_f32_16x16x32_bf16 v[76:79], a[220:223], v[40:43], v[76:79]
    s_waitcnt lgkmcnt(4)
    v_mfma_f32_16x16x32_bf16 v[80:83], a[208:211], v[44:47], v[80:83]
    v_mfma_f32_16x16x32_bf16 v[84:87], a[212:215], v[44:47], v[84:87]
    v_mfma_f32_16x16x32_bf16 v[88:91], a[216:219], v[44:47], v[88:91]
    v_mfma_f32_16x16x32_bf16 v[92:95], a[220:223], v[44:47], v[92:95]
    s_waitcnt lgkmcnt(3)
    v_mfma_f32_16x16x32_bf16 v[64:67], a[224:227], v[48:51], v[64:67]
    v_mfma_f32_16x16x32_bf16 v[68:71], a[228:231], v[48:51], v[68:71]
    v_mfma_f32_16x16x32_bf16 v[72:75], a[232:235], v[48:51], v[72:75]
    v_mfma_f32_16x16x32_bf16 v[76:79], a[236:239], v[48:51], v[76:79]
    s_waitcnt lgkmcnt(2)
    v_mfma_f32_16x16x32_bf16 v[80:83], a[224:227], v[52:55], v[80:83]
    v_mfma_f32_16x16x32_bf16 v[84:87], a[228:231], v[52:55], v[84:87]
    v_mfma_f32_16x16x32_bf16 v[88:91], a[232:235], v[52:55], v[88:91]
    v_mfma_f32_16x16x32_bf16 v[92:95], a[236:239], v[52:55], v[92:95]
    s_waitcnt lgkmcnt(1)
    v_mfma_f32_16x16x32_bf16 v[64:67], a[240:243], v[56:59], v[64:67]
    v_mfma_f32_16x16x32_bf16 v[68:71], a[244:247], v[56:59], v[68:71]
    v_mfma_f32_16x16x32_bf16 v[72:75], a[248:251], v[56:59], v[72:75]
    v_mfma_f32_16x16x32_bf16 v[76:79], a[252:255], v[56:59], v[76:79]
    s_waitcnt lgkmcnt(0)
    v_mfma_f32_16x16x32_bf16 v[80:83], a[240:243], v[60:63], v[80:83]
    v_mfma_f32_16x16x32_bf16 v[84:87], a[244:247], v[60:63], v[84:87]
    v_mfma_f32_16x16x32_bf16 v[88:91], a[248:251], v[60:63], v[88:91]
    v_mfma_f32_16x16x32_bf16 v[92:95], a[252:255], v[60:63], v[92:95]
    s_add_u32 s56, s56, 33792
    s_cmp_ge_u32 s56, 135168
    s_cselect_b32 s56, 0, s56
    s_add_u32 s54, s54, 1
    s_lshl_b32 s46, s43, 11
    s_add_u32 s46, s46, 4096
    s_add_u32 s47, s36, s46
    s_cmp_eq_u32 s43, 2
    v_pk_mul_f32 v[64:65], v[64:65], s[40:41]
    v_pk_mul_f32 v[66:67], v[66:67], s[40:41]
    v_pk_mul_f32 v[68:69], v[68:69], s[40:41]
    v_pk_mul_f32 v[70:71], v[70:71], s[40:41]
    v_pk_mul_f32 v[72:73], v[72:73], s[40:41]
    v_pk_mul_f32 v[74:75], v[74:75], s[40:41]
    v_pk_mul_f32 v[76:77], v[76:77], s[40:41]
    v_pk_mul_f32 v[78:79], v[78:79], s[40:41]
    v_pk_mul_f32 v[80:81], v[80:81], s[40:41]
    v_pk_mul_f32 v[82:83], v[82:83], s[40:41]
    v_pk_mul_f32 v[84:85], v[84:85], s[40:41]
    v_pk_mul_f32 v[86:87], v[86:87], s[40:41]
    v_pk_mul_f32 v[88:89], v[88:89], s[40:41]
    v_pk_mul_f32 v[90:91], v[90:91], s[40:41]
    v_pk_mul_f32 v[92:93], v[92:93], s[40:41]
    v_pk_mul_f32 v[94:95], v[94:95], s[40:41]
    v_cvt_pk_bf16_f32 v8, v64, v68
    v_cvt_pk_bf16_f32 v9, v72, v76
    v_cvt_pk_bf16_f32 v10, v65, v69
    v_cvt_pk_bf16_f32 v11, v73, v77
    v_cvt_pk_bf16_f32 v12, v66, v70
    v_cvt_pk_bf16_f32 v13, v74, v78
    v_cvt_pk_bf16_f32 v14, v67, v71
    v_cvt_pk_bf16_f32 v15, v75, v79
    v_cvt_pk_bf16_f32 v16, v80, v84
    v_cvt_pk_bf16_f32 v17, v88, v92
    v_cvt_pk_bf16_f32 v18, v81, v85
    v_cvt_pk_bf16_f32 v19, v89, v93
    v_cvt_pk_bf16_f32 v20, v82, v86
    v_cvt_pk_bf16_f32 v21, v90, v94
    v_cvt_pk_bf16_f32 v22, v83, v87
    v_cvt_pk_bf16_f32 v23, v91, v95
    s_cbranch_scc1 L_gemm_out
    buffer_store_dwordx4 v[8:11], v4, s[28:31], s36 offen offset:0 sc1
    buffer_store_dwordx4 v[12:15], v4, s[28:31], s36 offen offset:256 sc1
    buffer_store_dwordx4 v[16:19], v4, s[28:31], s47 offen offset:0 sc1
    buffer_store_dwordx4 v[20:23], v4, s[28:31], s47 offen offset:256 sc1
L_gemm_qk_next:
    s_add_u32 s36, s36, s37
    s_cmp_lt_u32 s54, s42
    s_cbranch_scc1 L_gemm_qk
    s_branch L_gemm_end
L_gemm_out:
    buffer_store_dwordx4 v[8:11], v4, s[28:31], s36 offen offset:0 nt
    buffer_store_dwordx4 v[12:15], v4, s[28:31], s36 offen offset:16 nt
    buffer_store_dwordx4 v[16:19], v4, s[28:31], s47 offen offset:0 nt
    buffer_store_dwordx4 v[20:23], v4, s[28:31], s47 offen offset:16 nt
    s_branch L_gemm_qk_next
L_gemm_v:
    v_add_u32 v2, s56, v3
    s_waitcnt vmcnt(12)
    s_barrier
    ds_read_b128 v[32:35], v2 offset:0
    ds_read_b128 v[36:39], v2 offset:16896
    ds_read_b128 v[40:43], v2 offset:64
    ds_read_b128 v[44:47], v2 offset:16960
    ds_read_b128 v[48:51], v2 offset:128
    ds_read_b128 v[52:55], v2 offset:17024
    s_waitcnt lgkmcnt(5)
    v_mfma_f32_16x16x32_bf16 v[64:67], v[32:35], a[0:3], 0
    ds_read_b128 v[56:59], v2 offset:192
    v_mfma_f32_16x16x32_bf16 v[68:71], v[32:35], a[4:7], 0
    v_mfma_f32_16x16x32_bf16 v[72:75], v[32:35], a[8:11], 0
    v_mfma_f32_16x16x32_bf16 v[76:79], v[32:35], a[12:15], 0
    s_waitcnt lgkmcnt(5)
    v_mfma_f32_16x16x32_bf16 v[80:83], v[36:39], a[0:3], 0
    ds_read_b128 v[60:63], v2 offset:17088
    v_mfma_f32_16x16x32_bf16 v[84:87], v[36:39], a[4:7], 0
    v_mfma_f32_16x16x32_bf16 v[88:91], v[36:39], a[8:11], 0
    v_mfma_f32_16x16x32_bf16 v[92:95], v[36:39], a[12:15], 0
    s_waitcnt lgkmcnt(5)
    v_mfma_f32_16x16x32_bf16 v[64:67], v[40:43], a[16:19], v[64:67]
    ds_read_b128 v[32:35], v2 offset:256
    v_mfma_f32_16x16x32_bf16 v[68:71], v[40:43], a[20:23], v[68:71]
    s_mul_i32 s48, s34, 0
    v_mfma_f32_16x16x32_bf16 v[72:75], v[40:43], a[24:27], v[72:75]
    s_add_u32 s48, s48, s32
    v_mfma_f32_16x16x32_bf16 v[76:79], v[40:43], a[28:31], v[76:79]
    s_waitcnt lgkmcnt(5)
    v_mfma_f32_16x16x32_bf16 v[80:83], v[44:47], a[16:19], v[80:83]
    ds_read_b128 v[36:39], v2 offset:17152
    v_mfma_f32_16x16x32_bf16 v[84:87], v[44:47], a[20:23], v[84:87]
    s_add_u32 m0, s57, 0
    v_mfma_f32_16x16x32_bf16 v[88:91], v[44:47], a[24:27], v[88:91]
    buffer_load_dwordx4 v1, s[20:23], s48 offen sc1 lds
    v_mfma_f32_16x16x32_bf16 v[92:95], v[44:47], a[28:31], v[92:95]
    s_waitcnt lgkmcnt(5)
    v_mfma_f32_16x16x32_bf16 v[64:67], v[48:51], a[32:35], v[64:67]
    ds_read_b128 v[40:43], v2 offset:320
    v_mfma_f32_16x16x32_bf16 v[68:71], v[48:51], a[36:39], v[68:71]
    s_mul_i32 s48, s34, 1
    v_mfma_f32_16x16x32_bf16 v[72:75], v[48:51], a[40:43], v[72:75]
    s_add_u32 s48, s48, s32
    v_mfma_f32_16x16x32_bf16 v[76:79], v[48:51], a[44:47], v[76:79]
    s_waitcnt lgkmcnt(5)
    v_mfma_f32_16x16x32_bf16 v[80:83], v[52:55], a[32:35], v[80:83]
    ds_read_b128 v[44:47], v2 offset:17216
    v_mfma_f32_16x16x32_bf16 v[84:87], v[52:55], a[36:39], v[84:87]
    s_add_u32 m0, s57, 1056
    v_mfma_f32_16x16x32_bf16 v[88:91], v[52:55], a[40:43], v[88:91]
    buffer_load_dwordx4 v1, s[20:23], s48 offen sc1 lds
    v_mfma_f32_16x16x32_bf16 v[92:95], v[52:55], a[44:47], v[92:95]
    s_waitcnt lgkmcnt(5)
    v_mfma_f32_16x16x32_bf16 v[64:67], v[56:59], a[48:51], v[64:67]
    ds_read_b128 v[48:51], v2 offset:384
    v_mfma_f32_16x16x32_bf16 v[68:71], v[56:59], a[52:55], v[68:71]
    s_mul_i32 s48, s34, 2
    v_mfma_f32_16x16x32_bf16 v[72:75], v[56:59], a[56:59], v[72:75]
    s_add_u32 s48, s48, s32
    v_mfma_f32_16x16x32_bf16 v[76:79], v[56:59], a[60:63], v[76:79]
    s_waitcnt lgkmcnt(5)
    v_mfma_f32_16x16x32_bf16 v[80:83], v[60:63], a[48:51], v[80:83]
    ds_read_b128 v[52:55], v2 offset:17280
    v_mfma_f32_16x16x32_bf16 v[84:87], v[60:63], a[52:55], v[84:87]
    s_add_u32 m0, s57, 2112
    v_mfma_f32_16x16x32_bf16 v[88:91], v[60:63], a[56:59], v[88:91]
    buffer_load_dwordx4 v1, s[20:23], s48 offen sc1 lds
    v_mfma_f32_16x16x32_bf16 v[92:95], v[60:63], a[60:63], v[92:95]
    s_waitcnt lgkmcnt(5)
    v_mfma_f32_16x16x32_bf16 v[64:67], v[32:35], a[64:67], v[64:67]
    ds_read_b128 v[56:59], v2 offset:448
    v_mfma_f32_16x16x32_bf16 v[68:71], v[32:35], a[68:71], v[68:71]
    s_mul_i32 s48, s34, 3
    v_mfma_f32_16x16x32_bf16 v[72:75], v[32:35], a[72:75], v[72:75]
    s_add_u32 s48, s48, s32
    v_mfma_f32_16x16x32_bf16 v[76:79], v[32:35], a[76:79], v[76:79]
    s_waitcnt lgkmcnt(5)
    v_mfma_f32_16x16x32_bf16 v[80:83], v[36:39], a[64:67], v[80:83]
    ds_read_b128 v[60:63], v2 offset:17344
    v_mfma_f32_16x16x32_bf16 v[84:87], v[36:39], a[68:71], v[84:87]
    s_add_u32 m0, s57, 3168
    v_mfma_f32_16x16x32_bf16 v[88:91], v[36:39], a[72:75], v[88:91]
    buffer_load_dwordx4 v1, s[20:23], s48 offen sc1 lds
    v_mfma_f32_16x16x32_bf16 v[92:95], v[36:39], a[76:79], v[92:95]
    s_waitcnt lgkmcnt(5)
    v_mfma_f32_16x16x32_bf16 v[64:67], v[40:43], a[80:83], v[64:67]
    ds_read_b128 v[32:35], v2 offset:512
    v_mfma_f32_16x16x32_bf16 v[68:71], v[40:43], a[84:87], v[68:71]
    s_mul_i32 s48, s34, 8
    v_mfma_f32_16x16x32_bf16 v[72:75], v[40:43], a[88:91], v[72:75]
    s_add_u32 s48, s48, s32
    v_mfma_f32_16x16x32_bf16 v[76:79], v[40:43], a[92:95], v[76:79]
    s_waitcnt lgkmcnt(5)
    v_mfma_f32_16x16x32_bf16 v[80:83], v[44:47], a[80:83], v[80:83]
    ds_read_b128 v[36:39], v2 offset:17408
    v_mfma_f32_16x16x32_bf16 v[84:87], v[44:47], a[84:87], v[84:87]
    s_add_u32 m0, s57, 4224
    v_mfma_f32_16x16x32_bf16 v[88:91], v[44:47], a[88:91], v[88:91]
    buffer_load_dwordx4 v1, s[20:23], s48 offen sc1 lds
    v_mfma_f32_16x16x32_bf16 v[92:95], v[44:47], a[92:95], v[92:95]
    s_waitcnt lgkmcnt(5)
    v_mfma_f32_16x16x32_bf16 v[64:67], v[48:51], a[96:99], v[64:67]
    ds_read_b128 v[40:43], v2 offset:576
    v_mfma_f32_16x16x32_bf16 v[68:71], v[48:51], a[100:103], v[68:71]
    s_mul_i32 s48, s34, 9
    v_mfma_f32_16x16x32_bf16 v[72:75], v[48:51], a[104:107], v[72:75]
    s_add_u32 s48, s48, s32
    v_mfma_f32_16x16x32_bf16 v[76:79], v[48:51], a[108:111], v[76:79]
    s_waitcnt lgkmcnt(5)
    v_mfma_f32_16x16x32_bf16 v[80:83], v[52:55], a[96:99], v[80:83]
    ds_read_b128 v[44:47], v2 offset:17472
    v_mfma_f32_16x16x32_bf16 v[84:87], v[52:55], a[100:103], v[84:87]
    s_add_u32 m0, s57, 5280
    v_mfma_f32_16x16x32_bf16 v[88:91], v[52:55], a[104:107], v[88:91]
    buffer_load_dwordx4 v1, s[20:23], s48 offen sc1 lds
    v_mfma_f32_16x16x32_bf16 v[92:95], v[52:55], a[108:111], v[92:95]
    s_waitcnt lgkmcnt(5)
    v_mfma_f32_16x16x32_bf16 v[64:67], v[56:59], a[112:115], v[64:67]
    ds_read_b128 v[48:51], v2 offset:640
    v_mfma_f32_16x16x32_bf16 v[68:71], v[56:59], a[116:119], v[68:71]
    s_mul_i32 s48, s34, 10
    v_mfma_f32_16x16x32_bf16 v[72:75], v[56:59], a[120:123], v[72:75]
    s_add_u32 s48, s48, s32
    v_mfma_f32_16x16x32_bf16 v[76:79], v[56:59], a[124:127], v[76:79]
    s_waitcnt lgkmcnt(5)
    v_mfma_f32_16x16x32_bf16 v[80:83], v[60:63], a[112:115], v[80:83]
    ds_read_b128 v[52:55], v2 offset:17536
    v_mfma_f32_16x16x32_bf16 v[84:87], v[60:63], a[116:119], v[84:87]
    s_add_u32 m0, s57, 6336
    v_mfma_f32_16x16x32_bf16 v[88:91], v[60:63], a[120:123], v[88:91]
    buffer_load_dwordx4 v1, s[20:23], s48 offen sc1 lds
    v_mfma_f32_16x16x32_bf16 v[92:95], v[60:63], a[124:127], v[92:95]
    s_waitcnt lgkmcnt(5)
    v_mfma_f32_16x16x32_bf16 v[64:67], v[32:35], a[128:131], v[64:67]
    ds_read_b128 v[56:59], v2 offset:704
    v_mfma_f32_16x16x32_bf16 v[68:71], v[32:35], a[132:135], v[68:71]
    s_mul_i32 s48, s34, 11
    v_mfma_f32_16x16x32_bf16 v[72:75], v[32:35], a[136:139], v[72:75]
    s_add_u32 s48, s48, s32
    v_mfma_f32_16x16x32_bf16 v[76:79], v[32:35], a[140:143], v[76:79]
    s_waitcnt lgkmcnt(5)
    v_mfma_f32_16x16x32_bf16 v[80:83], v[36:39], a[128:131], v[80:83]
    ds_read_b128 v[60:63], v2 offset:17600
    v_mfma_f32_16x16x32_bf16 v[84:87], v[36:39], a[132:135], v[84:87]
    s_add_u32 m0, s57, 7392
    v_mfma_f32_16x16x32_bf16 v[88:91], v[36:39], a[136:139], v[88:91]
    buffer_load_dwordx4 v1, s[20:23], s48 offen sc1 lds
    v_mfma_f32_16x16x32_bf16 v[92:95], v[36:39], a[140:143], v[92:95]
    s_waitcnt lgkmcnt(5)
    v_mfma_f32_16x16x32_bf16 v[64:67], v[40:43], a[144:147], v[64:67]
    ds_read_b128 v[32:35], v2 offset:768
    v_mfma_f32_16x16x32_bf16 v[68:71], v[40:43], a[148:151], v[68:71]
    s_sub_u32 s55, s55, 1
    v_mfma_f32_16x16x32_bf16 v[72:75], v[40:43], a[152:155], v[72:75]
    s_cmp_gt_i32 s55, 0
    v_mfma_f32_16x16x32_bf16 v[76:79], v[40:43], a[156:159], v[76:79]
    s_waitcnt lgkmcnt(5)
    v_mfma_f32_16x16x32_bf16 v[80:83], v[44:47], a[144:147], v[80:83]
    ds_read_b128 v[36:39], v2 offset:17664
    v_mfma_f32_16x16x32_bf16 v[84:87], v[44:47], a[148:151], v[84:87]
    s_cselect_b32 s48, s33, 0
    v_mfma_f32_16x16x32_bf16 v[88:91], v[44:47], a[152:155], v[88:91]
    s_add_u32 s32, s32, s48
    v_mfma_f32_16x16x32_bf16 v[92:95], v[44:47], a[156:159], v[92:95]
    s_waitcnt lgkmcnt(5)
    v_mfma_f32_16x16x32_bf16 v[64:67], v[48:51], a[160:163], v[64:67]
    ds_read_b128 v[40:43], v2 offset:832
    v_mfma_f32_16x16x32_bf16 v[68:71], v[48:51], a[164:167], v[68:71]
    s_add_u32 s57, s57, 33792
    v_mfma_f32_16x16x32_bf16 v[72:75], v[48:51], a[168:171], v[72:75]
    s_cmp_ge_u32 s57, 135168
    v_mfma_f32_16x16x32_bf16 v[76:79], v[48:51], a[172:175], v[76:79]
    s_waitcnt lgkmcnt(5)
    v_mfma_f32_16x16x32_bf16 v[80:83], v[52:55], a[160:163], v[80:83]
    ds_read_b128 v[44:47], v2 offset:17728
    v_mfma_f32_16x16x32_bf16 v[84:87], v[52:55], a[164:167], v[84:87]
    s_cselect_b32 s48, 135168, 0
    v_mfma_f32_16x16x32_bf16 v[88:91], v[52:55], a[168:171], v[88:91]
    s_sub_u32 s57, s57, s48
    v_mfma_f32_16x16x32_bf16 v[92:95], v[52:55], a[172:175], v[92:95]
    s_waitcnt lgkmcnt(5)
    v_mfma_f32_16x16x32_bf16 v[64:67], v[56:59], a[176:179], v[64:67]
    ds_read_b128 v[48:51], v2 offset:896
    v_mfma_f32_16x16x32_bf16 v[68:71], v[56:59], a[180:183], v[68:71]
    v_mfma_f32_16x16x32_bf16 v[72:75], v[56:59], a[184:187], v[72:75]
    v_mfma_f32_16x16x32_bf16 v[76:79], v[56:59], a[188:191], v[76:79]
    s_waitcnt lgkmcnt(5)
    v_mfma_f32_16x16x32_bf16 v[80:83], v[60:63], a[176:179], v[80:83]
    ds_read_b128 v[52:55], v2 offset:17792
    v_mfma_f32_16x16x32_bf16 v[84:87], v[60:63], a[180:183], v[84:87]
    v_mfma_f32_16x16x32_bf16 v[88:91], v[60:63], a[184:187], v[88:91]
    v_mfma_f32_16x16x32_bf16 v[92:95], v[60:63], a[188:191], v[92:95]
    s_lshr_b32 s46, 1042, s54
    s_bitcmp1_b32 s46, 0
    s_cbranch_scc0 L_ns_25
    s_waitcnt vmcnt(8)
    s_barrier
    s_cmp_eq_u32 s18, 0
    s_cbranch_scc0 L_sig_26
    v_mov_b32 v24, s44
    v_mov_b32 v25, 1
    s_mov_b64 exec, 1
    global_atomic_add v24, v25, s[16:17]
    s_mov_b64 exec, -1
L_sig_26:
    s_add_u32 s44, s44, s45
L_ns_25:
    s_waitcnt lgkmcnt(5)
    v_mfma_f32_16x16x32_bf16 v[64:67], v[32:35], a[192:195], v[64:67]
    ds_read_b128 v[56:59], v2 offset:960
    v_mfma_f32_16x16x32_bf16 v[68:71], v[32:35], a[196:199], v[68:71]
    v_mfma_f32_16x16x32_bf16 v[72:75], v[32:35], a[200:203], v[72:75]
    v_mfma_f32_16x16x32_bf16 v[76:79], v[32:35], a[204:207], v[76:79]
    s_waitcnt lgkmcnt(5)
    v_mfma_f32_16x16x32_bf16 v[80:83], v[36:39], a[192:195], v[80:83]
    ds_read_b128 v[60:63], v2 offset:17856
    v_mfma_f32_16x16x32_bf16 v[84:87], v[36:39], a[196:199], v[84:87]
    v_mfma_f32_16x16x32_bf16 v[88:91], v[36:39], a[200:203], v[88:91]
    v_mfma_f32_16x16x32_bf16 v[92:95], v[36:39], a[204:207], v[92:95]
    s_waitcnt lgkmcnt(5)
    v_mfma_f32_16x16x32_bf16 v[64:67], v[40:43], a[208:211], v[64:67]
    v_mfma_f32_16x16x32_bf16 v[68:71], v[40:43], a[212:215], v[68:71]
    v_mfma_f32_16x16x32_bf16 v[72:75], v[40:43], a[216:219], v[72:75]
    v_mfma_f32_16x16x32_bf16 v[76:79], v[40:43], a[220:223], v[76:79]
    s_waitcnt lgkmcnt(4)
    v_mfma_f32_16x16x32_bf16 v[80:83], v[44:47], a[208:211], v[80:83]
    v_mfma_f32_16x16x32_bf16 v[84:87], v[44:47], a[212:215], v[84:87]
    v_mfma_f32_16x16x32_bf16 v[88:91], v[44:47], a[216:219], v[88:91]
    v_mfma_f32_16x16x32_bf16 v[92:95], v[44:47], a[220:223], v[92:95]
    s_waitcnt lgkmcnt(3)
    v_mfma_f32_16x16x32_bf16 v[64:67], v[48:51], a[224:227], v[64:67]
    v_mfma_f32_16x16x32_bf16 v[68:71], v[48:51], a[228:231], v[68:71]
    v_mfma_f32_16x16x32_bf16 v[72:75], v[48:51], a[232:235], v[72:75]
    v_mfma_f32_16x16x32_bf16 v[76:79], v[48:51], a[236:239], v[76:79]
    s_waitcnt lgkmcnt(2)
    v_mfma_f32_16x16x32_bf16 v[80:83], v[52:55], a[224:227], v[80:83]
    v_mfma_f32_16x16x32_bf16 v[84:87], v[52:55], a[228:231], v[84:87]
    v_mfma_f32_16x16x32_bf16 v[88:91], v[52:55], a[232:235], v[88:91]
    v_mfma_f32_16x16x32_bf16 v[92:95], v[52:55], a[236:239], v[92:95]
    s_waitcnt lgkmcnt(1)
    v_mfma_f32_16x16x32_bf16 v[64:67], v[56:59], a[240:243], v[64:67]
    v_mfma_f32_16x16x32_bf16 v[68:71], v[56:59], a[244:247], v[68:71]
    v_mfma_f32_16x16x32_bf16 v[72:75], v[56:59], a[248:251], v[72:75]
    v_mfma_f32_16x16x32_bf16 v[76:79], v[56:59], a[252:255], v[76:79]
    s_waitcnt lgkmcnt(0)
    v_mfma_f32_16x16x32_bf16 v[80:83], v[60:63], a[240:243], v[80:83]
    v_mfma_f32_16x16x32_bf16 v[84:87], v[60:63], a[244:247], v[84:87]
    v_mfma_f32_16x16x32_bf16 v[88:91], v[60:63], a[248:251], v[88:91]
    v_mfma_f32_16x16x32_bf16 v[92:95], v[60:63], a[252:255], v[92:95]
    s_add_u32 s56, s56, 33792
    s_cmp_ge_u32 s56, 135168
    s_cselect_b32 s56, 0, s56
    s_add_u32 s54, s54, 1
    v_pk_mul_f32 v[64:65], v[64:65], s[40:41]
    v_pk_mul_f32 v[66:67], v[66:67], s[40:41]
    v_pk_mul_f32 v[68:69], v[68:69], s[40:41]
    v_pk_mul_f32 v[70:71], v[70:71], s[40:41]
    v_pk_mul_f32 v[72:73], v[72:73], s[40:41]
    v_pk_mul_f32 v[74:75], v[74:75], s[40:41]
    v_pk_mul_f32 v[76:77], v[76:77], s[40:41]
    v_pk_mul_f32 v[78:79], v[78:79], s[40:41]
    v_pk_mul_f32 v[80:81], v[80:81], s[40:41]
    v_pk_mul_f32 v[82:83], v[82:83], s[40:41]
    v_pk_mul_f32 v[84:85], v[84:85], s[40:41]
    v_pk_mul_f32 v[86:87], v[86:87], s[40:41]
    v_pk_mul_f32 v[88:89], v[88:89], s[40:41]
    v_pk_mul_f32 v[90:91], v[90:91], s[40:41]
    v_pk_mul_f32 v[92:93], v[92:93], s[40:41]
    v_pk_mul_f32 v[94:95], v[94:95], s[40:41]
    v_cvt_pk_bf16_f32 v8, v64, v65
    v_cvt_pk_bf16_f32 v9, v66, v67
    v_cvt_pk_bf16_f32 v10, v80, v81
    v_cvt_pk_bf16_f32 v11, v82, v83
    v_cvt_pk_bf16_f32 v12, v68, v69
    v_cvt_pk_bf16_f32 v13, v70, v71
    v_cvt_pk_bf16_f32 v14, v84, v85
    v_cvt_pk_bf16_f32 v15, v86, v87
    v_cvt_pk_bf16_f32 v16, v72, v73
    v_cvt_pk_bf16_f32 v17, v74, v75
    v_cvt_pk_bf16_f32 v18, v88, v89
    v_cvt_pk_bf16_f32 v19, v90, v91
    v_cvt_pk_bf16_f32 v20, v76, v77
    v_cvt_pk_bf16_f32 v21, v78, v79
    v_cvt_pk_bf16_f32 v22, v92, v93
    v_cvt_pk_bf16_f32 v23, v94, v95
    buffer_store_dwordx4 v[8:11], v4, s[28:31], s36 offen offset:0 sc1
    buffer_store_dwordx4 v[12:15], v4, s[28:31], s36 offen offset:1024 sc1
    buffer_store_dwordx4 v[16:19], v4, s[28:31], s36 offen offset:2048 sc1
    buffer_store_dwordx4 v[20:23], v4, s[28:31], s36 offen offset:3072 sc1
L_gemm_v_next:
    s_add_u32 s36, s36, s37
    s_cmp_lt_u32 s54, s42
    s_cbranch_scc1 L_gemm_v
    s_branch L_gemm_end
L_gemm_end:
    s_waitcnt vmcnt(0)
    s_barrier
    s_cmp_eq_u32 s18, 0
    s_cbranch_scc0 L_sig_27
    v_mov_b32 v24, s44
    v_mov_b32 v25, 1
    s_mov_b64 exec, 1
    global_atomic_add v24, v25, s[16:17]
    s_mov_b64 exec, -1
L_sig_27:
    s_add_u32 s44, s44, s45
    s_setpc_b64 s[52:53]
L_code_end:
.section .rodata,"a"
.p2align 6
.amdhsa_kernel concat_heads__memory_aug_recurrent_mem_tr__mha_block__prompt_kernel
  .amdhsa_next_free_vgpr 512
  .amdhsa_next_free_sgpr 102
  .amdhsa_accum_offset 256
  .amdhsa_group_segment_fixed_size 0
  .amdhsa_kernarg_size 104
  .amdhsa_user_sgpr_count 2
  .amdhsa_user_sgpr_kernarg_segment_ptr 1
  .amdhsa_system_sgpr_workgroup_id_x 1
.end_amdhsa_kernel
```
